```python
import torch

def _softmax(x, axis=-1):
    return torch.softmax(x, dim=axis)
def _gelu(x):
    return torch.nn.functional.gelu(x, approximate="tanh")
def _silu(x):
    return torch.nn.functional.silu(x)
def _sigmoid(x):
    return torch.sigmoid(x)
def _layernorm(x, axis=-1, eps=1e-5):
    m = x.mean(dim=axis, keepdim=True)
    v = x.var(dim=axis, keepdim=True, unbiased=False)
    return (x - m) / torch.sqrt(v + eps)
def _scatter_add(tgt, idx, src, axis=0):
    return tgt.clone().index_add_(axis, idx, src)
def _segment_sum(src, seg, n):
    out = torch.zeros((n,) + src.shape[1:], dtype=src.dtype)
    return out.index_add_(0, seg, src)
def _pad(x, pw):
    flat = tuple(v for pair in reversed(pw) for v in pair)
    return torch.nn.functional.pad(x, flat)

kernel_name = 'standalone__adm_resblock__diffusion'

def setup_inputs():

    _w = (lambda a: (lambda t: t.to(torch.bfloat16) if t.is_floating_point() else t)(torch.as_tensor(a)))
    B, C, HW, E = 2, 320, 64, 1152
    sc = (9.0 * C) ** -0.5
    return {
        "x": _w((lambda *s: torch.randn(*s, dtype=torch.bfloat16) * 0.05)(B, C, HW, HW)),
        "t_emb": _w((lambda *s: torch.randn(*s, dtype=torch.bfloat16) * 0.2)(B, E)),
        "g1": _w(1.0 + 0.1 * (lambda *s: torch.randn(*s, dtype=torch.bfloat16) * 0.2)(C)),
        "be1": _w(0.1 * (lambda *s: torch.randn(*s, dtype=torch.bfloat16) * 0.2)(C)),
        "w1": _w((lambda *s: torch.randn(*s, dtype=torch.bfloat16) * 0.2)(C, C, 3, 3) * sc),
        "w_emb": _w((lambda *s: torch.randn(*s, dtype=torch.bfloat16) * 0.2)(E, C) * (E ** -0.5)),
        "g2": _w(1.0 + 0.1 * (lambda *s: torch.randn(*s, dtype=torch.bfloat16) * 0.2)(C)),
        "be2": _w(0.1 * (lambda *s: torch.randn(*s, dtype=torch.bfloat16) * 0.2)(C)),
        "w2": _w((lambda *s: torch.randn(*s, dtype=torch.bfloat16) * 0.2)(C, C, 3, 3) * sc),
    }

def reference(x, t_emb, g1, be1, w1, w_emb, g2, be2, w2):
    B, C, H, W = x.shape
    G, eps = 4, 1e-5
    def gn(z, gamma, beta):
        zr = z.reshape(B, G, (C // G) * H * W)
        mu = zr.mean(-1).reshape(B, G, 1)
        var = ((zr - mu) ** 2).mean(-1).reshape(B, G, 1)
        zn = ((zr - mu) / torch.sqrt(var + eps)).reshape(B, C, H, W)
        return zn * gamma.reshape(1, C, 1, 1) + beta.reshape(1, C, 1, 1)
    def conv3(z, w):
        zp = _pad(z, ((0, 0), (0, 0), (1, 1), (1, 1)))
        taps = [torch.einsum("bchw,oc->bohw", zp[:, :, i:i+H, j:j+W], w[:, :, i, j]) for i in range(3) for j in range(3)]
        out = taps[0]
        for t in taps[1:]:
            out = out + t
        return out
    h = conv3(_silu(gn(x, g1, be1)), w1)
    emb = _silu(t_emb) @ w_emb
    h = h + emb.reshape(B, C, 1, 1)
    h = conv3(_silu(gn(h, g2, be2)), w2)
    return x + h
```

```asm
; @launch kernel=standalone__adm_resblock__diffusion_kernel grid=(256,1,1) block=(256,1,1) lds=163840
.amdgcn_target "amdgcn-amd-amdhsa--gfx950"
.text
.globl standalone__adm_resblock__diffusion_kernel
.p2align 8
.type standalone__adm_resblock__diffusion_kernel,@function
standalone__adm_resblock__diffusion_kernel:
    s_cmp_ge_u32 s2, 256
    s_cbranch_scc1 c2_end
    s_load_dwordx16 s[16:31], s[0:1], 0
    s_load_dwordx8 s[32:39], s[0:1], 64
    v_lshrrev_b32 v1, 6, v0
    v_and_b32 v2, 63, v0
    v_readfirstlane_b32 s3, v1
    s_lshr_b32 s4, s2, 6
    s_bfe_u32 s5, s2, 0x10002
    s_and_b32 s8, s2, 3
    s_bfe_u32 s9, s2, 0x30003
    s_lshl_b32 s8, s8, 4
    s_lshl_b32 s9, s9, 1
    s_add_u32 s6, s8, s9
    s_mul_i32 s8, s3, 40960
    v_lshrrev_b32 v3, 2, v2
    v_lshlrev_b32 v3, 13, v3
    v_and_b32 v4, 3, v2
    v_lshl_add_u32 v3, v4, 4, v3
    s_lshl_b32 s12, s5, 2
    s_add_u32 s12, s12, s4
    s_mul_i32 s11, s12, 655360
    s_lshl_b32 s14, s6, 7
    s_add_u32 s11, s11, s14
    s_lshl_b32 s14, s3, 6
    s_add_u32 s56, s11, s14
    s_getpc_b64 s[88:89]
m_pc:
    s_lshr_b32 s14, s2, 3
    s_mul_i32 s14, s14, 11
    v_add_u32 v6, s14, v0
    v_lshlrev_b32 v6, 7, v6
    v_min_u32 v6, c2_end-m_pc-4, v6
    v_cmp_gt_u32 vcc, 11, v0
    v_mov_b32 v0, 0
    s_and_saveexec_b64 s[14:15], vcc
    s_cbranch_execz m_noipf
    global_load_dword v8, v6, s[88:89]
m_noipf:
    s_mov_b64 exec, -1
    s_waitcnt lgkmcnt(0)
    s_mov_b32 s52, s16
    s_mov_b32 s53, s17
    s_mov_b32 s54, 0x500000
    s_mov_b32 s55, 0x00020000
    s_add_u32 m0, s8, 34816
    s_add_u32 s11, s56, 0
    buffer_load_dwordx4 v3, s[52:55], s11 offen lds
    s_add_u32 m0, s8, 35840
    s_add_u32 s11, s56, 131072
    buffer_load_dwordx4 v3, s[52:55], s11 offen lds
    s_add_u32 m0, s8, 36864
    s_add_u32 s11, s56, 262144
    buffer_load_dwordx4 v3, s[52:55], s11 offen lds
    s_add_u32 m0, s8, 37888
    s_add_u32 s11, s56, 393216
    buffer_load_dwordx4 v3, s[52:55], s11 offen lds
    s_add_u32 m0, s8, 38912
    s_add_u32 s11, s56, 524288
    buffer_load_dwordx4 v3, s[52:55], s11 offen lds
    s_add_u32 s92, s38, 0x1200000
    s_addc_u32 s93, s39, 0
    s_mov_b32 s94, 0x80000
    s_mov_b32 s95, 0x00020000
    s_mov_b32 s14, 0x24000
    buffer_load_dwordx2 v[246:247], v0, s[92:95], s14 offen sc1
    s_lshl_b32 s15, s12, 12
    s_add_u32 s15, s15, 0x1100000
    s_add_u32 s96, s38, s15
    s_addc_u32 s97, s39, 0
    s_mov_b32 s98, 4096
    s_mov_b32 s99, 0x00020000
    v_mov_b32 v0, 0
    buffer_load_dwordx2 v[244:245], v0, s[96:99], 0 offen offset:1024 sc1
    s_mov_b32 s56, s20
    s_mov_b32 s57, s21
    s_mov_b32 s58, 0x280
    s_mov_b32 s59, 0x00020000
    s_mov_b32 s60, s22
    s_mov_b32 s61, s23
    s_mov_b32 s62, 0x280
    s_mov_b32 s63, 0x00020000
    v_lshlrev_b32 v11, 4, v2
    s_mul_i32 s11, s4, 160
    s_mov_b64 exec, 0x3ff
    s_add_u32 m0, s8, 39936
    s_nop 0
    buffer_load_dwordx4 v11, s[56:59], s11 offen lds
    s_add_u32 m0, s8, 40192
    s_nop 0
    buffer_load_dwordx4 v11, s[60:63], s11 offen lds
    s_mov_b64 exec, -1
    v_lshlrev_b32 v11, 4, v2
    v_and_b32 v7, 15, v2
    v_lshrrev_b32 v28, 4, v2
    v_mul_u32_u24 v44, 36, v28
    v_mul_u32_u24 v45, 5760, v7
    v_add_u32 v44, v44, v45
    v_lshlrev_b32 v46, 4, v7
    v_lshlrev_b32 v47, 4, v28
    s_lshl_b32 s14, s5, 6
    s_add_u32 s14, s14, s6
    s_lshl_b32 s14, s14, 1
    s_mov_b32 s49, s14
    s_add_u32 s14, s14, s3
    s_max_u32 s15, s14, 199
    s_sub_u32 s15, s15, 199
    s_min_u32 s15, s15, 1
    s_mul_i32 s84, s15, 0x7fff0000
    s_min_u32 s14, s14, 199
    s_mul_i32 s15, s14, 52429
    s_lshr_b32 s15, s15, 21
    s_mul_i32 s85, s15, 40
    s_sub_u32 s14, s14, s85
    s_mul_i32 s85, s4, 5
    s_add_u32 s85, s85, s15
    s_mul_i32 s85, s85, 92160
    s_mul_i32 s86, s14, 144
    s_add_u32 s85, s85, s86
    s_add_u32 s85, s85, s84
    v_add_u32 v48, s85, v44
    s_mul_i32 s85, s14, 6554
    s_lshr_b32 s85, s85, 16
    s_mul_i32 s86, s85, 10
    s_sub_u32 s14, s14, s86
    s_lshl_b32 s86, s4, 2
    s_add_u32 s86, s86, s85
    s_mul_i32 s86, s86, 115
    s_add_u32 s86, s86, s15
    s_lshl_b32 s86, s86, 10
    s_and_b32 s85, s14, 3
    s_lshl_b32 s85, s85, 8
    s_add_u32 s86, s86, s85
    s_add_u32 s86, s86, s84
    v_add_u32 v188, s86, v46
    s_lshr_b32 s14, s14, 2
    s_lshl_b32 s14, s14, 6
    s_add_u32 s14, s14, w2_table-m_pc
    v_add_u32 v52, s14, v47
    s_mov_b32 s84, s24
    s_mov_b32 s85, s25
    s_mov_b32 s86, 0x1c2000
    s_mov_b32 s87, 0x00020000
    buffer_load_dwordx4 a[16:19], v48, s[84:87], 0 offen
    buffer_load_dwordx4 a[20:23], v48, s[84:87], 0 offen offset:16
    buffer_load_dword a24, v48, s[84:87], 0 offen offset:32
    s_mov_b32 s84, s32
    s_mov_b32 s85, s33
    s_mov_b32 s86, 0x1c2000
    s_mov_b32 s87, 0x00020000
    buffer_load_dwordx4 a[26:29], v48, s[84:87], 0 offen
    buffer_load_dwordx4 a[30:33], v48, s[84:87], 0 offen offset:16
    buffer_load_dword a34, v48, s[84:87], 0 offen offset:32
    global_load_dwordx4 v[192:195], v52, s[88:89]
    s_lshl_b32 s10, s4, 2
    s_add_u32 s10, s10, s3
    s_mul_i32 s10, s10, 117760
    v_add_u32 v1, 4096, v11
    s_mul_i32 s12, s5, 40
    s_mul_i32 s11, s3, 10
    s_add_u32 s12, s12, s11
    s_lshl_b32 s12, s12, 16
    s_lshl_b32 s11, s6, 10
    s_add_u32 s65, s12, s11
    s_add_u32 s66, s65, 1024
    s_cmp_eq_u32 s6, 0
    s_cselect_b32 s11, 0, 1024
    s_sub_u32 s64, s65, s11
    s_cmp_eq_u32 s6, 62
    s_cselect_b32 s11, 0, 1024
    s_add_u32 s67, s66, s11
    s_add_u32 s13, s49, s4
    s_lshl_b32 s13, s13, 7
    s_add_u32 s15, s49, s3
    s_lshl_b32 s15, s15, 7
    v_and_b32 v248, 1, v2
    v_lshlrev_b32 v248, 15, v248
    v_add_u32 v248, s15, v248
    v_bfe_u32 v6, v2, 1, 2
    s_min_u32 s15, s6, 1
    s_mul_i32 s15, s15, -512
    v_and_b32 v9, 1, v6
    v_mad_i32_i24 v248, v9, s15, v248
    s_min_u32 s15, s6, 61
    s_sub_u32 s15, s15, s6
    s_add_u32 s15, s15, 1
    s_lshl_b32 s15, s15, 9
    v_lshrrev_b32 v9, 1, v6
    v_mad_i32_i24 v248, v9, s15, v248
    s_lshl_b32 s14, s49, 4
    s_add_u32 s14, s14, 131008
    v_add_u32 v249, s14, v11
    v_lshrrev_b32 v220, 5, v2
    v_lshlrev_b32 v220, 9, v220
    v_bfe_u32 v9, v2, 2, 2
    v_lshl_add_u32 v220, v9, 6, v220
    v_bfe_u32 v9, v2, 4, 1
    v_lshl_add_u32 v220, v9, 5, v220
    v_lshl_add_u32 v220, v4, 3, v220
    v_add_u32 v220, s8, v220
    v_mov_b32 v221, 0x3f803f80
    v_mov_b32 v222, 0
    s_lshr_b32 s14, s6, 1
    s_mul_i32 s14, s14, 3
    s_add_u32 s14, s14, s3
    s_max_u32 s14, s14, 1
    s_sub_u32 s50, s14, 1
    s_mul_i32 s14, s50, 12
    v_add_u32 v53, s14, v28
    v_mul_u32_u24 v54, 640, v53
    v_add_u32 v54, v54, v46
    s_mul_i32 s15, s4, 160
    v_add_u32 v54, s15, v54
    v_mov_b32 v55, 0x7fff0000
    v_cmp_gt_u32 vcc, 10, v7
    s_nop 1
    v_cndmask_b32 v54, v55, v54, vcc
    s_mul_i32 s15, s5, 2304
    v_lshl_add_u32 v53, v53, 1, s15
    v_mov_b32 v9, 40864
    ds_write_b32 v9, v0
    v_lshrrev_b32 v84, 3, v2
    v_mul_u32_u24 v84, 4352, v84
    v_bfe_u32 v85, v2, 1, 2
    v_mul_u32_u24 v85, 1056, v85
    v_and_b32 v86, 1, v2
    v_mul_u32_u24 v86, 1040, v86
    v_add3_u32 v84, v84, v85, v86
    v_add_u32 v84, s8, v84
    v_mov_b32 v168, 0
    v_mov_b32 v169, 0
    v_mov_b32 v170, 0
    v_mov_b32 v171, 0
    ds_write_b128 v84, v[168:171]
    v_and_b32 v84, 15, v2
    v_lshrrev_b32 v85, 4, v2
    v_lshlrev_b32 v84, 4, v84
    v_add_u32 v84, s8, v84
    v_mul_u32_u24 v86, 4352, v85
    v_add_u32 v84, v84, v86
    v_lshrrev_b32 v85, 1, v85
    v_mul_i32_i24 v13, -7648, v85
    v_mul_i32_i24 v14, -1056, v85
    v_lshlrev_b32 v15, 4, v85
    s_xor_b32 s14, s3, 3
    s_bfe_u32 s15, s14, 0x10001
    s_and_b32 s14, s14, 1
    s_mul_i32 s15, s15, 1056
    s_lshl_b32 s14, s14, 9
    s_add_u32 s14, s14, s15
    v_add_u32 v16, s14, v84
    s_xor_b32 s14, s3, 2
    s_bfe_u32 s15, s14, 0x10001
    s_and_b32 s14, s14, 1
    s_mul_i32 s15, s15, 1056
    s_lshl_b32 s14, s14, 9
    s_add_u32 s14, s14, s15
    v_add_u32 v17, s14, v84
    s_xor_b32 s14, s3, 1
    s_bfe_u32 s15, s14, 0x10001
    s_and_b32 s14, s14, 1
    s_mul_i32 s15, s15, 1056
    s_lshl_b32 s14, s14, 9
    s_add_u32 s14, s14, s15
    v_add_u32 v18, s14, v84
    s_xor_b32 s14, s3, 0
    s_bfe_u32 s15, s14, 0x10001
    s_and_b32 s14, s14, 1
    s_mul_i32 s15, s15, 1056
    s_lshl_b32 s14, s14, 9
    s_add_u32 s14, s14, s15
    v_add_u32 v19, s14, v84
    s_add_u32 s14, s8, 8704
    v_add_u32 v20, s14, v11
    s_xor_b32 s14, s3, 3
    s_mul_i32 s14, s14, 40960
    s_add_u32 s14, s14, 8704
    v_add_u32 v21, s14, v11
    s_xor_b32 s14, s3, 2
    s_mul_i32 s14, s14, 40960
    s_add_u32 s14, s14, 18944
    v_add_u32 v22, s14, v11
    s_xor_b32 s14, s3, 1
    s_mul_i32 s14, s14, 40960
    s_add_u32 s14, s14, 29184
    v_add_u32 v23, s14, v11
    s_max_u32 s14, s6, 1
    s_sub_u32 s14, s14, s6
    s_mul_i32 s14, s14, 0x7fff0000
    v_add_u32 v4, s14, v11
    s_min_u32 s14, s6, 61
    s_sub_u32 s14, s6, s14
    s_mul_i32 s14, s14, 0x7fff0000
    v_add_u32 v5, s14, v11
    v_lshrrev_b32 v3, 4, v2
    s_mul_i32 s14, s4, 80
    v_lshl_add_u32 v3, v3, 2, s14
    v_lshlrev_b32 v12, 1, v3
    s_mul_i32 s14, s5, 320
    v_add_u32 v3, s14, v3
    v_lshlrev_b32 v3, 2, v3
    v_lshrrev_b32 v9, 5, v2
    v_lshlrev_b32 v9, 16, v9
    v_and_b32 v84, 31, v2
    v_lshl_add_u32 v9, v84, 4, v9
    s_mul_i32 s14, s5, 40
    s_mul_i32 s15, s4, 10
    s_add_u32 s14, s14, s15
    s_lshl_b32 s14, s14, 16
    s_lshl_b32 s15, s6, 10
    s_add_u32 s14, s14, s15
    s_lshl_b32 s15, s3, 9
    s_add_u32 s14, s14, s15
    v_add_u32 v9, s14, v9
    s_waitcnt vmcnt(11)
    ds_read_b64_tr_b16 v[64:65], v220 offset:34816
    ds_read_b64_tr_b16 v[66:67], v220 offset:35072
    ds_read_b64_tr_b16 v[68:69], v220 offset:35840
    ds_read_b64_tr_b16 v[70:71], v220 offset:36096
    ds_read_b64_tr_b16 v[72:73], v220 offset:36864
    ds_read_b64_tr_b16 v[74:75], v220 offset:37120
    ds_read_b64_tr_b16 v[76:77], v220 offset:37888
    ds_read_b64_tr_b16 v[78:79], v220 offset:38144
    ds_read_b64_tr_b16 v[80:81], v220 offset:38912
    ds_read_b64_tr_b16 v[82:83], v220 offset:39168
    v_mov_b32 v6, 0
    s_waitcnt lgkmcnt(8)
    v_dot2_f32_bf16 v6, v64, v221, v6
    v_dot2_f32_bf16 v222, v64, v64, v222
    v_dot2_f32_bf16 v6, v65, v221, v6
    v_dot2_f32_bf16 v222, v65, v65, v222
    v_dot2_f32_bf16 v6, v66, v221, v6
    v_dot2_f32_bf16 v222, v66, v66, v222
    v_dot2_f32_bf16 v6, v67, v221, v6
    v_dot2_f32_bf16 v222, v67, v67, v222
    s_waitcnt lgkmcnt(6)
    v_dot2_f32_bf16 v6, v68, v221, v6
    v_dot2_f32_bf16 v222, v68, v68, v222
    v_dot2_f32_bf16 v6, v69, v221, v6
    v_dot2_f32_bf16 v222, v69, v69, v222
    v_dot2_f32_bf16 v6, v70, v221, v6
    v_dot2_f32_bf16 v222, v70, v70, v222
    v_dot2_f32_bf16 v6, v71, v221, v6
    v_dot2_f32_bf16 v222, v71, v71, v222
    s_waitcnt lgkmcnt(4)
    v_dot2_f32_bf16 v6, v72, v221, v6
    v_dot2_f32_bf16 v222, v72, v72, v222
    v_dot2_f32_bf16 v6, v73, v221, v6
    v_dot2_f32_bf16 v222, v73, v73, v222
    v_dot2_f32_bf16 v6, v74, v221, v6
    v_dot2_f32_bf16 v222, v74, v74, v222
    v_dot2_f32_bf16 v6, v75, v221, v6
    v_dot2_f32_bf16 v222, v75, v75, v222
    s_waitcnt lgkmcnt(2)
    v_dot2_f32_bf16 v6, v76, v221, v6
    v_dot2_f32_bf16 v222, v76, v76, v222
    v_dot2_f32_bf16 v6, v77, v221, v6
    v_dot2_f32_bf16 v222, v77, v77, v222
    v_dot2_f32_bf16 v6, v78, v221, v6
    v_dot2_f32_bf16 v222, v78, v78, v222
    v_dot2_f32_bf16 v6, v79, v221, v6
    v_dot2_f32_bf16 v222, v79, v79, v222
    s_waitcnt lgkmcnt(0)
    v_dot2_f32_bf16 v6, v80, v221, v6
    v_dot2_f32_bf16 v222, v80, v80, v222
    v_dot2_f32_bf16 v6, v81, v221, v6
    v_dot2_f32_bf16 v222, v81, v81, v222
    v_dot2_f32_bf16 v6, v82, v221, v6
    v_dot2_f32_bf16 v222, v82, v82, v222
    v_dot2_f32_bf16 v6, v83, v221, v6
    v_dot2_f32_bf16 v222, v83, v83, v222
    s_nop 2
    v_mov_b32 v7, v222
    v_add_f32_dpp v6, v6, v6 row_shr:1 row_mask:0xf bank_mask:0xf bound_ctrl:0
    s_nop 0
    v_add_f32_dpp v7, v7, v7 row_shr:1 row_mask:0xf bank_mask:0xf bound_ctrl:0
    v_add_f32_dpp v6, v6, v6 row_shr:2 row_mask:0xf bank_mask:0xf bound_ctrl:0
    s_nop 0
    v_add_f32_dpp v7, v7, v7 row_shr:2 row_mask:0xf bank_mask:0xf bound_ctrl:0
    v_add_f32_dpp v6, v6, v6 row_shr:4 row_mask:0xf bank_mask:0xf bound_ctrl:0
    s_nop 0
    v_add_f32_dpp v7, v7, v7 row_shr:4 row_mask:0xf bank_mask:0xf bound_ctrl:0
    v_add_f32_dpp v6, v6, v6 row_shr:8 row_mask:0xf bank_mask:0xf bound_ctrl:0
    s_nop 0
    v_add_f32_dpp v7, v7, v7 row_shr:8 row_mask:0xf bank_mask:0xf bound_ctrl:0
    v_add_f32_dpp v6, v6, v6 row_bcast:15 row_mask:0xa bank_mask:0xf
    s_nop 0
    v_add_f32_dpp v7, v7, v7 row_bcast:15 row_mask:0xa bank_mask:0xf
    v_add_f32_dpp v6, v6, v6 row_bcast:31 row_mask:0xc bank_mask:0xf
    s_nop 0
    v_add_f32_dpp v7, v7, v7 row_bcast:31 row_mask:0xc bank_mask:0xf
    s_lshl_b32 s11, s3, 3
    s_add_u32 s11, s11, 40704
    v_mov_b32 v222, s11
    s_mov_b32 exec_lo, 0
    s_mov_b32 exec_hi, 0x80000000
    ds_write_b64 v222, v[6:7]
    s_mov_b64 exec, -1
    s_waitcnt vmcnt(7)
    s_getreg_b32 s9, hwreg(HW_REG_XCC_ID)
    v_readfirstlane_b32 s7, v246
    s_and_b32 s9, s9, 15
    s_add_u32 s7, s7, 0x9e3779b1
    s_add_u32 s9, s9, s7
    s_add_u32 s9, s9, 16
    v_mov_b32 v10, s7
    s_waitcnt lgkmcnt(0)
    s_barrier
    s_cmp_lg_u32 s3, 0
    s_cbranch_scc1 m_np
    v_mov_b32 v6, 0
    v_mov_b32 v7, 0
    v_lshlrev_b32 v222, 3, v2
    s_mov_b64 exec, 0xf
    ds_read_b64 v[6:7], v222 offset:40704
    s_mov_b64 exec, -1
    v_add_u32 v205, 0x9e3779b1, v244
    v_add_u32 v207, 0x7f4a7c15, v245
    s_lshl_b32 s14, s6, 3
    s_waitcnt lgkmcnt(0)
    v_add_f32_dpp v6, v6, v6 row_shr:1 row_mask:0xf bank_mask:0xf bound_ctrl:0
    v_add_f32_dpp v7, v7, v7 row_shr:1 row_mask:0xf bank_mask:0xf bound_ctrl:0
    s_nop 0
    v_add_f32_dpp v6, v6, v6 row_shr:2 row_mask:0xf bank_mask:0xf bound_ctrl:0
    v_add_f32_dpp v7, v7, v7 row_shr:2 row_mask:0xf bank_mask:0xf bound_ctrl:0
    v_mov_b32 v204, v6
    v_mov_b32 v206, v7
    s_mov_b64 exec, 8
    buffer_store_dwordx4 v[204:207], v0, s[96:99], s14 offen sc1
    s_mov_b64 exec, 1
    s_lshr_b32 s14, s13, 3
    s_add_u32 s14, s14, 0x20000
    v_mov_b32 v222, s9
    buffer_store_dword v222, v0, s[92:95], s14 offen sc1
    s_mov_b64 exec, -1
    s_branch m_np2
m_np:
    s_mov_b32 s60, s26
    s_mov_b32 s61, s27
    s_mov_b32 s62, 0xb4000
    s_mov_b32 s63, 0x00020000
    s_mov_b32 s56, s18
    s_mov_b32 s57, s19
    s_mov_b32 s58, 0x1200
    s_mov_b32 s59, 0x00020000
    buffer_load_ushort a12, v53, s[56:59], 0 offen offset:0
    buffer_load_ushort a13, v53, s[56:59], 0 offen offset:8
    buffer_load_ushort a14, v53, s[56:59], 0 offen offset:16
    s_mov_b32 s14, 5120
    buffer_load_dwordx4 a[0:3], v54, s[60:63], 0 offen
    buffer_load_dwordx4 a[4:7], v54, s[60:63], 0 offen offset:2560
    buffer_load_dwordx4 a[8:11], v54, s[60:63], s14 offen
m_np2:
    s_mov_b32 s90, 0x07060100
    s_mov_b32 s91, 0x05040302
    s_cmp_lg_u32 s3, 0
    s_cbranch_scc1 m_w6
    s_waitcnt vmcnt(2)
m_w6:
    s_waitcnt vmcnt(6)
    v_accvgpr_read_b32 v148, a16
    v_accvgpr_read_b32 v149, a17
    v_accvgpr_read_b32 v150, a18
    v_accvgpr_read_b32 v151, a19
    v_accvgpr_read_b32 v152, a20
    v_accvgpr_read_b32 v153, a21
    v_accvgpr_read_b32 v154, a22
    v_accvgpr_read_b32 v155, a23
    v_accvgpr_read_b32 v156, a24
    v_accvgpr_read_b32 v158, a26
    v_accvgpr_read_b32 v159, a27
    v_accvgpr_read_b32 v160, a28
    v_accvgpr_read_b32 v161, a29
    v_accvgpr_read_b32 v162, a30
    v_accvgpr_read_b32 v163, a31
    v_accvgpr_read_b32 v164, a32
    v_accvgpr_read_b32 v165, a33
    v_accvgpr_read_b32 v166, a34
    v_perm_b32 v224, v152, v148, s90
    v_perm_b32 v225, v153, v148, s91
    v_perm_b32 v226, v153, v149, s90
    v_perm_b32 v227, v154, v149, s91
    v_perm_b32 v228, v154, v150, s90
    v_perm_b32 v229, v155, v150, s91
    v_perm_b32 v230, v155, v151, s90
    v_perm_b32 v231, v156, v151, s91
    v_perm_b32 v240, v156, v152, s90
    v_perm_b32 v232, v162, v158, s90
    v_perm_b32 v233, v163, v158, s91
    v_perm_b32 v234, v163, v159, s90
    v_perm_b32 v235, v164, v159, s91
    v_perm_b32 v236, v164, v160, s90
    v_perm_b32 v237, v165, v160, s91
    v_perm_b32 v238, v165, v161, s90
    v_perm_b32 v239, v166, v161, s91
    v_perm_b32 v241, v166, v162, s90
    v_mov_b32 v242, 0
    v_mov_b32 v243, 0
    v_permlane32_swap_b32 v224, v226
    v_permlane32_swap_b32 v225, v227
    v_permlane32_swap_b32 v228, v230
    v_permlane32_swap_b32 v229, v231
    v_permlane32_swap_b32 v232, v234
    v_permlane32_swap_b32 v233, v235
    v_permlane32_swap_b32 v236, v238
    v_permlane32_swap_b32 v237, v239
    v_permlane32_swap_b32 v240, v242
    v_permlane32_swap_b32 v241, v243
    v_add_u32 v192, v192, v188
    v_add_u32 v193, v193, v188
    v_add_u32 v194, v194, v188
    v_bfe_u32 v222, v2, 4, 1
    v_lshlrev_b32 v222, 21, v222
    v_add_u32 v194, v194, v222
    v_permlane16_swap_b32 v224, v225
    v_permlane16_swap_b32 v226, v227
    v_permlane16_swap_b32 v228, v229
    v_permlane16_swap_b32 v230, v231
    v_permlane16_swap_b32 v232, v233
    v_permlane16_swap_b32 v234, v235
    v_permlane16_swap_b32 v236, v237
    v_permlane16_swap_b32 v238, v239
    v_permlane16_swap_b32 v240, v241
    v_permlane16_swap_b32 v242, v243
    s_mov_b32 s84, s38
    s_mov_b32 s85, s39
    s_mov_b32 s86, 0x3cc000
    s_mov_b32 s87, 0x00020000
    s_mov_b32 s14, 0x200000
    buffer_store_dwordx4 v[224:227], v192, s[84:87], 0 offen sc1
    buffer_store_dwordx4 v[228:231], v193, s[84:87], 0 offen sc1
    buffer_store_dwordx4 v[240:243], v194, s[84:87], 0 offen sc1
    buffer_store_dwordx4 v[232:235], v192, s[84:87], s14 offen sc1
    buffer_store_dwordx4 v[236:239], v193, s[84:87], s14 offen sc1
    v_lshrrev_b32 v223, 5, v2
    v_lshlrev_b32 v223, 4, v223
    v_add_u32 v223, s8, v223
    ds_read_b128 v[88:91], v223 offset:39936
    ds_read_b128 v[128:131], v223 offset:40192
    ds_read_b128 v[92:95], v223 offset:39968
    ds_read_b128 v[132:135], v223 offset:40224
    ds_read_b128 v[96:99], v223 offset:40000
    ds_read_b128 v[136:139], v223 offset:40256
    ds_read_b128 v[100:103], v223 offset:40032
    ds_read_b128 v[140:143], v223 offset:40288
    ds_read_b128 v[104:107], v223 offset:40064
    ds_read_b128 v[144:147], v223 offset:40320
    s_mov_b32 s58, 0xbfb8aa3b
    s_mov_b32 s59, 0xbfb8aa3b
    v_lshlrev_b32 v108, 16, v64
    v_and_b32 v109, 0xffff0000, v64
    v_lshlrev_b32 v110, 16, v65
    v_and_b32 v111, 0xffff0000, v65
    v_lshlrev_b32 v112, 16, v66
    v_and_b32 v113, 0xffff0000, v66
    v_lshlrev_b32 v114, 16, v67
    v_and_b32 v115, 0xffff0000, v67
    v_lshlrev_b32 v116, 16, v68
    v_and_b32 v117, 0xffff0000, v68
    v_lshlrev_b32 v118, 16, v69
    v_and_b32 v119, 0xffff0000, v69
    v_lshlrev_b32 v120, 16, v70
    v_and_b32 v121, 0xffff0000, v70
    v_lshlrev_b32 v122, 16, v71
    v_and_b32 v123, 0xffff0000, v71
    v_lshlrev_b32 v124, 16, v72
    v_and_b32 v125, 0xffff0000, v72
    v_lshlrev_b32 v126, 16, v73
    v_and_b32 v127, 0xffff0000, v73
    s_waitcnt lgkmcnt(0)
    v_lshlrev_b32 v24, 16, v88
    v_and_b32 v25, 0xffff0000, v88
    v_lshlrev_b32 v148, 16, v128
    v_and_b32 v149, 0xffff0000, v128
    v_lshlrev_b32 v26, 16, v89
    v_and_b32 v27, 0xffff0000, v89
    v_lshlrev_b32 v150, 16, v129
    v_and_b32 v151, 0xffff0000, v129
    v_lshlrev_b32 v28, 16, v90
    v_and_b32 v29, 0xffff0000, v90
    v_lshlrev_b32 v152, 16, v130
    v_and_b32 v153, 0xffff0000, v130
    v_lshlrev_b32 v30, 16, v91
    v_and_b32 v31, 0xffff0000, v91
    v_lshlrev_b32 v154, 16, v131
    v_and_b32 v155, 0xffff0000, v131
    v_lshlrev_b32 v32, 16, v92
    v_and_b32 v33, 0xffff0000, v92
    v_lshlrev_b32 v156, 16, v132
    v_and_b32 v157, 0xffff0000, v132
    v_lshlrev_b32 v34, 16, v93
    v_and_b32 v35, 0xffff0000, v93
    v_lshlrev_b32 v158, 16, v133
    v_and_b32 v159, 0xffff0000, v133
    v_lshlrev_b32 v36, 16, v94
    v_and_b32 v37, 0xffff0000, v94
    v_lshlrev_b32 v160, 16, v134
    v_and_b32 v161, 0xffff0000, v134
    v_lshlrev_b32 v38, 16, v95
    v_and_b32 v39, 0xffff0000, v95
    v_lshlrev_b32 v162, 16, v135
    v_and_b32 v163, 0xffff0000, v135
    v_lshlrev_b32 v40, 16, v96
    v_and_b32 v41, 0xffff0000, v96
    v_lshlrev_b32 v164, 16, v136
    v_and_b32 v165, 0xffff0000, v136
    v_lshlrev_b32 v42, 16, v97
    v_and_b32 v43, 0xffff0000, v97
    v_lshlrev_b32 v166, 16, v137
    v_and_b32 v167, 0xffff0000, v137
    v_lshlrev_b32 v44, 16, v98
    v_and_b32 v45, 0xffff0000, v98
    v_lshlrev_b32 v168, 16, v138
    v_and_b32 v169, 0xffff0000, v138
    v_lshlrev_b32 v46, 16, v99
    v_and_b32 v47, 0xffff0000, v99
    v_lshlrev_b32 v170, 16, v139
    v_and_b32 v171, 0xffff0000, v139
    v_lshlrev_b32 v48, 16, v100
    v_and_b32 v49, 0xffff0000, v100
    v_lshlrev_b32 v172, 16, v140
    v_and_b32 v173, 0xffff0000, v140
    v_lshlrev_b32 v50, 16, v101
    v_and_b32 v51, 0xffff0000, v101
    v_lshlrev_b32 v174, 16, v141
    v_and_b32 v175, 0xffff0000, v141
    v_lshlrev_b32 v52, 16, v102
    v_and_b32 v53, 0xffff0000, v102
    v_lshlrev_b32 v176, 16, v142
    v_and_b32 v177, 0xffff0000, v142
    v_lshlrev_b32 v54, 16, v103
    v_and_b32 v55, 0xffff0000, v103
    v_lshlrev_b32 v178, 16, v143
    v_and_b32 v179, 0xffff0000, v143
    v_lshlrev_b32 v56, 16, v104
    v_and_b32 v57, 0xffff0000, v104
    v_lshlrev_b32 v180, 16, v144
    v_and_b32 v181, 0xffff0000, v144
    v_lshlrev_b32 v58, 16, v105
    v_and_b32 v59, 0xffff0000, v105
    v_lshlrev_b32 v182, 16, v145
    v_and_b32 v183, 0xffff0000, v145
    v_lshlrev_b32 v60, 16, v106
    v_and_b32 v61, 0xffff0000, v106
    v_lshlrev_b32 v184, 16, v146
    v_and_b32 v185, 0xffff0000, v146
    v_lshlrev_b32 v62, 16, v107
    v_and_b32 v63, 0xffff0000, v107
    v_lshlrev_b32 v186, 16, v147
    v_and_b32 v187, 0xffff0000, v147
    v_lshlrev_b32 v128, 16, v74
    v_and_b32 v129, 0xffff0000, v74
    v_lshlrev_b32 v130, 16, v75
    v_and_b32 v131, 0xffff0000, v75
    v_lshlrev_b32 v132, 16, v76
    v_and_b32 v133, 0xffff0000, v76
    v_lshlrev_b32 v134, 16, v77
    v_and_b32 v135, 0xffff0000, v77
    v_lshlrev_b32 v136, 16, v78
    v_and_b32 v137, 0xffff0000, v78
    v_lshlrev_b32 v138, 16, v79
    v_and_b32 v139, 0xffff0000, v79
    v_lshlrev_b32 v140, 16, v80
    v_and_b32 v141, 0xffff0000, v80
    v_lshlrev_b32 v142, 16, v81
    v_and_b32 v143, 0xffff0000, v81
    v_lshlrev_b32 v144, 16, v82
    v_and_b32 v145, 0xffff0000, v82
    v_lshlrev_b32 v146, 16, v83
    v_and_b32 v147, 0xffff0000, v83
    s_cmp_lg_u32 s3, 0
    s_cbranch_scc1 m_nq
    s_mov_b32 exec_hi, 0
    buffer_load_dwordx4 v[212:215], v11, s[96:99], 0 offen sc1
    s_mov_b64 exec, -1
m_nq:
    v_pk_mul_f32 v[24:25], v[24:25], s[58:59]
    v_pk_mul_f32 v[148:149], v[148:149], s[58:59]
    v_pk_mul_f32 v[108:109], v[108:109], v[24:25]
    v_pk_mul_f32 v[26:27], v[26:27], s[58:59]
    v_pk_mul_f32 v[150:151], v[150:151], s[58:59]
    v_pk_mul_f32 v[110:111], v[110:111], v[26:27]
    v_pk_mul_f32 v[28:29], v[28:29], s[58:59]
    v_pk_mul_f32 v[152:153], v[152:153], s[58:59]
    v_pk_mul_f32 v[112:113], v[112:113], v[28:29]
    v_pk_mul_f32 v[30:31], v[30:31], s[58:59]
    v_pk_mul_f32 v[154:155], v[154:155], s[58:59]
    v_pk_mul_f32 v[114:115], v[114:115], v[30:31]
    v_pk_mul_f32 v[32:33], v[32:33], s[58:59]
    v_pk_mul_f32 v[156:157], v[156:157], s[58:59]
    v_pk_mul_f32 v[116:117], v[116:117], v[32:33]
    v_pk_mul_f32 v[34:35], v[34:35], s[58:59]
    v_pk_mul_f32 v[158:159], v[158:159], s[58:59]
    v_pk_mul_f32 v[118:119], v[118:119], v[34:35]
    v_pk_mul_f32 v[36:37], v[36:37], s[58:59]
    v_pk_mul_f32 v[160:161], v[160:161], s[58:59]
    v_pk_mul_f32 v[120:121], v[120:121], v[36:37]
    v_pk_mul_f32 v[38:39], v[38:39], s[58:59]
    v_pk_mul_f32 v[162:163], v[162:163], s[58:59]
    v_pk_mul_f32 v[122:123], v[122:123], v[38:39]
    v_pk_mul_f32 v[40:41], v[40:41], s[58:59]
    v_pk_mul_f32 v[164:165], v[164:165], s[58:59]
    v_pk_mul_f32 v[124:125], v[124:125], v[40:41]
    v_pk_mul_f32 v[42:43], v[42:43], s[58:59]
    v_pk_mul_f32 v[166:167], v[166:167], s[58:59]
    v_pk_mul_f32 v[126:127], v[126:127], v[42:43]
    v_pk_mul_f32 v[44:45], v[44:45], s[58:59]
    v_pk_mul_f32 v[168:169], v[168:169], s[58:59]
    v_pk_mul_f32 v[128:129], v[128:129], v[44:45]
    v_pk_mul_f32 v[46:47], v[46:47], s[58:59]
    v_pk_mul_f32 v[170:171], v[170:171], s[58:59]
    v_pk_mul_f32 v[130:131], v[130:131], v[46:47]
    v_pk_mul_f32 v[48:49], v[48:49], s[58:59]
    v_pk_mul_f32 v[172:173], v[172:173], s[58:59]
    v_pk_mul_f32 v[132:133], v[132:133], v[48:49]
    v_pk_mul_f32 v[50:51], v[50:51], s[58:59]
    v_pk_mul_f32 v[174:175], v[174:175], s[58:59]
    v_pk_mul_f32 v[134:135], v[134:135], v[50:51]
    v_pk_mul_f32 v[52:53], v[52:53], s[58:59]
    v_pk_mul_f32 v[176:177], v[176:177], s[58:59]
    v_pk_mul_f32 v[136:137], v[136:137], v[52:53]
    v_pk_mul_f32 v[54:55], v[54:55], s[58:59]
    v_pk_mul_f32 v[178:179], v[178:179], s[58:59]
    v_pk_mul_f32 v[138:139], v[138:139], v[54:55]
    v_pk_mul_f32 v[56:57], v[56:57], s[58:59]
    v_pk_mul_f32 v[180:181], v[180:181], s[58:59]
    v_pk_mul_f32 v[140:141], v[140:141], v[56:57]
    v_pk_mul_f32 v[58:59], v[58:59], s[58:59]
    v_pk_mul_f32 v[182:183], v[182:183], s[58:59]
    v_pk_mul_f32 v[142:143], v[142:143], v[58:59]
    v_pk_mul_f32 v[60:61], v[60:61], s[58:59]
    v_pk_mul_f32 v[184:185], v[184:185], s[58:59]
    v_pk_mul_f32 v[144:145], v[144:145], v[60:61]
    v_pk_mul_f32 v[62:63], v[62:63], s[58:59]
    v_pk_mul_f32 v[186:187], v[186:187], s[58:59]
    v_pk_mul_f32 v[146:147], v[146:147], v[62:63]
    s_lshl_b32 s63, s4, 10
    s_add_u32 s63, s63, 0x22000
    v_mov_b32 v84, 40864
    v_mov_b32 v85, 1
    s_waitcnt vmcnt(0)
    s_mov_b64 exec, 1
    ds_add_rtn_u32 v86, v84, v85
    s_lshl_b32 s14, s49, 2
    s_add_u32 s14, s14, s63
    s_waitcnt lgkmcnt(0)
    v_readfirstlane_b32 s15, v86
    s_nop 0
    s_cmp_lg_u32 s15, 3
    s_cbranch_scc1 m_nowf
    buffer_store_dword v10, v0, s[92:95], s14 offen sc1
m_nowf:
    s_mov_b64 exec, -1
    s_cmp_lg_u32 s3, 0
    s_cbranch_scc1 m_wait2
    s_mov_b32 exec_hi, 0
    s_mov_b32 s55, 0
m0_poll:
    v_cmp_eq_u32 vcc, v213, v205
    v_cmp_eq_u32 s[52:53], v215, v207
    s_add_u32 s55, s55, 1
    s_and_b32 s52, s52, vcc_lo
    s_cmp_eq_u32 s52, -1
    s_cbranch_scc1 m0_done
    s_cmp_ge_u32 s55, 0x40000
    s_cbranch_scc1 m0_done
    buffer_load_dwordx4 v[212:215], v11, s[96:99], 0 offen sc1
    s_waitcnt vmcnt(0)
    s_branch m0_poll
m0_done:
    s_mov_b64 exec, -1
    v_add_f32_dpp v212, v212, v212 row_shr:1 row_mask:0xf bank_mask:0xf bound_ctrl:0
    v_add_f32_dpp v214, v214, v214 row_shr:1 row_mask:0xf bank_mask:0xf bound_ctrl:0
    s_nop 0
    v_add_f32_dpp v212, v212, v212 row_shr:2 row_mask:0xf bank_mask:0xf bound_ctrl:0
    v_add_f32_dpp v214, v214, v214 row_shr:2 row_mask:0xf bank_mask:0xf bound_ctrl:0
    s_nop 0
    v_add_f32_dpp v212, v212, v212 row_shr:4 row_mask:0xf bank_mask:0xf bound_ctrl:0
    v_add_f32_dpp v214, v214, v214 row_shr:4 row_mask:0xf bank_mask:0xf bound_ctrl:0
    s_nop 0
    v_add_f32_dpp v212, v212, v212 row_shr:8 row_mask:0xf bank_mask:0xf bound_ctrl:0
    v_add_f32_dpp v214, v214, v214 row_shr:8 row_mask:0xf bank_mask:0xf bound_ctrl:0
    s_nop 0
    v_add_f32_dpp v212, v212, v212 row_bcast:15 row_mask:0xa bank_mask:0xf
    v_add_f32_dpp v214, v214, v214 row_bcast:15 row_mask:0xa bank_mask:0xf
    v_mul_f32 v212, 0x364ccccd, v212
    v_mul_f32 v213, 0x364ccccd, v214
    v_fma_f32 v213, -v212, v212, v213
    v_max_f32 v213, 0, v213
    v_add_f32 v213, 0x3727c5ac, v213
    v_rsq_f32 v213, v213
    v_mov_b32 v8, 40832
    s_mov_b32 exec_lo, 0x80000000
    s_mov_b32 exec_hi, 0
    ds_write_b64 v8, v[212:213]
    s_cmp_lg_u32 s6, 0
    s_cbranch_scc1 m0_noep
    v_mov_b32 v206, v205
    buffer_store_dwordx2 v[206:207], v0, s[96:99], 0 offen offset:1024 sc1
m0_noep:
    s_mov_b64 exec, -1
m_wait2:
    v_mov_b32 v8, 40832
    s_waitcnt lgkmcnt(0)
    s_barrier
    ds_read_b64 v[6:7], v8
    s_mov_b64 exec, 0xfff
    buffer_load_dword v249, v249, s[92:95], 0 offen sc1
    s_mov_b64 exec, -1
    s_mov_b32 s44, s38
    s_mov_b32 s45, s39
    s_mov_b32 s46, 0x1cc000
    s_mov_b32 s47, 0x00020000
    s_add_u32 s52, s38, 0x400000
    s_addc_u32 s53, s39, 0
    s_mov_b32 s54, 0x500000
    s_mov_b32 s55, 0x00020000
    s_waitcnt lgkmcnt(0)
    v_mul_f32 v6, v6, v7
    v_sub_f32 v6, 0, v6
    v_pk_fma_f32 v[148:149], v[24:25], v[6:7], v[148:149] op_sel_hi:[1,0,1]
    v_pk_fma_f32 v[150:151], v[26:27], v[6:7], v[150:151] op_sel_hi:[1,0,1]
    v_pk_fma_f32 v[152:153], v[28:29], v[6:7], v[152:153] op_sel_hi:[1,0,1]
    v_pk_fma_f32 v[154:155], v[30:31], v[6:7], v[154:155] op_sel_hi:[1,0,1]
    v_pk_fma_f32 v[108:109], v[108:109], v[6:7], v[148:149] op_sel:[0,1,0] op_sel_hi:[1,1,1]
    v_pk_fma_f32 v[110:111], v[110:111], v[6:7], v[150:151] op_sel:[0,1,0] op_sel_hi:[1,1,1]
    v_pk_fma_f32 v[112:113], v[112:113], v[6:7], v[152:153] op_sel:[0,1,0] op_sel_hi:[1,1,1]
    v_pk_fma_f32 v[114:115], v[114:115], v[6:7], v[154:155] op_sel:[0,1,0] op_sel_hi:[1,1,1]
    v_exp_f32 v64, v108
    v_exp_f32 v65, v109
    v_exp_f32 v66, v110
    v_exp_f32 v67, v111
    v_exp_f32 v68, v112
    v_exp_f32 v69, v113
    v_exp_f32 v70, v114
    v_exp_f32 v71, v115
    v_pk_fma_f32 v[64:65], v[64:65], s[58:59], s[58:59]
    v_pk_fma_f32 v[66:67], v[66:67], s[58:59], s[58:59]
    v_pk_fma_f32 v[68:69], v[68:69], s[58:59], s[58:59]
    v_pk_fma_f32 v[70:71], v[70:71], s[58:59], s[58:59]
    v_rcp_f32 v64, v64
    v_rcp_f32 v65, v65
    v_rcp_f32 v66, v66
    v_rcp_f32 v67, v67
    v_rcp_f32 v68, v68
    v_rcp_f32 v69, v69
    v_rcp_f32 v70, v70
    v_rcp_f32 v71, v71
    v_pk_mul_f32 v[108:109], v[108:109], v[64:65]
    v_cvt_pk_bf16_f32 v88, v108, v109
    v_pk_mul_f32 v[110:111], v[110:111], v[66:67]
    v_cvt_pk_bf16_f32 v89, v110, v111
    v_pk_mul_f32 v[112:113], v[112:113], v[68:69]
    v_cvt_pk_bf16_f32 v90, v112, v113
    v_pk_mul_f32 v[114:115], v[114:115], v[70:71]
    v_cvt_pk_bf16_f32 v91, v114, v115
    s_mov_b32 s14, 0
    buffer_store_dwordx4 v[88:91], v9, s[52:55], s14 offen sc1
    v_pk_fma_f32 v[156:157], v[32:33], v[6:7], v[156:157] op_sel_hi:[1,0,1]
    v_pk_fma_f32 v[158:159], v[34:35], v[6:7], v[158:159] op_sel_hi:[1,0,1]
    v_pk_fma_f32 v[160:161], v[36:37], v[6:7], v[160:161] op_sel_hi:[1,0,1]
    v_pk_fma_f32 v[162:163], v[38:39], v[6:7], v[162:163] op_sel_hi:[1,0,1]
    v_pk_fma_f32 v[116:117], v[116:117], v[6:7], v[156:157] op_sel:[0,1,0] op_sel_hi:[1,1,1]
    v_pk_fma_f32 v[118:119], v[118:119], v[6:7], v[158:159] op_sel:[0,1,0] op_sel_hi:[1,1,1]
    v_pk_fma_f32 v[120:121], v[120:121], v[6:7], v[160:161] op_sel:[0,1,0] op_sel_hi:[1,1,1]
    v_pk_fma_f32 v[122:123], v[122:123], v[6:7], v[162:163] op_sel:[0,1,0] op_sel_hi:[1,1,1]
    v_exp_f32 v72, v116
    v_exp_f32 v73, v117
    v_exp_f32 v74, v118
    v_exp_f32 v75, v119
    v_exp_f32 v76, v120
    v_exp_f32 v77, v121
    v_exp_f32 v78, v122
    v_exp_f32 v79, v123
    v_pk_fma_f32 v[72:73], v[72:73], s[58:59], s[58:59]
    v_pk_fma_f32 v[74:75], v[74:75], s[58:59], s[58:59]
    v_pk_fma_f32 v[76:77], v[76:77], s[58:59], s[58:59]
    v_pk_fma_f32 v[78:79], v[78:79], s[58:59], s[58:59]
    v_rcp_f32 v72, v72
    v_rcp_f32 v73, v73
    v_rcp_f32 v74, v74
    v_rcp_f32 v75, v75
    v_rcp_f32 v76, v76
    v_rcp_f32 v77, v77
    v_rcp_f32 v78, v78
    v_rcp_f32 v79, v79
    v_pk_mul_f32 v[116:117], v[116:117], v[72:73]
    v_cvt_pk_bf16_f32 v92, v116, v117
    v_pk_mul_f32 v[118:119], v[118:119], v[74:75]
    v_cvt_pk_bf16_f32 v93, v118, v119
    v_pk_mul_f32 v[120:121], v[120:121], v[76:77]
    v_cvt_pk_bf16_f32 v94, v120, v121
    v_pk_mul_f32 v[122:123], v[122:123], v[78:79]
    v_cvt_pk_bf16_f32 v95, v122, v123
    s_mov_b32 s14, 131072
    buffer_store_dwordx4 v[92:95], v9, s[52:55], s14 offen sc1
    v_pk_fma_f32 v[164:165], v[40:41], v[6:7], v[164:165] op_sel_hi:[1,0,1]
    v_pk_fma_f32 v[166:167], v[42:43], v[6:7], v[166:167] op_sel_hi:[1,0,1]
    v_pk_fma_f32 v[168:169], v[44:45], v[6:7], v[168:169] op_sel_hi:[1,0,1]
    v_pk_fma_f32 v[170:171], v[46:47], v[6:7], v[170:171] op_sel_hi:[1,0,1]
    v_pk_fma_f32 v[124:125], v[124:125], v[6:7], v[164:165] op_sel:[0,1,0] op_sel_hi:[1,1,1]
    v_pk_fma_f32 v[126:127], v[126:127], v[6:7], v[166:167] op_sel:[0,1,0] op_sel_hi:[1,1,1]
    v_pk_fma_f32 v[128:129], v[128:129], v[6:7], v[168:169] op_sel:[0,1,0] op_sel_hi:[1,1,1]
    v_pk_fma_f32 v[130:131], v[130:131], v[6:7], v[170:171] op_sel:[0,1,0] op_sel_hi:[1,1,1]
    v_exp_f32 v64, v124
    v_exp_f32 v65, v125
    v_exp_f32 v66, v126
    v_exp_f32 v67, v127
    v_exp_f32 v68, v128
    v_exp_f32 v69, v129
    v_exp_f32 v70, v130
    v_exp_f32 v71, v131
    v_pk_fma_f32 v[64:65], v[64:65], s[58:59], s[58:59]
    v_pk_fma_f32 v[66:67], v[66:67], s[58:59], s[58:59]
    v_pk_fma_f32 v[68:69], v[68:69], s[58:59], s[58:59]
    v_pk_fma_f32 v[70:71], v[70:71], s[58:59], s[58:59]
    v_rcp_f32 v64, v64
    v_rcp_f32 v65, v65
    v_rcp_f32 v66, v66
    v_rcp_f32 v67, v67
    v_rcp_f32 v68, v68
    v_rcp_f32 v69, v69
    v_rcp_f32 v70, v70
    v_rcp_f32 v71, v71
    v_pk_mul_f32 v[124:125], v[124:125], v[64:65]
    v_cvt_pk_bf16_f32 v96, v124, v125
    v_pk_mul_f32 v[126:127], v[126:127], v[66:67]
    v_cvt_pk_bf16_f32 v97, v126, v127
    v_pk_mul_f32 v[128:129], v[128:129], v[68:69]
    v_cvt_pk_bf16_f32 v98, v128, v129
    v_pk_mul_f32 v[130:131], v[130:131], v[70:71]
    v_cvt_pk_bf16_f32 v99, v130, v131
    s_mov_b32 s14, 262144
    buffer_store_dwordx4 v[96:99], v9, s[52:55], s14 offen sc1
    v_pk_fma_f32 v[172:173], v[48:49], v[6:7], v[172:173] op_sel_hi:[1,0,1]
    v_pk_fma_f32 v[174:175], v[50:51], v[6:7], v[174:175] op_sel_hi:[1,0,1]
    v_pk_fma_f32 v[176:177], v[52:53], v[6:7], v[176:177] op_sel_hi:[1,0,1]
    v_pk_fma_f32 v[178:179], v[54:55], v[6:7], v[178:179] op_sel_hi:[1,0,1]
    v_pk_fma_f32 v[132:133], v[132:133], v[6:7], v[172:173] op_sel:[0,1,0] op_sel_hi:[1,1,1]
    v_pk_fma_f32 v[134:135], v[134:135], v[6:7], v[174:175] op_sel:[0,1,0] op_sel_hi:[1,1,1]
    v_pk_fma_f32 v[136:137], v[136:137], v[6:7], v[176:177] op_sel:[0,1,0] op_sel_hi:[1,1,1]
    v_pk_fma_f32 v[138:139], v[138:139], v[6:7], v[178:179] op_sel:[0,1,0] op_sel_hi:[1,1,1]
    v_exp_f32 v72, v132
    v_exp_f32 v73, v133
    v_exp_f32 v74, v134
    v_exp_f32 v75, v135
    v_exp_f32 v76, v136
    v_exp_f32 v77, v137
    v_exp_f32 v78, v138
    v_exp_f32 v79, v139
    v_pk_fma_f32 v[72:73], v[72:73], s[58:59], s[58:59]
    v_pk_fma_f32 v[74:75], v[74:75], s[58:59], s[58:59]
    v_pk_fma_f32 v[76:77], v[76:77], s[58:59], s[58:59]
    v_pk_fma_f32 v[78:79], v[78:79], s[58:59], s[58:59]
    v_rcp_f32 v72, v72
    v_rcp_f32 v73, v73
    v_rcp_f32 v74, v74
    v_rcp_f32 v75, v75
    v_rcp_f32 v76, v76
    v_rcp_f32 v77, v77
    v_rcp_f32 v78, v78
    v_rcp_f32 v79, v79
    v_pk_mul_f32 v[132:133], v[132:133], v[72:73]
    v_cvt_pk_bf16_f32 v100, v132, v133
    v_pk_mul_f32 v[134:135], v[134:135], v[74:75]
    v_cvt_pk_bf16_f32 v101, v134, v135
    v_pk_mul_f32 v[136:137], v[136:137], v[76:77]
    v_cvt_pk_bf16_f32 v102, v136, v137
    v_pk_mul_f32 v[138:139], v[138:139], v[78:79]
    v_cvt_pk_bf16_f32 v103, v138, v139
    s_mov_b32 s14, 393216
    buffer_store_dwordx4 v[100:103], v9, s[52:55], s14 offen sc1
    v_pk_fma_f32 v[180:181], v[56:57], v[6:7], v[180:181] op_sel_hi:[1,0,1]
    v_pk_fma_f32 v[182:183], v[58:59], v[6:7], v[182:183] op_sel_hi:[1,0,1]
    v_pk_fma_f32 v[184:185], v[60:61], v[6:7], v[184:185] op_sel_hi:[1,0,1]
    v_pk_fma_f32 v[186:187], v[62:63], v[6:7], v[186:187] op_sel_hi:[1,0,1]
    v_pk_fma_f32 v[140:141], v[140:141], v[6:7], v[180:181] op_sel:[0,1,0] op_sel_hi:[1,1,1]
    v_pk_fma_f32 v[142:143], v[142:143], v[6:7], v[182:183] op_sel:[0,1,0] op_sel_hi:[1,1,1]
    v_pk_fma_f32 v[144:145], v[144:145], v[6:7], v[184:185] op_sel:[0,1,0] op_sel_hi:[1,1,1]
    v_pk_fma_f32 v[146:147], v[146:147], v[6:7], v[186:187] op_sel:[0,1,0] op_sel_hi:[1,1,1]
    v_exp_f32 v64, v140
    v_exp_f32 v65, v141
    v_exp_f32 v66, v142
    v_exp_f32 v67, v143
    v_exp_f32 v68, v144
    v_exp_f32 v69, v145
    v_exp_f32 v70, v146
    v_exp_f32 v71, v147
    v_pk_fma_f32 v[64:65], v[64:65], s[58:59], s[58:59]
    v_pk_fma_f32 v[66:67], v[66:67], s[58:59], s[58:59]
    v_pk_fma_f32 v[68:69], v[68:69], s[58:59], s[58:59]
    v_pk_fma_f32 v[70:71], v[70:71], s[58:59], s[58:59]
    v_rcp_f32 v64, v64
    v_rcp_f32 v65, v65
    v_rcp_f32 v66, v66
    v_rcp_f32 v67, v67
    v_rcp_f32 v68, v68
    v_rcp_f32 v69, v69
    v_rcp_f32 v70, v70
    v_rcp_f32 v71, v71
    v_pk_mul_f32 v[140:141], v[140:141], v[64:65]
    v_cvt_pk_bf16_f32 v104, v140, v141
    v_pk_mul_f32 v[142:143], v[142:143], v[66:67]
    v_cvt_pk_bf16_f32 v105, v142, v143
    v_pk_mul_f32 v[144:145], v[144:145], v[68:69]
    v_cvt_pk_bf16_f32 v106, v144, v145
    v_pk_mul_f32 v[146:147], v[146:147], v[70:71]
    v_cvt_pk_bf16_f32 v107, v146, v147
    s_mov_b32 s14, 524288
    buffer_store_dwordx4 v[104:107], v9, s[52:55], s14 offen sc1
    buffer_load_dword v196, v11, s[92:95], s63 offen sc1
    v_accvgpr_read_b32 v24, a12
    v_accvgpr_read_b32 v25, a13
    v_accvgpr_read_b32 v26, a14
    v_lshlrev_b32 v24, 16, v24
    v_lshlrev_b32 v25, 16, v25
    v_lshlrev_b32 v26, 16, v26
    v_mul_f32 v28, 0xbfb8aa3b, v24
    v_mul_f32 v29, 0xbfb8aa3b, v25
    v_mul_f32 v30, 0xbfb8aa3b, v26
    v_exp_f32 v28, v28
    v_exp_f32 v29, v29
    v_exp_f32 v30, v30
    v_add_f32 v28, 1.0, v28
    v_add_f32 v29, 1.0, v29
    v_add_f32 v30, 1.0, v30
    v_rcp_f32 v28, v28
    v_rcp_f32 v29, v29
    v_rcp_f32 v30, v30
    v_mul_f32 v24, v24, v28
    v_mul_f32 v25, v25, v29
    v_mul_f32 v26, v26, v30
    v_cvt_pk_bf16_f32 v24, v24, v24
    v_cvt_pk_bf16_f32 v25, v25, v25
    v_cvt_pk_bf16_f32 v26, v26, v26
    v_lshlrev_b32 v24, 16, v24
    v_lshlrev_b32 v25, 16, v25
    v_lshlrev_b32 v26, 16, v26
    v_accvgpr_read_b32 v29, a0
    v_lshlrev_b32 v28, 16, v29
    v_and_b32 v29, 0xffff0000, v29
    v_mul_f32 v32, v24, v28
    v_mul_f32 v33, v24, v29
    v_accvgpr_read_b32 v29, a1
    v_lshlrev_b32 v28, 16, v29
    v_and_b32 v29, 0xffff0000, v29
    v_mul_f32 v34, v24, v28
    v_mul_f32 v35, v24, v29
    v_accvgpr_read_b32 v29, a2
    v_lshlrev_b32 v28, 16, v29
    v_and_b32 v29, 0xffff0000, v29
    v_mul_f32 v36, v24, v28
    v_mul_f32 v37, v24, v29
    v_accvgpr_read_b32 v29, a3
    v_lshlrev_b32 v28, 16, v29
    v_and_b32 v29, 0xffff0000, v29
    v_mul_f32 v38, v24, v28
    v_mul_f32 v39, v24, v29
    v_accvgpr_read_b32 v29, a4
    v_lshlrev_b32 v28, 16, v29
    v_and_b32 v29, 0xffff0000, v29
    v_fmac_f32 v32, v25, v28
    v_fmac_f32 v33, v25, v29
    v_accvgpr_read_b32 v29, a5
    v_lshlrev_b32 v28, 16, v29
    v_and_b32 v29, 0xffff0000, v29
    v_fmac_f32 v34, v25, v28
    v_fmac_f32 v35, v25, v29
    v_accvgpr_read_b32 v29, a6
    v_lshlrev_b32 v28, 16, v29
    v_and_b32 v29, 0xffff0000, v29
    v_fmac_f32 v36, v25, v28
    v_fmac_f32 v37, v25, v29
    v_accvgpr_read_b32 v29, a7
    v_lshlrev_b32 v28, 16, v29
    v_and_b32 v29, 0xffff0000, v29
    v_fmac_f32 v38, v25, v28
    v_fmac_f32 v39, v25, v29
    v_accvgpr_read_b32 v29, a8
    v_lshlrev_b32 v28, 16, v29
    v_and_b32 v29, 0xffff0000, v29
    v_fmac_f32 v32, v26, v28
    v_fmac_f32 v33, v26, v29
    v_accvgpr_read_b32 v29, a9
    v_lshlrev_b32 v28, 16, v29
    v_and_b32 v29, 0xffff0000, v29
    v_fmac_f32 v34, v26, v28
    v_fmac_f32 v35, v26, v29
    v_accvgpr_read_b32 v29, a10
    v_lshlrev_b32 v28, 16, v29
    v_and_b32 v29, 0xffff0000, v29
    v_fmac_f32 v36, v26, v28
    v_fmac_f32 v37, v26, v29
    v_accvgpr_read_b32 v29, a11
    v_lshlrev_b32 v28, 16, v29
    v_and_b32 v29, 0xffff0000, v29
    v_fmac_f32 v38, v26, v28
    v_fmac_f32 v39, v26, v29
    v_permlane32_swap_b32 v32, v36
    v_permlane32_swap_b32 v33, v37
    v_permlane32_swap_b32 v34, v38
    v_permlane32_swap_b32 v35, v39
    v_add_f32 v32, v32, v36
    v_add_f32 v33, v33, v37
    v_add_f32 v34, v34, v38
    v_add_f32 v35, v35, v39
    s_nop 0
    v_permlane16_swap_b32 v32, v34
    v_permlane16_swap_b32 v33, v35
    v_add_f32 v32, v32, v34
    v_add_f32 v33, v33, v35
    v_and_b32 v28, 15, v2
    v_lshrrev_b32 v29, 4, v2
    v_lshlrev_b32 v29, 3, v29
    v_lshl_add_u32 v29, v28, 5, v29
    v_mov_b32 v30, 0x7fff0000
    s_cmp_lg_u32 s3, 0
    s_cselect_b32 s14, 10, 0
    v_cmp_gt_u32 vcc, s14, v28
    s_nop 1
    v_cndmask_b32 v29, v30, v29, vcc
    s_lshl_b32 s14, s5, 2
    s_add_u32 s14, s14, s4
    s_mul_i32 s14, s14, 40960
    s_mul_i32 s15, s50, 320
    s_add_u32 s14, s14, s15
    s_add_u32 s62, s14, 0x30000
    s_lshl_b32 s14, s3, 2
    s_add_u32 s14, s14, s13
    s_waitcnt vmcnt(0)
    s_mov_b64 exec, 1
    buffer_store_dword v10, v0, s[92:95], s14 offen
    s_mov_b64 exec, -1
    v_cmp_ne_u32 vcc, s9, v249
    s_add_u32 s14, s7, 1
    v_mov_b32 v252, s14
    v_mov_b32 v253, s14
    v_mov_b32 v254, s14
    v_mov_b32 v255, s14
    s_lshr_b32 s14, vcc_lo, s3
    s_mov_b32 s1, 0
    s_bfe_u32 s15, s14, 0x10004
    s_lshl_b32 s0, 1, s15
    s_and_b32 s15, s14, 1
    s_lshl_b32 s15, 4, s15
    s_or_b32 s0, s0, s15
    s_bfe_u32 s15, s14, 0x10008
    s_lshl_b32 s15, 16, s15
    s_or_b32 s0, s0, s15
    s_mov_b32 s15, 0
m_wf_chk:
    v_cmp_eq_u32 vcc, s7, v196
    s_add_u32 s15, s15, 1
    s_cmp_eq_u64 vcc, -1
    s_cbranch_scc1 m_wf_ok
    s_cmp_ge_u32 s15, 0x40000
    s_cbranch_scc1 m_wf_ok
    s_sleep 4
    buffer_load_dword v196, v11, s[92:95], s63 offen sc1
    s_waitcnt vmcnt(0)
    s_branch m_wf_chk
m_wf_ok:
    s_add_u32 s40, s38, 0x400000
    s_addc_u32 s41, s39, 0
    s_mov_b32 s42, 0x500000
    s_mov_b32 s43, 0x00020000
    s_cmp_lt_u32 s3, 2
    s_cselect_b32 s96, s66, s65
    s_cselect_b32 s97, s65, s66
    s_cselect_b32 s11, 1056, 0
    s_cselect_b32 s12, 0, 1056
    s_add_u32 s98, s8, s11
    s_add_u32 s99, s8, s12
    s_and_b64 exec, s[0:1], 3
    buffer_load_dwordx4 v[252:255], v248, s[92:95], 0 offen sc1
    s_mov_b64 exec, -1
    s_add_u32 s12, s10, 0
    buffer_load_dwordx4 a[32:35], v11, s[44:47], s12 offen offset:0 sc1
    buffer_load_dwordx4 a[36:39], v11, s[44:47], s12 offen offset:1024 sc1
    buffer_load_dwordx4 a[40:43], v11, s[44:47], s12 offen offset:2048 sc1
    buffer_load_dwordx4 a[44:47], v11, s[44:47], s12 offen offset:3072 sc1
    buffer_load_dwordx4 a[48:51], v1, s[44:47], s12 offen sc1
    s_waitcnt vmcnt(5)
    s_mov_b32 s15, 0
c1_own_chk:
    v_min3_u32 v250, v252, v253, v254
    v_max3_u32 v251, v252, v253, v254
    v_min_u32 v250, v250, v255
    v_max_u32 v251, v251, v255
    v_cmp_eq_u32 vcc, s7, v250
    v_cmp_eq_u32 s[50:51], s7, v251
    s_nop 0
    s_and_b64 vcc, vcc, s[50:51]
    s_add_u32 s15, s15, 1
    s_and_b32 s14, vcc_lo, 3
    s_cbranch_scc1 c1_own_ok
    s_cmp_ge_u32 s15, 0x40000
    s_cbranch_scc1 c1_own_ok
    s_cmp_ge_u32 s15, 24
    s_cbranch_scc1 c1_own_both
    s_cmp_lg_u32 s15, 5
    s_cbranch_scc1 c1_own_nofs
    buffer_store_dwordx2 v[32:33], v29, s[92:95], s62 offen sc1
    s_waitcnt vmcnt(0)
    s_lshl_b32 s14, s3, 2
    s_add_u32 s14, s14, s13
    s_add_u32 s14, s14, 0x8000
    s_mov_b64 exec, 1
    buffer_store_dword v10, v0, s[92:95], s14 offen sc1
    s_mov_b64 exec, -1
c1_own_nofs:
    s_and_b64 exec, s[0:1], 3
    buffer_load_dwordx4 v[252:255], v248, s[92:95], 0 offen sc1
    s_mov_b64 exec, -1
    s_waitcnt vmcnt(0)
    s_branch c1_own_chk
c1_own_both:
    s_mov_b64 exec, 3
    buffer_load_dwordx4 v[252:255], v248, s[92:95], 0 offen sc1
    s_mov_b64 exec, -1
    s_waitcnt vmcnt(0)
    s_branch c1_own_chk
c1_own_ok:
    s_add_u32 m0, s98, 1072
    s_add_u32 s11, s96, 0
    buffer_load_dwordx4 v11, s[40:43], s11 offen sc1 lds
    s_add_u32 m0, s98, 5424
    s_add_u32 s11, s96, 65536
    buffer_load_dwordx4 v11, s[40:43], s11 offen sc1 lds
    s_add_u32 m0, s98, 9776
    s_add_u32 s11, s96, 131072
    buffer_load_dwordx4 v11, s[40:43], s11 offen sc1 lds
    s_add_u32 m0, s98, 14128
    s_add_u32 s11, s96, 196608
    buffer_load_dwordx4 v11, s[40:43], s11 offen sc1 lds
    s_add_u32 m0, s99, 1072
    s_add_u32 s11, s97, 0
    buffer_load_dwordx4 v11, s[40:43], s11 offen sc1 lds
    s_add_u32 m0, s99, 5424
    s_add_u32 s11, s97, 65536
    buffer_load_dwordx4 v11, s[40:43], s11 offen sc1 lds
    s_add_u32 m0, s99, 9776
    s_add_u32 s11, s97, 131072
    buffer_load_dwordx4 v11, s[40:43], s11 offen sc1 lds
    s_add_u32 m0, s99, 14128
    s_add_u32 s11, s97, 196608
    buffer_load_dwordx4 v11, s[40:43], s11 offen sc1 lds
    s_add_u32 s12, s10, 5120
    buffer_load_dwordx4 a[52:55], v11, s[44:47], s12 offen offset:0 sc1
    buffer_load_dwordx4 a[56:59], v11, s[44:47], s12 offen offset:1024 sc1
    buffer_store_dwordx2 v[32:33], v29, s[92:95], s62 offen sc1
    s_waitcnt lgkmcnt(0)
    s_mov_b32 s48, 0x26000
    s_mov_b32 s52, s28
    s_mov_b32 s53, s29
    s_mov_b32 s54, 0x280
    s_mov_b32 s55, 0x00020000
    s_mov_b32 s56, s30
    s_mov_b32 s57, s31
    s_mov_b32 s58, 0x280
    s_mov_b32 s59, 0x00020000
    s_add_u32 s60, s38, 0xa00000
    s_addc_u32 s61, s39, 0
    s_mov_b32 s62, 0x500000
    s_mov_b32 s63, 0x00020000
    s_lshl_b32 s14, s5, 2
    s_add_u32 s14, s14, s4
    s_lshl_b32 s15, s14, 12
    s_add_u32 s15, s15, 0x1108000
    s_add_u32 s96, s38, s15
    s_addc_u32 s97, s39, 0
    s_mov_b32 s98, 4096
    s_mov_b32 s99, 0x00020000
    v_mov_b32 v0, 0
    s_lshl_b32 s14, s49, 4
    s_add_u32 s14, s14, 131008
    v_add_u32 v249, s14, v11
    s_lshr_b32 s14, s6, 1
    s_lshl_b32 s15, s3, 5
    s_add_u32 s15, s15, s14
    s_cmp_lt_u32 s15, 20
    s_cselect_b32 s15, 0, 0x7fff0000
    s_lshl_b32 s14, s14, 4
    s_add_u32 s15, s15, s14
    v_mul_u32_u24 v44, 320, v2
    v_add_u32 v44, s15, v44
    s_lshl_b32 s14, s5, 2
    s_add_u32 s14, s14, s4
    s_mul_i32 s84, s14, 40960
    s_add_u32 s84, s84, 0x30000
    s_add_u32 s85, s84, 20480
    s_mul_i32 s86, s14, 320
    s_add_u32 s86, s86, 0x26000
    s_lshl_b32 s87, s14, 7
    s_add_u32 s87, s87, 0x28000
    v_mov_b32 v45, s15
    s_lshr_b32 s14, s15, 2
    s_and_b32 s15, s15, 0x7fff0000
    s_and_b32 s14, s14, 0xff
    s_add_u32 s14, s14, s15
    v_mov_b32 v46, s14
    v_lshlrev_b32 v47, 2, v2
    s_lshl_b32 s88, s5, 7
    s_add_u32 s88, s88, s4
    s_lshl_b32 s88, s88, 7
    s_add_u32 s88, s88, 0x8000
    s_mov_b32 s90, s15
    v_and_b32 v58, 31, v2
    v_lshlrev_b32 v58, 9, v58
    v_add_u32 v58, s15, v58
    v_mov_b32 v57, 0x7fff0000
    v_cmp_gt_u32 vcc, 32, v2
    s_nop 1
    v_cndmask_b32 v57, v57, v44, vcc
    s_waitcnt vmcnt(7)
    ds_read_b128 a[0:3], v16 offset:1056
    ds_read_b128 a[4:7], v16 offset:1312
    ds_read_b128 a[8:11], v17 offset:1056
    ds_read_b128 a[12:15], v17 offset:1312
    s_waitcnt lgkmcnt(0)
    v_mfma_f32_16x16x32_bf16 v[64:67], a[32:35], a[0:3], 0
    v_mfma_f32_16x16x32_bf16 v[68:71], a[36:39], a[0:3], 0
    buffer_load_dwordx4 a[60:63], v11, s[44:47], s12 offen offset:2048 sc1
    v_mfma_f32_16x16x32_bf16 v[72:75], a[40:43], a[0:3], 0
    v_mfma_f32_16x16x32_bf16 v[76:79], a[44:47], a[0:3], 0
    buffer_load_dwordx4 a[64:67], v11, s[44:47], s12 offen offset:3072 sc1
    v_mfma_f32_16x16x32_bf16 v[80:83], a[48:51], a[0:3], 0
    v_mfma_f32_16x16x32_bf16 v[84:87], a[32:35], a[4:7], 0
    ds_read_b128 a[0:3], v16 offset:1072
    v_mfma_f32_16x16x32_bf16 v[88:91], a[36:39], a[4:7], 0
    buffer_load_dwordx4 a[68:71], v1, s[44:47], s12 offen sc1
    v_mfma_f32_16x16x32_bf16 v[92:95], a[40:43], a[4:7], 0
    v_mfma_f32_16x16x32_bf16 v[96:99], a[44:47], a[4:7], 0
    s_add_u32 m0, s8, 18480
    s_add_u32 s11, s65, 262144
    buffer_load_dwordx4 v11, s[40:43], s11 offen sc1 lds
    v_mfma_f32_16x16x32_bf16 v[100:103], a[48:51], a[4:7], 0
    s_waitcnt vmcnt(7)
    ds_read_b128 a[16:19], v18 offset:1056
    ds_read_b128 a[20:23], v18 offset:1312
    ds_read_b128 a[24:27], v19 offset:1056
    ds_read_b128 a[28:31], v19 offset:1312
    v_mfma_f32_16x16x32_bf16 v[104:107], a[32:35], a[8:11], 0
    ds_read_b128 a[4:7], v16 offset:1328
    v_mfma_f32_16x16x32_bf16 v[108:111], a[36:39], a[8:11], 0
    s_add_u32 m0, s8, 19536
    s_add_u32 s11, s66, 262144
    buffer_load_dwordx4 v11, s[40:43], s11 offen sc1 lds
    v_mfma_f32_16x16x32_bf16 v[112:115], a[40:43], a[8:11], 0
    v_mfma_f32_16x16x32_bf16 v[116:119], a[44:47], a[8:11], 0
    s_add_u32 m0, s8, 22832
    s_add_u32 s11, s65, 327680
    buffer_load_dwordx4 v11, s[40:43], s11 offen sc1 lds
    v_mfma_f32_16x16x32_bf16 v[120:123], a[48:51], a[8:11], 0
    v_mfma_f32_16x16x32_bf16 v[124:127], a[32:35], a[12:15], 0
    ds_read_b128 a[8:11], v17 offset:1072
    v_mfma_f32_16x16x32_bf16 v[128:131], a[36:39], a[12:15], 0
    s_add_u32 m0, s8, 23888
    s_add_u32 s11, s66, 327680
    buffer_load_dwordx4 v11, s[40:43], s11 offen sc1 lds
    v_mfma_f32_16x16x32_bf16 v[132:135], a[40:43], a[12:15], 0
    v_mfma_f32_16x16x32_bf16 v[136:139], a[44:47], a[12:15], 0
    s_add_u32 m0, s8, 27184
    s_add_u32 s11, s65, 393216
    buffer_load_dwordx4 v11, s[40:43], s11 offen sc1 lds
    v_mfma_f32_16x16x32_bf16 v[140:143], a[48:51], a[12:15], 0
    s_waitcnt lgkmcnt(2)
    v_mfma_f32_16x16x32_bf16 v[144:147], a[32:35], a[16:19], 0
    ds_read_b128 a[12:15], v17 offset:1328
    v_mfma_f32_16x16x32_bf16 v[148:151], a[36:39], a[16:19], 0
    s_add_u32 m0, s8, 28240
    s_add_u32 s11, s66, 393216
    buffer_load_dwordx4 v11, s[40:43], s11 offen sc1 lds
    v_mfma_f32_16x16x32_bf16 v[152:155], a[40:43], a[16:19], 0
    v_mfma_f32_16x16x32_bf16 v[156:159], a[44:47], a[16:19], 0
    s_add_u32 m0, s8, 31536
    s_add_u32 s11, s65, 458752
    buffer_load_dwordx4 v11, s[40:43], s11 offen sc1 lds
    v_mfma_f32_16x16x32_bf16 v[160:163], a[48:51], a[16:19], 0
    v_mfma_f32_16x16x32_bf16 v[164:167], a[32:35], a[20:23], 0
    ds_read_b128 a[16:19], v18 offset:1072
    v_mfma_f32_16x16x32_bf16 v[168:171], a[36:39], a[20:23], 0
    s_add_u32 m0, s8, 32592
    s_add_u32 s11, s66, 458752
    buffer_load_dwordx4 v11, s[40:43], s11 offen sc1 lds
    v_mfma_f32_16x16x32_bf16 v[172:175], a[40:43], a[20:23], 0
    v_mfma_f32_16x16x32_bf16 v[176:179], a[44:47], a[20:23], 0
    s_add_u32 s12, s10, 10240
    buffer_load_dwordx4 a[72:75], v11, s[44:47], s12 offen offset:0 sc1
    v_mfma_f32_16x16x32_bf16 v[180:183], a[48:51], a[20:23], 0
    v_mfma_f32_16x16x32_bf16 v[184:187], a[32:35], a[24:27], 0
    ds_read_b128 a[20:23], v18 offset:1328
    v_mfma_f32_16x16x32_bf16 v[188:191], a[36:39], a[24:27], 0
    buffer_load_dwordx4 a[76:79], v11, s[44:47], s12 offen offset:1024 sc1
    v_mfma_f32_16x16x32_bf16 v[192:195], a[40:43], a[24:27], 0
    v_mfma_f32_16x16x32_bf16 v[196:199], a[44:47], a[24:27], 0
    buffer_load_dwordx4 a[80:83], v11, s[44:47], s12 offen offset:2048 sc1
    v_mfma_f32_16x16x32_bf16 v[200:203], a[48:51], a[24:27], 0
    v_mfma_f32_16x16x32_bf16 v[204:207], a[32:35], a[28:31], 0
    ds_read_b128 a[24:27], v19 offset:1072
    v_mfma_f32_16x16x32_bf16 v[208:211], a[36:39], a[28:31], 0
    buffer_load_dwordx4 a[84:87], v11, s[44:47], s12 offen offset:3072 sc1
    v_mfma_f32_16x16x32_bf16 v[212:215], a[40:43], a[28:31], 0
    v_mfma_f32_16x16x32_bf16 v[216:219], a[44:47], a[28:31], 0
    buffer_load_dwordx4 a[88:91], v1, s[44:47], s12 offen sc1
    v_mfma_f32_16x16x32_bf16 v[220:223], a[48:51], a[28:31], 0
    s_waitcnt vmcnt(13)
    s_waitcnt lgkmcnt(3)
    v_mfma_f32_16x16x32_bf16 v[64:67], a[52:55], a[0:3], v[64:67]
    ds_read_b128 a[28:31], v19 offset:1328
    v_mfma_f32_16x16x32_bf16 v[68:71], a[56:59], a[0:3], v[68:71]
    v_mfma_f32_16x16x32_bf16 v[72:75], a[60:63], a[0:3], v[72:75]
    s_lshl_b32 s14, s3, 2
    s_add_u32 s14, s14, s13
    s_add_u32 s14, s14, 0x8000
    s_mov_b64 exec, 1
    buffer_store_dword v10, v0, s[92:95], s14 offen sc1
    s_mov_b64 exec, -1
    v_mfma_f32_16x16x32_bf16 v[76:79], a[64:67], a[0:3], v[76:79]
    v_mfma_f32_16x16x32_bf16 v[80:83], a[68:71], a[0:3], v[80:83]
    v_mfma_f32_16x16x32_bf16 v[84:87], a[52:55], a[4:7], v[84:87]
    ds_read_b128 a[0:3], v16 offset:1088
    v_mfma_f32_16x16x32_bf16 v[88:91], a[56:59], a[4:7], v[88:91]
    v_mfma_f32_16x16x32_bf16 v[92:95], a[60:63], a[4:7], v[92:95]
    s_add_u32 s12, s10, 15360
    buffer_load_dwordx4 a[92:95], v11, s[44:47], s12 offen offset:0 sc1
    v_mfma_f32_16x16x32_bf16 v[96:99], a[64:67], a[4:7], v[96:99]
    v_mfma_f32_16x16x32_bf16 v[100:103], a[68:71], a[4:7], v[100:103]
    v_mfma_f32_16x16x32_bf16 v[104:107], a[52:55], a[8:11], v[104:107]
    ds_read_b128 a[4:7], v16 offset:1344
    v_mfma_f32_16x16x32_bf16 v[108:111], a[56:59], a[8:11], v[108:111]
    v_mfma_f32_16x16x32_bf16 v[112:115], a[60:63], a[8:11], v[112:115]
    buffer_load_dwordx4 a[96:99], v11, s[44:47], s12 offen offset:1024 sc1
    v_mfma_f32_16x16x32_bf16 v[116:119], a[64:67], a[8:11], v[116:119]
    v_mfma_f32_16x16x32_bf16 v[120:123], a[68:71], a[8:11], v[120:123]
    v_mfma_f32_16x16x32_bf16 v[124:127], a[52:55], a[12:15], v[124:127]
    ds_read_b128 a[8:11], v17 offset:1088
    v_mfma_f32_16x16x32_bf16 v[128:131], a[56:59], a[12:15], v[128:131]
    v_mfma_f32_16x16x32_bf16 v[132:135], a[60:63], a[12:15], v[132:135]
    buffer_load_dwordx4 a[100:103], v11, s[44:47], s12 offen offset:2048 sc1
    v_mfma_f32_16x16x32_bf16 v[136:139], a[64:67], a[12:15], v[136:139]
    v_mfma_f32_16x16x32_bf16 v[140:143], a[68:71], a[12:15], v[140:143]
    s_waitcnt lgkmcnt(3)
    v_mfma_f32_16x16x32_bf16 v[144:147], a[52:55], a[16:19], v[144:147]
    ds_read_b128 a[12:15], v17 offset:1344
    v_mfma_f32_16x16x32_bf16 v[148:151], a[56:59], a[16:19], v[148:151]
    v_mfma_f32_16x16x32_bf16 v[152:155], a[60:63], a[16:19], v[152:155]
    buffer_load_dwordx4 a[104:107], v11, s[44:47], s12 offen offset:3072 sc1
    v_mfma_f32_16x16x32_bf16 v[156:159], a[64:67], a[16:19], v[156:159]
    v_mfma_f32_16x16x32_bf16 v[160:163], a[68:71], a[16:19], v[160:163]
    v_mfma_f32_16x16x32_bf16 v[164:167], a[52:55], a[20:23], v[164:167]
    ds_read_b128 a[16:19], v18 offset:1088
    v_mfma_f32_16x16x32_bf16 v[168:171], a[56:59], a[20:23], v[168:171]
    v_mfma_f32_16x16x32_bf16 v[172:175], a[60:63], a[20:23], v[172:175]
    buffer_load_dwordx4 a[108:111], v1, s[44:47], s12 offen sc1
    v_mfma_f32_16x16x32_bf16 v[176:179], a[64:67], a[20:23], v[176:179]
    v_mfma_f32_16x16x32_bf16 v[180:183], a[68:71], a[20:23], v[180:183]
    v_mfma_f32_16x16x32_bf16 v[184:187], a[52:55], a[24:27], v[184:187]
    ds_read_b128 a[20:23], v18 offset:1344
    v_mfma_f32_16x16x32_bf16 v[188:191], a[56:59], a[24:27], v[188:191]
    v_mfma_f32_16x16x32_bf16 v[192:195], a[60:63], a[24:27], v[192:195]
    s_add_u32 s12, s10, 20480
    buffer_load_dwordx4 a[112:115], v11, s[44:47], s12 offen offset:0 sc1
    v_mfma_f32_16x16x32_bf16 v[196:199], a[64:67], a[24:27], v[196:199]
    v_mfma_f32_16x16x32_bf16 v[200:203], a[68:71], a[24:27], v[200:203]
    v_mfma_f32_16x16x32_bf16 v[204:207], a[52:55], a[28:31], v[204:207]
    ds_read_b128 a[24:27], v19 offset:1088
    v_mfma_f32_16x16x32_bf16 v[208:211], a[56:59], a[28:31], v[208:211]
    v_mfma_f32_16x16x32_bf16 v[212:215], a[60:63], a[28:31], v[212:215]
    buffer_load_dwordx4 a[116:119], v11, s[44:47], s12 offen offset:1024 sc1
    v_mfma_f32_16x16x32_bf16 v[216:219], a[64:67], a[28:31], v[216:219]
    v_mfma_f32_16x16x32_bf16 v[220:223], a[68:71], a[28:31], v[220:223]
    s_waitcnt vmcnt(8)
    s_waitcnt lgkmcnt(3)
    v_mfma_f32_16x16x32_bf16 v[64:67], a[72:75], a[0:3], v[64:67]
    ds_read_b128 a[28:31], v19 offset:1344
    v_mfma_f32_16x16x32_bf16 v[68:71], a[76:79], a[0:3], v[68:71]
    v_mfma_f32_16x16x32_bf16 v[72:75], a[80:83], a[0:3], v[72:75]
    s_and_b64 exec, s[0:1], 12
    buffer_load_dwordx4 v[252:255], v248, s[92:95], 0 offen sc1
    s_mov_b64 exec, -1
    v_mfma_f32_16x16x32_bf16 v[76:79], a[84:87], a[0:3], v[76:79]
    v_mfma_f32_16x16x32_bf16 v[80:83], a[88:91], a[0:3], v[80:83]
    v_mfma_f32_16x16x32_bf16 v[84:87], a[72:75], a[4:7], v[84:87]
    ds_read_b128 a[0:3], v16 offset:18464
    v_mfma_f32_16x16x32_bf16 v[88:91], a[76:79], a[4:7], v[88:91]
    v_mfma_f32_16x16x32_bf16 v[92:95], a[80:83], a[4:7], v[92:95]
    buffer_load_dwordx4 a[120:123], v11, s[44:47], s12 offen offset:2048 sc1
    v_mfma_f32_16x16x32_bf16 v[96:99], a[84:87], a[4:7], v[96:99]
    v_mfma_f32_16x16x32_bf16 v[100:103], a[88:91], a[4:7], v[100:103]
    v_mfma_f32_16x16x32_bf16 v[104:107], a[72:75], a[8:11], v[104:107]
    ds_read_b128 a[4:7], v16 offset:18720
    v_mfma_f32_16x16x32_bf16 v[108:111], a[76:79], a[8:11], v[108:111]
    buffer_load_dwordx4 a[124:127], v11, s[44:47], s12 offen offset:3072 sc1
    v_mfma_f32_16x16x32_bf16 v[112:115], a[80:83], a[8:11], v[112:115]
    v_mfma_f32_16x16x32_bf16 v[116:119], a[84:87], a[8:11], v[116:119]
    v_mfma_f32_16x16x32_bf16 v[120:123], a[88:91], a[8:11], v[120:123]
    buffer_load_dwordx4 a[128:131], v1, s[44:47], s12 offen sc1
    v_mfma_f32_16x16x32_bf16 v[124:127], a[72:75], a[12:15], v[124:127]
    ds_read_b128 a[8:11], v17 offset:18464
    v_mfma_f32_16x16x32_bf16 v[128:131], a[76:79], a[12:15], v[128:131]
    v_mfma_f32_16x16x32_bf16 v[132:135], a[80:83], a[12:15], v[132:135]
    v_mfma_f32_16x16x32_bf16 v[136:139], a[84:87], a[12:15], v[136:139]
    v_mfma_f32_16x16x32_bf16 v[140:143], a[88:91], a[12:15], v[140:143]
    s_waitcnt lgkmcnt(3)
    v_mfma_f32_16x16x32_bf16 v[144:147], a[72:75], a[16:19], v[144:147]
    ds_read_b128 a[12:15], v17 offset:18720
    v_mfma_f32_16x16x32_bf16 v[148:151], a[76:79], a[16:19], v[148:151]
    s_add_u32 s12, s10, 25600
    buffer_load_dwordx4 a[132:135], v11, s[44:47], s12 offen offset:0 sc1
    v_mfma_f32_16x16x32_bf16 v[152:155], a[80:83], a[16:19], v[152:155]
    v_mfma_f32_16x16x32_bf16 v[156:159], a[84:87], a[16:19], v[156:159]
    v_mfma_f32_16x16x32_bf16 v[160:163], a[88:91], a[16:19], v[160:163]
    buffer_load_dwordx4 a[136:139], v11, s[44:47], s12 offen offset:1024 sc1
    v_mfma_f32_16x16x32_bf16 v[164:167], a[72:75], a[20:23], v[164:167]
    ds_read_b128 a[16:19], v18 offset:18464
    v_mfma_f32_16x16x32_bf16 v[168:171], a[76:79], a[20:23], v[168:171]
    v_mfma_f32_16x16x32_bf16 v[172:175], a[80:83], a[20:23], v[172:175]
    v_mfma_f32_16x16x32_bf16 v[176:179], a[84:87], a[20:23], v[176:179]
    buffer_load_dwordx4 a[140:143], v11, s[44:47], s12 offen offset:2048 sc1
    v_mfma_f32_16x16x32_bf16 v[180:183], a[88:91], a[20:23], v[180:183]
    v_mfma_f32_16x16x32_bf16 v[184:187], a[72:75], a[24:27], v[184:187]
    ds_read_b128 a[20:23], v18 offset:18720
    v_mfma_f32_16x16x32_bf16 v[188:191], a[76:79], a[24:27], v[188:191]
    v_mfma_f32_16x16x32_bf16 v[192:195], a[80:83], a[24:27], v[192:195]
    v_mfma_f32_16x16x32_bf16 v[196:199], a[84:87], a[24:27], v[196:199]
    buffer_load_dwordx4 a[144:147], v11, s[44:47], s12 offen offset:3072 sc1
    v_mfma_f32_16x16x32_bf16 v[200:203], a[88:91], a[24:27], v[200:203]
    v_mfma_f32_16x16x32_bf16 v[204:207], a[72:75], a[28:31], v[204:207]
    ds_read_b128 a[24:27], v19 offset:18464
    v_mfma_f32_16x16x32_bf16 v[208:211], a[76:79], a[28:31], v[208:211]
    v_mfma_f32_16x16x32_bf16 v[212:215], a[80:83], a[28:31], v[212:215]
    buffer_load_dwordx4 a[148:151], v1, s[44:47], s12 offen sc1
    v_mfma_f32_16x16x32_bf16 v[216:219], a[84:87], a[28:31], v[216:219]
    v_mfma_f32_16x16x32_bf16 v[220:223], a[88:91], a[28:31], v[220:223]
    s_waitcnt vmcnt(8)
    s_cmp_eq_u32 s6, 0
    s_cbranch_scc1 c1_h0_ok
    s_mov_b32 s15, 0
c1_h0_chk:
    v_min3_u32 v250, v252, v253, v254
    v_max3_u32 v251, v252, v253, v254
    v_min_u32 v250, v250, v255
    v_max_u32 v251, v251, v255
    v_cmp_eq_u32 vcc, s7, v250
    v_cmp_eq_u32 s[50:51], s7, v251
    s_nop 0
    s_and_b64 vcc, vcc, s[50:51]
    s_add_u32 s15, s15, 1
    s_and_b32 s14, vcc_lo, 12
    s_cbranch_scc1 c1_h0_ok
    s_cmp_ge_u32 s15, 0x40000
    s_cbranch_scc1 c1_h0_ok
    s_cmp_ge_u32 s15, 24
    s_cbranch_scc1 c1_h0_both
    s_and_b64 exec, s[0:1], 12
    buffer_load_dwordx4 v[252:255], v248, s[92:95], 0 offen sc1
    s_mov_b64 exec, -1
    s_waitcnt vmcnt(0)
    s_branch c1_h0_chk
c1_h0_both:
    s_mov_b64 exec, 12
    buffer_load_dwordx4 v[252:255], v248, s[92:95], 0 offen sc1
    s_mov_b64 exec, -1
    s_waitcnt vmcnt(0)
    s_branch c1_h0_chk
c1_h0_ok:
    s_waitcnt lgkmcnt(3)
    v_mfma_f32_16x16x32_bf16 v[64:67], a[92:95], a[0:3], v[64:67]
    ds_read_b128 a[28:31], v19 offset:18720
    v_mfma_f32_16x16x32_bf16 v[68:71], a[96:99], a[0:3], v[68:71]
    v_mfma_f32_16x16x32_bf16 v[72:75], a[100:103], a[0:3], v[72:75]
    s_add_u32 m0, s8, 16
    s_nop 0
    buffer_load_dwordx4 v4, s[40:43], s64 offen sc1 lds
    v_mfma_f32_16x16x32_bf16 v[76:79], a[104:107], a[0:3], v[76:79]
    v_mfma_f32_16x16x32_bf16 v[80:83], a[108:111], a[0:3], v[80:83]
    v_mfma_f32_16x16x32_bf16 v[84:87], a[92:95], a[4:7], v[84:87]
    ds_read_b128 a[0:3], v16 offset:18480
    v_mfma_f32_16x16x32_bf16 v[88:91], a[96:99], a[4:7], v[88:91]
    v_mfma_f32_16x16x32_bf16 v[92:95], a[100:103], a[4:7], v[92:95]
    s_add_u32 m0, s8, 4368
    s_add_u32 s11, s64, 65536
    buffer_load_dwordx4 v4, s[40:43], s11 offen sc1 lds
    v_mfma_f32_16x16x32_bf16 v[96:99], a[104:107], a[4:7], v[96:99]
    v_mfma_f32_16x16x32_bf16 v[100:103], a[108:111], a[4:7], v[100:103]
    v_mfma_f32_16x16x32_bf16 v[104:107], a[92:95], a[8:11], v[104:107]
    ds_read_b128 a[4:7], v16 offset:18736
    v_mfma_f32_16x16x32_bf16 v[108:111], a[96:99], a[8:11], v[108:111]
    v_mfma_f32_16x16x32_bf16 v[112:115], a[100:103], a[8:11], v[112:115]
    s_add_u32 m0, s8, 8720
    s_add_u32 s11, s64, 131072
    buffer_load_dwordx4 v4, s[40:43], s11 offen sc1 lds
    v_mfma_f32_16x16x32_bf16 v[116:119], a[104:107], a[8:11], v[116:119]
    v_mfma_f32_16x16x32_bf16 v[120:123], a[108:111], a[8:11], v[120:123]
    v_mfma_f32_16x16x32_bf16 v[124:127], a[92:95], a[12:15], v[124:127]
    ds_read_b128 a[8:11], v17 offset:18480
    v_mfma_f32_16x16x32_bf16 v[128:131], a[96:99], a[12:15], v[128:131]
    v_mfma_f32_16x16x32_bf16 v[132:135], a[100:103], a[12:15], v[132:135]
    s_add_u32 m0, s8, 13072
    s_add_u32 s11, s64, 196608
    buffer_load_dwordx4 v4, s[40:43], s11 offen sc1 lds
    v_mfma_f32_16x16x32_bf16 v[136:139], a[104:107], a[12:15], v[136:139]
    v_mfma_f32_16x16x32_bf16 v[140:143], a[108:111], a[12:15], v[140:143]
    s_waitcnt lgkmcnt(3)
    v_mfma_f32_16x16x32_bf16 v[144:147], a[92:95], a[16:19], v[144:147]
    ds_read_b128 a[12:15], v17 offset:18736
    v_mfma_f32_16x16x32_bf16 v[148:151], a[96:99], a[16:19], v[148:151]
    v_mfma_f32_16x16x32_bf16 v[152:155], a[100:103], a[16:19], v[152:155]
    s_add_u32 s12, s10, 30720
    buffer_load_dwordx4 a[152:155], v11, s[44:47], s12 offen offset:0 sc1
    v_mfma_f32_16x16x32_bf16 v[156:159], a[104:107], a[16:19], v[156:159]
    v_mfma_f32_16x16x32_bf16 v[160:163], a[108:111], a[16:19], v[160:163]
    v_mfma_f32_16x16x32_bf16 v[164:167], a[92:95], a[20:23], v[164:167]
    ds_read_b128 a[16:19], v18 offset:18480
    v_mfma_f32_16x16x32_bf16 v[168:171], a[96:99], a[20:23], v[168:171]
    v_mfma_f32_16x16x32_bf16 v[172:175], a[100:103], a[20:23], v[172:175]
    buffer_load_dwordx4 a[156:159], v11, s[44:47], s12 offen offset:1024 sc1
    v_mfma_f32_16x16x32_bf16 v[176:179], a[104:107], a[20:23], v[176:179]
    v_mfma_f32_16x16x32_bf16 v[180:183], a[108:111], a[20:23], v[180:183]
    v_mfma_f32_16x16x32_bf16 v[184:187], a[92:95], a[24:27], v[184:187]
    ds_read_b128 a[20:23], v18 offset:18736
    v_mfma_f32_16x16x32_bf16 v[188:191], a[96:99], a[24:27], v[188:191]
    v_mfma_f32_16x16x32_bf16 v[192:195], a[100:103], a[24:27], v[192:195]
    buffer_load_dwordx4 a[160:163], v11, s[44:47], s12 offen offset:2048 sc1
    v_mfma_f32_16x16x32_bf16 v[196:199], a[104:107], a[24:27], v[196:199]
    v_mfma_f32_16x16x32_bf16 v[200:203], a[108:111], a[24:27], v[200:203]
    v_mfma_f32_16x16x32_bf16 v[204:207], a[92:95], a[28:31], v[204:207]
    ds_read_b128 a[24:27], v19 offset:18480
    v_mfma_f32_16x16x32_bf16 v[208:211], a[96:99], a[28:31], v[208:211]
    v_mfma_f32_16x16x32_bf16 v[212:215], a[100:103], a[28:31], v[212:215]
    buffer_load_dwordx4 a[164:167], v11, s[44:47], s12 offen offset:3072 sc1
    v_mfma_f32_16x16x32_bf16 v[216:219], a[104:107], a[28:31], v[216:219]
    v_mfma_f32_16x16x32_bf16 v[220:223], a[108:111], a[28:31], v[220:223]
    s_waitcnt vmcnt(13) lgkmcnt(3)
    v_mfma_f32_16x16x32_bf16 v[64:67], a[112:115], a[0:3], v[64:67]
    ds_read_b128 a[28:31], v19 offset:18736
    v_mfma_f32_16x16x32_bf16 v[68:71], a[116:119], a[0:3], v[68:71]
    v_mfma_f32_16x16x32_bf16 v[72:75], a[120:123], a[0:3], v[72:75]
    s_and_b64 exec, s[0:1], 48
    buffer_load_dwordx4 v[252:255], v248, s[92:95], 0 offen sc1
    s_mov_b64 exec, -1
    v_mfma_f32_16x16x32_bf16 v[76:79], a[124:127], a[0:3], v[76:79]
    v_mfma_f32_16x16x32_bf16 v[80:83], a[128:131], a[0:3], v[80:83]
    v_mfma_f32_16x16x32_bf16 v[84:87], a[112:115], a[4:7], v[84:87]
    ds_read_b128 a[0:3], v16 offset:18496
    v_mfma_f32_16x16x32_bf16 v[88:91], a[116:119], a[4:7], v[88:91]
    v_mfma_f32_16x16x32_bf16 v[92:95], a[120:123], a[4:7], v[92:95]
    buffer_load_dwordx4 v[60:63], v58, s[92:95], s88 offen sc1
    v_mfma_f32_16x16x32_bf16 v[96:99], a[124:127], a[4:7], v[96:99]
    v_mfma_f32_16x16x32_bf16 v[100:103], a[128:131], a[4:7], v[100:103]
    v_mfma_f32_16x16x32_bf16 v[104:107], a[112:115], a[8:11], v[104:107]
    ds_read_b128 a[4:7], v16 offset:18752
    v_mfma_f32_16x16x32_bf16 v[108:111], a[116:119], a[8:11], v[108:111]
    buffer_load_dwordx4 a[168:171], v1, s[44:47], s12 offen sc1
    v_mfma_f32_16x16x32_bf16 v[112:115], a[120:123], a[8:11], v[112:115]
    v_mfma_f32_16x16x32_bf16 v[116:119], a[124:127], a[8:11], v[116:119]
    v_mfma_f32_16x16x32_bf16 v[120:123], a[128:131], a[8:11], v[120:123]
    s_add_u32 s12, s10, 35840
    buffer_load_dwordx4 a[172:175], v11, s[44:47], s12 offen offset:0 sc1
    v_mfma_f32_16x16x32_bf16 v[124:127], a[112:115], a[12:15], v[124:127]
    ds_read_b128 a[8:11], v17 offset:18496
    v_mfma_f32_16x16x32_bf16 v[128:131], a[116:119], a[12:15], v[128:131]
    v_mfma_f32_16x16x32_bf16 v[132:135], a[120:123], a[12:15], v[132:135]
    v_mfma_f32_16x16x32_bf16 v[136:139], a[124:127], a[12:15], v[136:139]
    v_mfma_f32_16x16x32_bf16 v[140:143], a[128:131], a[12:15], v[140:143]
    s_waitcnt lgkmcnt(3)
    v_mfma_f32_16x16x32_bf16 v[144:147], a[112:115], a[16:19], v[144:147]
    ds_read_b128 a[12:15], v17 offset:18752
    v_mfma_f32_16x16x32_bf16 v[148:151], a[116:119], a[16:19], v[148:151]
    buffer_load_dwordx4 a[176:179], v11, s[44:47], s12 offen offset:1024 sc1
    v_mfma_f32_16x16x32_bf16 v[152:155], a[120:123], a[16:19], v[152:155]
    v_mfma_f32_16x16x32_bf16 v[156:159], a[124:127], a[16:19], v[156:159]
    v_mfma_f32_16x16x32_bf16 v[160:163], a[128:131], a[16:19], v[160:163]
    buffer_load_dwordx4 a[180:183], v11, s[44:47], s12 offen offset:2048 sc1
    v_mfma_f32_16x16x32_bf16 v[164:167], a[112:115], a[20:23], v[164:167]
    ds_read_b128 a[16:19], v18 offset:18496
    v_mfma_f32_16x16x32_bf16 v[168:171], a[116:119], a[20:23], v[168:171]
    v_mfma_f32_16x16x32_bf16 v[172:175], a[120:123], a[20:23], v[172:175]
    v_mfma_f32_16x16x32_bf16 v[176:179], a[124:127], a[20:23], v[176:179]
    buffer_load_dwordx4 a[184:187], v11, s[44:47], s12 offen offset:3072 sc1
    v_mfma_f32_16x16x32_bf16 v[180:183], a[128:131], a[20:23], v[180:183]
    v_mfma_f32_16x16x32_bf16 v[184:187], a[112:115], a[24:27], v[184:187]
    ds_read_b128 a[20:23], v18 offset:18752
    v_mfma_f32_16x16x32_bf16 v[188:191], a[116:119], a[24:27], v[188:191]
    v_mfma_f32_16x16x32_bf16 v[192:195], a[120:123], a[24:27], v[192:195]
    v_mfma_f32_16x16x32_bf16 v[196:199], a[124:127], a[24:27], v[196:199]
    buffer_load_dwordx4 a[188:191], v1, s[44:47], s12 offen sc1
    v_mfma_f32_16x16x32_bf16 v[200:203], a[128:131], a[24:27], v[200:203]
    v_mfma_f32_16x16x32_bf16 v[204:207], a[112:115], a[28:31], v[204:207]
    ds_read_b128 a[24:27], v19 offset:18496
    v_mfma_f32_16x16x32_bf16 v[208:211], a[116:119], a[28:31], v[208:211]
    v_mfma_f32_16x16x32_bf16 v[212:215], a[120:123], a[28:31], v[212:215]
    s_add_u32 s12, s10, 40960
    buffer_load_dwordx4 a[32:35], v11, s[44:47], s12 offen offset:0 sc1
    v_mfma_f32_16x16x32_bf16 v[216:219], a[124:127], a[28:31], v[216:219]
    v_mfma_f32_16x16x32_bf16 v[220:223], a[128:131], a[28:31], v[220:223]
    s_waitcnt vmcnt(7)
    s_cmp_lg_u32 s90, 0
    s_cbranch_scc1 c1_pf_ok
    s_mov_b32 s15, 0
c1_pf_chk:
    v_min3_u32 v59, v61, v62, v63
    v_max3_u32 v60, v61, v62, v63
    v_cmp_eq_u32 vcc, s7, v59
    v_cmp_eq_u32 s[50:51], s7, v60
    s_add_u32 s15, s15, 1
    s_and_b64 vcc, vcc, s[50:51]
    s_cmp_eq_u64 vcc, -1
    s_cbranch_scc1 c1_pf_ok
    s_cmp_ge_u32 s15, 0x40000
    s_cbranch_scc1 c1_pf_ok
    buffer_load_dwordx4 v[60:63], v58, s[92:95], s88 offen sc1
    s_waitcnt vmcnt(0)
    s_branch c1_pf_chk
c1_pf_ok:
    s_cmp_eq_u32 s6, 62
    s_cbranch_scc1 c1_h3_ok
    s_mov_b32 s15, 0
c1_h3_chk:
    v_min3_u32 v250, v252, v253, v254
    v_max3_u32 v251, v252, v253, v254
    v_min_u32 v250, v250, v255
    v_max_u32 v251, v251, v255
    v_cmp_eq_u32 vcc, s7, v250
    v_cmp_eq_u32 s[50:51], s7, v251
    s_nop 0
    s_and_b64 vcc, vcc, s[50:51]
    s_add_u32 s15, s15, 1
    s_and_b32 s14, vcc_lo, 48
    s_cbranch_scc1 c1_h3_ok
    s_cmp_ge_u32 s15, 0x40000
    s_cbranch_scc1 c1_h3_ok
    s_cmp_ge_u32 s15, 24
    s_cbranch_scc1 c1_h3_both
    s_and_b64 exec, s[0:1], 48
    buffer_load_dwordx4 v[252:255], v248, s[92:95], 0 offen sc1
    s_mov_b64 exec, -1
    s_waitcnt vmcnt(0)
    s_branch c1_h3_chk
c1_h3_both:
    s_mov_b64 exec, 48
    buffer_load_dwordx4 v[252:255], v248, s[92:95], 0 offen sc1
    s_mov_b64 exec, -1
    s_waitcnt vmcnt(0)
    s_branch c1_h3_chk
c1_h3_ok:
    s_waitcnt lgkmcnt(3)
    v_mfma_f32_16x16x32_bf16 v[64:67], a[132:135], a[0:3], v[64:67]
    ds_read_b128 a[28:31], v19 offset:18752
    v_mfma_f32_16x16x32_bf16 v[68:71], a[136:139], a[0:3], v[68:71]
    v_mfma_f32_16x16x32_bf16 v[72:75], a[140:143], a[0:3], v[72:75]
    buffer_load_dwordx4 v[48:51], v44, s[92:95], s84 offen sc1
    v_mfma_f32_16x16x32_bf16 v[76:79], a[144:147], a[0:3], v[76:79]
    v_mfma_f32_16x16x32_bf16 v[80:83], a[148:151], a[0:3], v[80:83]
    v_mfma_f32_16x16x32_bf16 v[84:87], a[132:135], a[4:7], v[84:87]
    ds_read_b128 a[0:3], v16 offset:0
    v_mfma_f32_16x16x32_bf16 v[88:91], a[136:139], a[4:7], v[88:91]
    v_mfma_f32_16x16x32_bf16 v[92:95], a[140:143], a[4:7], v[92:95]
    buffer_load_dwordx4 v[52:55], v57, s[92:95], s85 offen sc1
    v_mfma_f32_16x16x32_bf16 v[96:99], a[144:147], a[4:7], v[96:99]
    v_mfma_f32_16x16x32_bf16 v[100:103], a[148:151], a[4:7], v[100:103]
    v_mfma_f32_16x16x32_bf16 v[104:107], a[132:135], a[8:11], v[104:107]
    ds_read_b128 a[4:7], v16 offset:256
    v_mfma_f32_16x16x32_bf16 v[108:111], a[136:139], a[8:11], v[108:111]
    s_add_u32 m0, s8, 3184
    s_nop 0
    buffer_load_dwordx4 v5, s[40:43], s67 offen sc1 lds
    v_mfma_f32_16x16x32_bf16 v[112:115], a[140:143], a[8:11], v[112:115]
    v_mfma_f32_16x16x32_bf16 v[116:119], a[144:147], a[8:11], v[116:119]
    v_mfma_f32_16x16x32_bf16 v[120:123], a[148:151], a[8:11], v[120:123]
    s_add_u32 m0, s8, 7536
    s_add_u32 s11, s67, 65536
    buffer_load_dwordx4 v5, s[40:43], s11 offen sc1 lds
    v_mfma_f32_16x16x32_bf16 v[124:127], a[132:135], a[12:15], v[124:127]
    ds_read_b128 a[8:11], v17 offset:0
    v_mfma_f32_16x16x32_bf16 v[128:131], a[136:139], a[12:15], v[128:131]
    v_mfma_f32_16x16x32_bf16 v[132:135], a[140:143], a[12:15], v[132:135]
    v_mfma_f32_16x16x32_bf16 v[136:139], a[144:147], a[12:15], v[136:139]
    v_mfma_f32_16x16x32_bf16 v[140:143], a[148:151], a[12:15], v[140:143]
    s_waitcnt lgkmcnt(3)
    v_mfma_f32_16x16x32_bf16 v[144:147], a[132:135], a[16:19], v[144:147]
    ds_read_b128 a[12:15], v17 offset:256
    v_mfma_f32_16x16x32_bf16 v[148:151], a[136:139], a[16:19], v[148:151]
    s_add_u32 m0, s8, 11888
    s_add_u32 s11, s67, 131072
    buffer_load_dwordx4 v5, s[40:43], s11 offen sc1 lds
    v_mfma_f32_16x16x32_bf16 v[152:155], a[140:143], a[16:19], v[152:155]
    v_mfma_f32_16x16x32_bf16 v[156:159], a[144:147], a[16:19], v[156:159]
    v_mfma_f32_16x16x32_bf16 v[160:163], a[148:151], a[16:19], v[160:163]
    s_add_u32 m0, s8, 16240
    s_add_u32 s11, s67, 196608
    buffer_load_dwordx4 v5, s[40:43], s11 offen sc1 lds
    v_mfma_f32_16x16x32_bf16 v[164:167], a[132:135], a[20:23], v[164:167]
    ds_read_b128 a[16:19], v18 offset:0
    v_mfma_f32_16x16x32_bf16 v[168:171], a[136:139], a[20:23], v[168:171]
    v_mfma_f32_16x16x32_bf16 v[172:175], a[140:143], a[20:23], v[172:175]
    v_mfma_f32_16x16x32_bf16 v[176:179], a[144:147], a[20:23], v[176:179]
    buffer_load_dwordx4 a[36:39], v11, s[44:47], s12 offen offset:1024 sc1
    v_mfma_f32_16x16x32_bf16 v[180:183], a[148:151], a[20:23], v[180:183]
    v_mfma_f32_16x16x32_bf16 v[184:187], a[132:135], a[24:27], v[184:187]
    ds_read_b128 a[20:23], v18 offset:256
    v_mfma_f32_16x16x32_bf16 v[188:191], a[136:139], a[24:27], v[188:191]
    v_mfma_f32_16x16x32_bf16 v[192:195], a[140:143], a[24:27], v[192:195]
    v_mfma_f32_16x16x32_bf16 v[196:199], a[144:147], a[24:27], v[196:199]
    buffer_load_dwordx4 a[40:43], v11, s[44:47], s12 offen offset:2048 sc1
    v_mfma_f32_16x16x32_bf16 v[200:203], a[148:151], a[24:27], v[200:203]
    v_mfma_f32_16x16x32_bf16 v[204:207], a[132:135], a[28:31], v[204:207]
    ds_read_b128 a[24:27], v19 offset:0
    v_mfma_f32_16x16x32_bf16 v[208:211], a[136:139], a[28:31], v[208:211]
    v_mfma_f32_16x16x32_bf16 v[212:215], a[140:143], a[28:31], v[212:215]
    buffer_load_dwordx4 a[44:47], v11, s[44:47], s12 offen offset:3072 sc1
    v_mfma_f32_16x16x32_bf16 v[216:219], a[144:147], a[28:31], v[216:219]
    v_mfma_f32_16x16x32_bf16 v[220:223], a[148:151], a[28:31], v[220:223]
    s_waitcnt vmcnt(15) lgkmcnt(3)
    v_mfma_f32_16x16x32_bf16 v[64:67], a[152:155], a[0:3], v[64:67]
    ds_read_b128 a[28:31], v19 offset:256
    v_mfma_f32_16x16x32_bf16 v[68:71], a[156:159], a[0:3], v[68:71]
    v_mfma_f32_16x16x32_bf16 v[72:75], a[160:163], a[0:3], v[72:75]
    buffer_load_dwordx4 a[48:51], v1, s[44:47], s12 offen sc1
    v_mfma_f32_16x16x32_bf16 v[76:79], a[164:167], a[0:3], v[76:79]
    v_mfma_f32_16x16x32_bf16 v[80:83], a[168:171], a[0:3], v[80:83]
    v_mfma_f32_16x16x32_bf16 v[84:87], a[152:155], a[4:7], v[84:87]
    ds_read_b128 a[0:3], v16 offset:16
    v_mfma_f32_16x16x32_bf16 v[88:91], a[156:159], a[4:7], v[88:91]
    v_mfma_f32_16x16x32_bf16 v[92:95], a[160:163], a[4:7], v[92:95]
    s_add_u32 s12, s10, 46080
    buffer_load_dwordx4 a[52:55], v11, s[44:47], s12 offen offset:0 sc1
    v_mfma_f32_16x16x32_bf16 v[96:99], a[164:167], a[4:7], v[96:99]
    v_mfma_f32_16x16x32_bf16 v[100:103], a[168:171], a[4:7], v[100:103]
    v_mfma_f32_16x16x32_bf16 v[104:107], a[152:155], a[8:11], v[104:107]
    ds_read_b128 a[4:7], v16 offset:272
    v_mfma_f32_16x16x32_bf16 v[108:111], a[156:159], a[8:11], v[108:111]
    v_mfma_f32_16x16x32_bf16 v[112:115], a[160:163], a[8:11], v[112:115]
    buffer_load_dwordx4 a[56:59], v11, s[44:47], s12 offen offset:1024 sc1
    v_mfma_f32_16x16x32_bf16 v[116:119], a[164:167], a[8:11], v[116:119]
    v_mfma_f32_16x16x32_bf16 v[120:123], a[168:171], a[8:11], v[120:123]
    v_mfma_f32_16x16x32_bf16 v[124:127], a[152:155], a[12:15], v[124:127]
    ds_read_b128 a[8:11], v17 offset:16
    v_mfma_f32_16x16x32_bf16 v[128:131], a[156:159], a[12:15], v[128:131]
    v_mfma_f32_16x16x32_bf16 v[132:135], a[160:163], a[12:15], v[132:135]
    buffer_load_dwordx4 a[60:63], v11, s[44:47], s12 offen offset:2048 sc1
    v_mfma_f32_16x16x32_bf16 v[136:139], a[164:167], a[12:15], v[136:139]
    v_mfma_f32_16x16x32_bf16 v[140:143], a[168:171], a[12:15], v[140:143]
    s_waitcnt lgkmcnt(3)
    v_mfma_f32_16x16x32_bf16 v[144:147], a[152:155], a[16:19], v[144:147]
    ds_read_b128 a[12:15], v17 offset:272
    v_mfma_f32_16x16x32_bf16 v[148:151], a[156:159], a[16:19], v[148:151]
    v_mfma_f32_16x16x32_bf16 v[152:155], a[160:163], a[16:19], v[152:155]
    buffer_load_dwordx4 a[64:67], v11, s[44:47], s12 offen offset:3072 sc1
    v_mfma_f32_16x16x32_bf16 v[156:159], a[164:167], a[16:19], v[156:159]
    v_mfma_f32_16x16x32_bf16 v[160:163], a[168:171], a[16:19], v[160:163]
    v_mfma_f32_16x16x32_bf16 v[164:167], a[152:155], a[20:23], v[164:167]
    ds_read_b128 a[16:19], v18 offset:16
    v_mfma_f32_16x16x32_bf16 v[168:171], a[156:159], a[20:23], v[168:171]
    v_mfma_f32_16x16x32_bf16 v[172:175], a[160:163], a[20:23], v[172:175]
    buffer_load_dwordx4 a[68:71], v1, s[44:47], s12 offen sc1
    v_mfma_f32_16x16x32_bf16 v[176:179], a[164:167], a[20:23], v[176:179]
    v_mfma_f32_16x16x32_bf16 v[180:183], a[168:171], a[20:23], v[180:183]
    v_mfma_f32_16x16x32_bf16 v[184:187], a[152:155], a[24:27], v[184:187]
    ds_read_b128 a[20:23], v18 offset:272
    v_mfma_f32_16x16x32_bf16 v[188:191], a[156:159], a[24:27], v[188:191]
    v_mfma_f32_16x16x32_bf16 v[192:195], a[160:163], a[24:27], v[192:195]
    s_add_u32 s12, s10, 51200
    buffer_load_dwordx4 a[72:75], v11, s[44:47], s12 offen offset:0 sc1
    v_mfma_f32_16x16x32_bf16 v[196:199], a[164:167], a[24:27], v[196:199]
    v_mfma_f32_16x16x32_bf16 v[200:203], a[168:171], a[24:27], v[200:203]
    v_mfma_f32_16x16x32_bf16 v[204:207], a[152:155], a[28:31], v[204:207]
    ds_read_b128 a[24:27], v19 offset:16
    v_mfma_f32_16x16x32_bf16 v[208:211], a[156:159], a[28:31], v[208:211]
    v_mfma_f32_16x16x32_bf16 v[212:215], a[160:163], a[28:31], v[212:215]
    buffer_load_dwordx4 a[76:79], v11, s[44:47], s12 offen offset:1024 sc1
    v_mfma_f32_16x16x32_bf16 v[216:219], a[164:167], a[28:31], v[216:219]
    v_mfma_f32_16x16x32_bf16 v[220:223], a[168:171], a[28:31], v[220:223]
    s_waitcnt vmcnt(15)
    s_waitcnt lgkmcnt(3)
    v_mfma_f32_16x16x32_bf16 v[64:67], a[172:175], a[0:3], v[64:67]
    ds_read_b128 a[28:31], v19 offset:272
    v_mfma_f32_16x16x32_bf16 v[68:71], a[176:179], a[0:3], v[68:71]
    v_add_f32 v48, v48, v52
    v_add_f32 v49, v49, v53
    v_mfma_f32_16x16x32_bf16 v[72:75], a[180:183], a[0:3], v[72:75]
    buffer_load_dwordx4 a[80:83], v11, s[44:47], s12 offen offset:2048 sc1
    v_mfma_f32_16x16x32_bf16 v[76:79], a[184:187], a[0:3], v[76:79]
    v_add_f32 v50, v50, v54
    v_add_f32 v51, v51, v55
    v_mfma_f32_16x16x32_bf16 v[80:83], a[188:191], a[0:3], v[80:83]
    v_add_f32_dpp v48, v48, v48 row_shr:1 row_mask:0xf bank_mask:0xf bound_ctrl:0
    v_add_f32_dpp v49, v49, v49 row_shr:1 row_mask:0xf bank_mask:0xf bound_ctrl:0
    v_mfma_f32_16x16x32_bf16 v[84:87], a[172:175], a[4:7], v[84:87]
    ds_read_b128 a[0:3], v16 offset:32
    v_mfma_f32_16x16x32_bf16 v[88:91], a[176:179], a[4:7], v[88:91]
    v_add_f32_dpp v50, v50, v50 row_shr:1 row_mask:0xf bank_mask:0xf bound_ctrl:0
    v_add_f32_dpp v51, v51, v51 row_shr:1 row_mask:0xf bank_mask:0xf bound_ctrl:0
    v_mfma_f32_16x16x32_bf16 v[92:95], a[180:183], a[4:7], v[92:95]
    buffer_load_dwordx4 a[84:87], v11, s[44:47], s12 offen offset:3072 sc1
    v_mfma_f32_16x16x32_bf16 v[96:99], a[184:187], a[4:7], v[96:99]
    v_add_f32_dpp v48, v48, v48 row_shr:2 row_mask:0xf bank_mask:0xf bound_ctrl:0
    v_add_f32_dpp v49, v49, v49 row_shr:2 row_mask:0xf bank_mask:0xf bound_ctrl:0
    v_mfma_f32_16x16x32_bf16 v[100:103], a[188:191], a[4:7], v[100:103]
    v_add_f32_dpp v50, v50, v50 row_shr:2 row_mask:0xf bank_mask:0xf bound_ctrl:0
    v_add_f32_dpp v51, v51, v51 row_shr:2 row_mask:0xf bank_mask:0xf bound_ctrl:0
    v_mfma_f32_16x16x32_bf16 v[104:107], a[172:175], a[8:11], v[104:107]
    ds_read_b128 a[4:7], v16 offset:288
    v_mfma_f32_16x16x32_bf16 v[108:111], a[176:179], a[8:11], v[108:111]
    v_add_f32_dpp v48, v48, v48 row_shr:4 row_mask:0xf bank_mask:0xf bound_ctrl:0
    v_add_f32_dpp v49, v49, v49 row_shr:4 row_mask:0xf bank_mask:0xf bound_ctrl:0
    v_mfma_f32_16x16x32_bf16 v[112:115], a[180:183], a[8:11], v[112:115]
    buffer_load_dwordx4 a[88:91], v1, s[44:47], s12 offen sc1
    v_mfma_f32_16x16x32_bf16 v[116:119], a[184:187], a[8:11], v[116:119]
    v_add_f32_dpp v50, v50, v50 row_shr:4 row_mask:0xf bank_mask:0xf bound_ctrl:0
    v_add_f32_dpp v51, v51, v51 row_shr:4 row_mask:0xf bank_mask:0xf bound_ctrl:0
    v_mfma_f32_16x16x32_bf16 v[120:123], a[188:191], a[8:11], v[120:123]
    v_add_f32_dpp v48, v48, v48 row_shr:8 row_mask:0xf bank_mask:0xf bound_ctrl:0
    v_add_f32_dpp v49, v49, v49 row_shr:8 row_mask:0xf bank_mask:0xf bound_ctrl:0
    v_mfma_f32_16x16x32_bf16 v[124:127], a[172:175], a[12:15], v[124:127]
    ds_read_b128 a[8:11], v17 offset:32
    v_mfma_f32_16x16x32_bf16 v[128:131], a[176:179], a[12:15], v[128:131]
    v_add_f32_dpp v50, v50, v50 row_shr:8 row_mask:0xf bank_mask:0xf bound_ctrl:0
    v_add_f32_dpp v51, v51, v51 row_shr:8 row_mask:0xf bank_mask:0xf bound_ctrl:0
    v_mfma_f32_16x16x32_bf16 v[132:135], a[180:183], a[12:15], v[132:135]
    s_add_u32 m0, s8, 17424
    s_add_u32 s11, s64, 262144
    buffer_load_dwordx4 v4, s[40:43], s11 offen sc1 lds
    v_mfma_f32_16x16x32_bf16 v[136:139], a[184:187], a[12:15], v[136:139]
    v_add_f32_dpp v48, v48, v48 row_bcast:15 row_mask:0xa bank_mask:0xf
    v_add_f32_dpp v49, v49, v49 row_bcast:15 row_mask:0xa bank_mask:0xf
    v_mfma_f32_16x16x32_bf16 v[140:143], a[188:191], a[12:15], v[140:143]
    s_waitcnt lgkmcnt(3)
    v_mfma_f32_16x16x32_bf16 v[144:147], a[172:175], a[16:19], v[144:147]
    ds_read_b128 a[12:15], v17 offset:288
    v_mfma_f32_16x16x32_bf16 v[148:151], a[176:179], a[16:19], v[148:151]
    v_add_f32_dpp v50, v50, v50 row_bcast:15 row_mask:0xa bank_mask:0xf
    v_add_f32_dpp v51, v51, v51 row_bcast:15 row_mask:0xa bank_mask:0xf
    v_mfma_f32_16x16x32_bf16 v[152:155], a[180:183], a[16:19], v[152:155]
    s_add_u32 m0, s8, 21776
    s_add_u32 s11, s64, 327680
    buffer_load_dwordx4 v4, s[40:43], s11 offen sc1 lds
    v_mfma_f32_16x16x32_bf16 v[156:159], a[184:187], a[16:19], v[156:159]
    v_add_f32_dpp v48, v48, v48 row_bcast:31 row_mask:0xc bank_mask:0xf
    v_add_f32_dpp v49, v49, v49 row_bcast:31 row_mask:0xc bank_mask:0xf
    v_mfma_f32_16x16x32_bf16 v[160:163], a[188:191], a[16:19], v[160:163]
    v_add_f32_dpp v50, v50, v50 row_bcast:31 row_mask:0xc bank_mask:0xf
    v_add_f32_dpp v51, v51, v51 row_bcast:31 row_mask:0xc bank_mask:0xf
    v_mfma_f32_16x16x32_bf16 v[164:167], a[172:175], a[20:23], v[164:167]
    ds_read_b128 a[16:19], v18 offset:32
    v_mfma_f32_16x16x32_bf16 v[168:171], a[176:179], a[20:23], v[168:171]
    v_mfma_f32_16x16x32_bf16 v[172:175], a[180:183], a[20:23], v[172:175]
    s_add_u32 m0, s8, 26128
    s_add_u32 s11, s64, 393216
    buffer_load_dwordx4 v4, s[40:43], s11 offen sc1 lds
    v_mfma_f32_16x16x32_bf16 v[176:179], a[184:187], a[20:23], v[176:179]
    v_mfma_f32_16x16x32_bf16 v[180:183], a[188:191], a[20:23], v[180:183]
    v_mfma_f32_16x16x32_bf16 v[184:187], a[172:175], a[24:27], v[184:187]
    ds_read_b128 a[20:23], v18 offset:288
    v_mfma_f32_16x16x32_bf16 v[188:191], a[176:179], a[24:27], v[188:191]
    v_mfma_f32_16x16x32_bf16 v[192:195], a[180:183], a[24:27], v[192:195]
    s_add_u32 m0, s8, 30480
    s_add_u32 s11, s64, 458752
    buffer_load_dwordx4 v4, s[40:43], s11 offen sc1 lds
    v_mfma_f32_16x16x32_bf16 v[196:199], a[184:187], a[24:27], v[196:199]
    v_mfma_f32_16x16x32_bf16 v[200:203], a[188:191], a[24:27], v[200:203]
    v_mfma_f32_16x16x32_bf16 v[204:207], a[172:175], a[28:31], v[204:207]
    ds_read_b128 a[24:27], v19 offset:32
    v_mfma_f32_16x16x32_bf16 v[208:211], a[176:179], a[28:31], v[208:211]
    v_mfma_f32_16x16x32_bf16 v[212:215], a[180:183], a[28:31], v[212:215]
    s_add_u32 s12, s10, 56320
    buffer_load_dwordx4 a[92:95], v11, s[44:47], s12 offen offset:0 sc1
    v_mfma_f32_16x16x32_bf16 v[216:219], a[184:187], a[28:31], v[216:219]
    v_mfma_f32_16x16x32_bf16 v[220:223], a[188:191], a[28:31], v[220:223]
    s_waitcnt vmcnt(15)
    s_waitcnt lgkmcnt(3)
    v_mfma_f32_16x16x32_bf16 v[64:67], a[32:35], a[0:3], v[64:67]
    ds_read_b128 a[28:31], v19 offset:288
    v_mfma_f32_16x16x32_bf16 v[68:71], a[36:39], a[0:3], v[68:71]
    v_mfma_f32_16x16x32_bf16 v[72:75], a[40:43], a[0:3], v[72:75]
    s_mov_b32 exec_lo, 0
    s_mov_b32 exec_hi, 0x80000000
    buffer_store_dwordx4 v[48:51], v45, s[92:95], s86 offen sc1
    s_mov_b64 exec, -1
    v_mfma_f32_16x16x32_bf16 v[76:79], a[44:47], a[0:3], v[76:79]
    v_mfma_f32_16x16x32_bf16 v[80:83], a[48:51], a[0:3], v[80:83]
    v_mfma_f32_16x16x32_bf16 v[84:87], a[32:35], a[4:7], v[84:87]
    ds_read_b128 a[0:3], v16 offset:2112
    v_mfma_f32_16x16x32_bf16 v[88:91], a[36:39], a[4:7], v[88:91]
    v_mfma_f32_16x16x32_bf16 v[92:95], a[40:43], a[4:7], v[92:95]
    buffer_load_dwordx4 a[96:99], v11, s[44:47], s12 offen offset:1024 sc1
    v_mfma_f32_16x16x32_bf16 v[96:99], a[44:47], a[4:7], v[96:99]
    v_mfma_f32_16x16x32_bf16 v[100:103], a[48:51], a[4:7], v[100:103]
    v_mfma_f32_16x16x32_bf16 v[104:107], a[32:35], a[8:11], v[104:107]
    ds_read_b128 a[4:7], v16 offset:2368
    v_mfma_f32_16x16x32_bf16 v[108:111], a[36:39], a[8:11], v[108:111]
    v_mfma_f32_16x16x32_bf16 v[112:115], a[40:43], a[8:11], v[112:115]
    buffer_load_dwordx4 a[100:103], v11, s[44:47], s12 offen offset:2048 sc1
    v_mfma_f32_16x16x32_bf16 v[116:119], a[44:47], a[8:11], v[116:119]
    v_mfma_f32_16x16x32_bf16 v[120:123], a[48:51], a[8:11], v[120:123]
    v_mfma_f32_16x16x32_bf16 v[124:127], a[32:35], a[12:15], v[124:127]
    ds_read_b128 a[8:11], v17 offset:2112
    v_mfma_f32_16x16x32_bf16 v[128:131], a[36:39], a[12:15], v[128:131]
    v_mfma_f32_16x16x32_bf16 v[132:135], a[40:43], a[12:15], v[132:135]
    buffer_load_dwordx4 a[104:107], v11, s[44:47], s12 offen offset:3072 sc1
    v_mfma_f32_16x16x32_bf16 v[136:139], a[44:47], a[12:15], v[136:139]
    v_mfma_f32_16x16x32_bf16 v[140:143], a[48:51], a[12:15], v[140:143]
    s_waitcnt lgkmcnt(3)
    v_mfma_f32_16x16x32_bf16 v[144:147], a[32:35], a[16:19], v[144:147]
    ds_read_b128 a[12:15], v17 offset:2368
    v_mfma_f32_16x16x32_bf16 v[148:151], a[36:39], a[16:19], v[148:151]
    v_mfma_f32_16x16x32_bf16 v[152:155], a[40:43], a[16:19], v[152:155]
    buffer_load_dwordx4 a[108:111], v1, s[44:47], s12 offen sc1
    v_mfma_f32_16x16x32_bf16 v[156:159], a[44:47], a[16:19], v[156:159]
    v_mfma_f32_16x16x32_bf16 v[160:163], a[48:51], a[16:19], v[160:163]
    v_mfma_f32_16x16x32_bf16 v[164:167], a[32:35], a[20:23], v[164:167]
    ds_read_b128 a[16:19], v18 offset:2112
    v_mfma_f32_16x16x32_bf16 v[168:171], a[36:39], a[20:23], v[168:171]
    v_mfma_f32_16x16x32_bf16 v[172:175], a[40:43], a[20:23], v[172:175]
    s_add_u32 s12, s10, 61440
    buffer_load_dwordx4 a[112:115], v11, s[44:47], s12 offen offset:0 sc1
    v_mfma_f32_16x16x32_bf16 v[176:179], a[44:47], a[20:23], v[176:179]
    v_mfma_f32_16x16x32_bf16 v[180:183], a[48:51], a[20:23], v[180:183]
    v_mfma_f32_16x16x32_bf16 v[184:187], a[32:35], a[24:27], v[184:187]
    ds_read_b128 a[20:23], v18 offset:2368
    v_mfma_f32_16x16x32_bf16 v[188:191], a[36:39], a[24:27], v[188:191]
    v_mfma_f32_16x16x32_bf16 v[192:195], a[40:43], a[24:27], v[192:195]
    buffer_load_dwordx4 a[116:119], v11, s[44:47], s12 offen offset:1024 sc1
    v_mfma_f32_16x16x32_bf16 v[196:199], a[44:47], a[24:27], v[196:199]
    v_mfma_f32_16x16x32_bf16 v[200:203], a[48:51], a[24:27], v[200:203]
    v_mfma_f32_16x16x32_bf16 v[204:207], a[32:35], a[28:31], v[204:207]
    ds_read_b128 a[24:27], v19 offset:2112
    v_mfma_f32_16x16x32_bf16 v[208:211], a[36:39], a[28:31], v[208:211]
    v_mfma_f32_16x16x32_bf16 v[212:215], a[40:43], a[28:31], v[212:215]
    buffer_load_dwordx4 a[120:123], v11, s[44:47], s12 offen offset:2048 sc1
    v_mfma_f32_16x16x32_bf16 v[216:219], a[44:47], a[28:31], v[216:219]
    v_mfma_f32_16x16x32_bf16 v[220:223], a[48:51], a[28:31], v[220:223]
    s_waitcnt vmcnt(18) lgkmcnt(3)
    v_mfma_f32_16x16x32_bf16 v[64:67], a[52:55], a[0:3], v[64:67]
    ds_read_b128 a[28:31], v19 offset:2368
    v_mfma_f32_16x16x32_bf16 v[68:71], a[56:59], a[0:3], v[68:71]
    v_mfma_f32_16x16x32_bf16 v[72:75], a[60:63], a[0:3], v[72:75]
    buffer_load_dwordx4 a[124:127], v11, s[44:47], s12 offen offset:3072 sc1
    v_mfma_f32_16x16x32_bf16 v[76:79], a[64:67], a[0:3], v[76:79]
    v_mfma_f32_16x16x32_bf16 v[80:83], a[68:71], a[0:3], v[80:83]
    v_mfma_f32_16x16x32_bf16 v[84:87], a[52:55], a[4:7], v[84:87]
    ds_read_b128 a[0:3], v16 offset:2128
    v_mfma_f32_16x16x32_bf16 v[88:91], a[56:59], a[4:7], v[88:91]
    v_mfma_f32_16x16x32_bf16 v[92:95], a[60:63], a[4:7], v[92:95]
    buffer_load_dwordx4 a[128:131], v1, s[44:47], s12 offen sc1
    v_mfma_f32_16x16x32_bf16 v[96:99], a[64:67], a[4:7], v[96:99]
    v_mfma_f32_16x16x32_bf16 v[100:103], a[68:71], a[4:7], v[100:103]
    v_mfma_f32_16x16x32_bf16 v[104:107], a[52:55], a[8:11], v[104:107]
    ds_read_b128 a[4:7], v16 offset:2384
    v_mfma_f32_16x16x32_bf16 v[108:111], a[56:59], a[8:11], v[108:111]
    v_mfma_f32_16x16x32_bf16 v[112:115], a[60:63], a[8:11], v[112:115]
    s_add_u32 s12, s10, 66560
    buffer_load_dwordx4 a[132:135], v11, s[44:47], s12 offen offset:0 sc1
    v_mfma_f32_16x16x32_bf16 v[116:119], a[64:67], a[8:11], v[116:119]
    v_mfma_f32_16x16x32_bf16 v[120:123], a[68:71], a[8:11], v[120:123]
    v_mfma_f32_16x16x32_bf16 v[124:127], a[52:55], a[12:15], v[124:127]
    ds_read_b128 a[8:11], v17 offset:2128
    v_mfma_f32_16x16x32_bf16 v[128:131], a[56:59], a[12:15], v[128:131]
    v_mfma_f32_16x16x32_bf16 v[132:135], a[60:63], a[12:15], v[132:135]
    buffer_load_dwordx4 a[136:139], v11, s[44:47], s12 offen offset:1024 sc1
    v_mfma_f32_16x16x32_bf16 v[136:139], a[64:67], a[12:15], v[136:139]
    v_mfma_f32_16x16x32_bf16 v[140:143], a[68:71], a[12:15], v[140:143]
    s_waitcnt lgkmcnt(3)
    v_mfma_f32_16x16x32_bf16 v[144:147], a[52:55], a[16:19], v[144:147]
    ds_read_b128 a[12:15], v17 offset:2384
    v_mfma_f32_16x16x32_bf16 v[148:151], a[56:59], a[16:19], v[148:151]
    v_mfma_f32_16x16x32_bf16 v[152:155], a[60:63], a[16:19], v[152:155]
    buffer_load_dwordx4 a[140:143], v11, s[44:47], s12 offen offset:2048 sc1
    v_mfma_f32_16x16x32_bf16 v[156:159], a[64:67], a[16:19], v[156:159]
    v_mfma_f32_16x16x32_bf16 v[160:163], a[68:71], a[16:19], v[160:163]
    v_mfma_f32_16x16x32_bf16 v[164:167], a[52:55], a[20:23], v[164:167]
    ds_read_b128 a[16:19], v18 offset:2128
    v_mfma_f32_16x16x32_bf16 v[168:171], a[56:59], a[20:23], v[168:171]
    v_mfma_f32_16x16x32_bf16 v[172:175], a[60:63], a[20:23], v[172:175]
    buffer_load_dwordx4 a[144:147], v11, s[44:47], s12 offen offset:3072 sc1
    v_mfma_f32_16x16x32_bf16 v[176:179], a[64:67], a[20:23], v[176:179]
    v_mfma_f32_16x16x32_bf16 v[180:183], a[68:71], a[20:23], v[180:183]
    v_mfma_f32_16x16x32_bf16 v[184:187], a[52:55], a[24:27], v[184:187]
    ds_read_b128 a[20:23], v18 offset:2384
    v_mfma_f32_16x16x32_bf16 v[188:191], a[56:59], a[24:27], v[188:191]
    v_mfma_f32_16x16x32_bf16 v[192:195], a[60:63], a[24:27], v[192:195]
    buffer_load_dwordx4 a[148:151], v1, s[44:47], s12 offen sc1
    v_mfma_f32_16x16x32_bf16 v[196:199], a[64:67], a[24:27], v[196:199]
    v_mfma_f32_16x16x32_bf16 v[200:203], a[68:71], a[24:27], v[200:203]
    v_mfma_f32_16x16x32_bf16 v[204:207], a[52:55], a[28:31], v[204:207]
    ds_read_b128 a[24:27], v19 offset:2128
    v_mfma_f32_16x16x32_bf16 v[208:211], a[56:59], a[28:31], v[208:211]
    v_mfma_f32_16x16x32_bf16 v[212:215], a[60:63], a[28:31], v[212:215]
    s_add_u32 m0, s8, 20592
    s_add_u32 s11, s67, 262144
    buffer_load_dwordx4 v5, s[40:43], s11 offen sc1 lds
    v_mfma_f32_16x16x32_bf16 v[216:219], a[64:67], a[28:31], v[216:219]
    v_mfma_f32_16x16x32_bf16 v[220:223], a[68:71], a[28:31], v[220:223]
    s_waitcnt vmcnt(15)
    s_waitcnt lgkmcnt(3)
    v_mfma_f32_16x16x32_bf16 v[64:67], a[72:75], a[0:3], v[64:67]
    ds_read_b128 a[28:31], v19 offset:2384
    v_mfma_f32_16x16x32_bf16 v[68:71], a[76:79], a[0:3], v[68:71]
    v_mfma_f32_16x16x32_bf16 v[72:75], a[80:83], a[0:3], v[72:75]
    s_mov_b64 exec, 1
    buffer_store_dword v10, v46, s[92:95], s87 offen sc1
    s_mov_b64 exec, -1
    v_mfma_f32_16x16x32_bf16 v[76:79], a[84:87], a[0:3], v[76:79]
    v_mfma_f32_16x16x32_bf16 v[80:83], a[88:91], a[0:3], v[80:83]
    v_mfma_f32_16x16x32_bf16 v[84:87], a[72:75], a[4:7], v[84:87]
    ds_read_b128 a[0:3], v16 offset:2144
    v_mfma_f32_16x16x32_bf16 v[88:91], a[76:79], a[4:7], v[88:91]
    v_mfma_f32_16x16x32_bf16 v[92:95], a[80:83], a[4:7], v[92:95]
    s_add_u32 m0, s8, 24944
    s_add_u32 s11, s67, 327680
    buffer_load_dwordx4 v5, s[40:43], s11 offen sc1 lds
    v_mfma_f32_16x16x32_bf16 v[96:99], a[84:87], a[4:7], v[96:99]
    v_mfma_f32_16x16x32_bf16 v[100:103], a[88:91], a[4:7], v[100:103]
    v_mfma_f32_16x16x32_bf16 v[104:107], a[72:75], a[8:11], v[104:107]
    ds_read_b128 a[4:7], v16 offset:2400
    v_mfma_f32_16x16x32_bf16 v[108:111], a[76:79], a[8:11], v[108:111]
    v_mfma_f32_16x16x32_bf16 v[112:115], a[80:83], a[8:11], v[112:115]
    s_add_u32 m0, s8, 29296
    s_add_u32 s11, s67, 393216
    buffer_load_dwordx4 v5, s[40:43], s11 offen sc1 lds
    v_mfma_f32_16x16x32_bf16 v[116:119], a[84:87], a[8:11], v[116:119]
    v_mfma_f32_16x16x32_bf16 v[120:123], a[88:91], a[8:11], v[120:123]
    v_mfma_f32_16x16x32_bf16 v[124:127], a[72:75], a[12:15], v[124:127]
    ds_read_b128 a[8:11], v17 offset:2144
    v_mfma_f32_16x16x32_bf16 v[128:131], a[76:79], a[12:15], v[128:131]
    v_mfma_f32_16x16x32_bf16 v[132:135], a[80:83], a[12:15], v[132:135]
    s_add_u32 m0, s8, 33648
    s_add_u32 s11, s67, 458752
    buffer_load_dwordx4 v5, s[40:43], s11 offen sc1 lds
    v_mfma_f32_16x16x32_bf16 v[136:139], a[84:87], a[12:15], v[136:139]
    v_mfma_f32_16x16x32_bf16 v[140:143], a[88:91], a[12:15], v[140:143]
    s_waitcnt lgkmcnt(3)
    v_mfma_f32_16x16x32_bf16 v[144:147], a[72:75], a[16:19], v[144:147]
    ds_read_b128 a[12:15], v17 offset:2400
    v_mfma_f32_16x16x32_bf16 v[148:151], a[76:79], a[16:19], v[148:151]
    v_mfma_f32_16x16x32_bf16 v[152:155], a[80:83], a[16:19], v[152:155]
    s_add_u32 s12, s10, 71680
    buffer_load_dwordx4 a[152:155], v11, s[44:47], s12 offen offset:0 sc1
    v_mfma_f32_16x16x32_bf16 v[156:159], a[84:87], a[16:19], v[156:159]
    v_mfma_f32_16x16x32_bf16 v[160:163], a[88:91], a[16:19], v[160:163]
    v_mfma_f32_16x16x32_bf16 v[164:167], a[72:75], a[20:23], v[164:167]
    ds_read_b128 a[16:19], v18 offset:2144
    v_mfma_f32_16x16x32_bf16 v[168:171], a[76:79], a[20:23], v[168:171]
    v_mfma_f32_16x16x32_bf16 v[172:175], a[80:83], a[20:23], v[172:175]
    buffer_load_dwordx4 a[156:159], v11, s[44:47], s12 offen offset:1024 sc1
    v_mfma_f32_16x16x32_bf16 v[176:179], a[84:87], a[20:23], v[176:179]
    v_mfma_f32_16x16x32_bf16 v[180:183], a[88:91], a[20:23], v[180:183]
    v_mfma_f32_16x16x32_bf16 v[184:187], a[72:75], a[24:27], v[184:187]
    ds_read_b128 a[20:23], v18 offset:2400
    v_mfma_f32_16x16x32_bf16 v[188:191], a[76:79], a[24:27], v[188:191]
    v_mfma_f32_16x16x32_bf16 v[192:195], a[80:83], a[24:27], v[192:195]
    buffer_load_dwordx4 a[160:163], v11, s[44:47], s12 offen offset:2048 sc1
    v_mfma_f32_16x16x32_bf16 v[196:199], a[84:87], a[24:27], v[196:199]
    v_mfma_f32_16x16x32_bf16 v[200:203], a[88:91], a[24:27], v[200:203]
    v_mfma_f32_16x16x32_bf16 v[204:207], a[72:75], a[28:31], v[204:207]
    ds_read_b128 a[24:27], v19 offset:2144
    v_mfma_f32_16x16x32_bf16 v[208:211], a[76:79], a[28:31], v[208:211]
    v_mfma_f32_16x16x32_bf16 v[212:215], a[80:83], a[28:31], v[212:215]
    buffer_load_dwordx4 a[164:167], v11, s[44:47], s12 offen offset:3072 sc1
    v_mfma_f32_16x16x32_bf16 v[216:219], a[84:87], a[28:31], v[216:219]
    v_mfma_f32_16x16x32_bf16 v[220:223], a[88:91], a[28:31], v[220:223]
    ds_read_b128 a[28:31], v19 offset:2400
    s_waitcnt vmcnt(19)
    s_waitcnt lgkmcnt(4)
    v_mfma_f32_16x16x32_bf16 v[64:67], a[92:95], a[0:3], v[64:67]
    v_mfma_f32_16x16x32_bf16 v[68:71], a[96:99], a[0:3], v[68:71]
    v_mfma_f32_16x16x32_bf16 v[72:75], a[100:103], a[0:3], v[72:75]
    buffer_load_dwordx4 a[168:171], v1, s[44:47], s12 offen sc1
    v_mfma_f32_16x16x32_bf16 v[76:79], a[104:107], a[0:3], v[76:79]
    v_mfma_f32_16x16x32_bf16 v[80:83], a[108:111], a[0:3], v[80:83]
    buffer_load_dwordx2 v[224:225], v12, s[52:55], 0 offen offset:0
    v_mfma_f32_16x16x32_bf16 v[84:87], a[92:95], a[4:7], v[84:87]
    ds_read_b128 a[0:3], v16 offset:17408
    v_mfma_f32_16x16x32_bf16 v[88:91], a[96:99], a[4:7], v[88:91]
    v_mfma_f32_16x16x32_bf16 v[92:95], a[100:103], a[4:7], v[92:95]
    buffer_load_dwordx2 v[226:227], v12, s[52:55], 0 offen offset:32
    v_mfma_f32_16x16x32_bf16 v[96:99], a[104:107], a[4:7], v[96:99]
    v_mfma_f32_16x16x32_bf16 v[100:103], a[108:111], a[4:7], v[100:103]
    buffer_load_dwordx2 v[228:229], v12, s[52:55], 0 offen offset:64
    v_mfma_f32_16x16x32_bf16 v[104:107], a[92:95], a[8:11], v[104:107]
    ds_read_b128 a[4:7], v16 offset:17664
    v_mfma_f32_16x16x32_bf16 v[108:111], a[96:99], a[8:11], v[108:111]
    v_mfma_f32_16x16x32_bf16 v[112:115], a[100:103], a[8:11], v[112:115]
    buffer_load_dwordx2 v[230:231], v12, s[52:55], 0 offen offset:96
    v_mfma_f32_16x16x32_bf16 v[116:119], a[104:107], a[8:11], v[116:119]
    v_mfma_f32_16x16x32_bf16 v[120:123], a[108:111], a[8:11], v[120:123]
    buffer_load_dwordx2 v[232:233], v12, s[52:55], 0 offen offset:128
    v_mfma_f32_16x16x32_bf16 v[124:127], a[92:95], a[12:15], v[124:127]
    ds_read_b128 a[8:11], v17 offset:17408
    v_mfma_f32_16x16x32_bf16 v[128:131], a[96:99], a[12:15], v[128:131]
    v_mfma_f32_16x16x32_bf16 v[132:135], a[100:103], a[12:15], v[132:135]
    s_add_u32 s12, s10, 76800
    buffer_load_dwordx4 a[172:175], v11, s[44:47], s12 offen offset:0 sc1
    v_mfma_f32_16x16x32_bf16 v[136:139], a[104:107], a[12:15], v[136:139]
    v_mfma_f32_16x16x32_bf16 v[140:143], a[108:111], a[12:15], v[140:143]
    s_waitcnt lgkmcnt(3)
    v_mfma_f32_16x16x32_bf16 v[144:147], a[92:95], a[16:19], v[144:147]
    ds_read_b128 a[12:15], v17 offset:17664
    v_mfma_f32_16x16x32_bf16 v[148:151], a[96:99], a[16:19], v[148:151]
    v_mfma_f32_16x16x32_bf16 v[152:155], a[100:103], a[16:19], v[152:155]
    buffer_load_dwordx4 a[176:179], v11, s[44:47], s12 offen offset:1024 sc1
    v_mfma_f32_16x16x32_bf16 v[156:159], a[104:107], a[16:19], v[156:159]
    v_mfma_f32_16x16x32_bf16 v[160:163], a[108:111], a[16:19], v[160:163]
    buffer_load_dwordx4 a[180:183], v11, s[44:47], s12 offen offset:2048 sc1
    v_mfma_f32_16x16x32_bf16 v[164:167], a[92:95], a[20:23], v[164:167]
    ds_read_b128 a[16:19], v18 offset:17408
    v_mfma_f32_16x16x32_bf16 v[168:171], a[96:99], a[20:23], v[168:171]
    v_mfma_f32_16x16x32_bf16 v[172:175], a[100:103], a[20:23], v[172:175]
    buffer_load_dwordx4 a[184:187], v11, s[44:47], s12 offen offset:3072 sc1
    v_mfma_f32_16x16x32_bf16 v[176:179], a[104:107], a[20:23], v[176:179]
    v_mfma_f32_16x16x32_bf16 v[180:183], a[108:111], a[20:23], v[180:183]
    buffer_load_dwordx4 a[188:191], v1, s[44:47], s12 offen sc1
    v_mfma_f32_16x16x32_bf16 v[184:187], a[92:95], a[24:27], v[184:187]
    ds_read_b128 a[20:23], v18 offset:17664
    v_mfma_f32_16x16x32_bf16 v[188:191], a[96:99], a[24:27], v[188:191]
    v_mfma_f32_16x16x32_bf16 v[192:195], a[100:103], a[24:27], v[192:195]
    buffer_load_dwordx2 v[234:235], v12, s[56:59], 0 offen offset:0
    v_mfma_f32_16x16x32_bf16 v[196:199], a[104:107], a[24:27], v[196:199]
    v_mfma_f32_16x16x32_bf16 v[200:203], a[108:111], a[24:27], v[200:203]
    buffer_load_dwordx2 v[236:237], v12, s[56:59], 0 offen offset:32
    v_mfma_f32_16x16x32_bf16 v[204:207], a[92:95], a[28:31], v[204:207]
    ds_read_b128 a[24:27], v19 offset:17408
    v_mfma_f32_16x16x32_bf16 v[208:211], a[96:99], a[28:31], v[208:211]
    v_mfma_f32_16x16x32_bf16 v[212:215], a[100:103], a[28:31], v[212:215]
    buffer_load_dwordx2 v[238:239], v12, s[56:59], 0 offen offset:64
    v_mfma_f32_16x16x32_bf16 v[216:219], a[104:107], a[28:31], v[216:219]
    v_mfma_f32_16x16x32_bf16 v[220:223], a[108:111], a[28:31], v[220:223]
    s_waitcnt vmcnt(28) lgkmcnt(3)
    v_mfma_f32_16x16x32_bf16 v[64:67], a[112:115], a[0:3], v[64:67]
    ds_read_b128 a[28:31], v19 offset:17664
    v_mfma_f32_16x16x32_bf16 v[68:71], a[116:119], a[0:3], v[68:71]
    v_mfma_f32_16x16x32_bf16 v[72:75], a[120:123], a[0:3], v[72:75]
    buffer_load_dwordx2 v[240:241], v12, s[56:59], 0 offen offset:96
    v_mfma_f32_16x16x32_bf16 v[76:79], a[124:127], a[0:3], v[76:79]
    v_mfma_f32_16x16x32_bf16 v[80:83], a[128:131], a[0:3], v[80:83]
    v_mfma_f32_16x16x32_bf16 v[84:87], a[112:115], a[4:7], v[84:87]
    ds_read_b128 a[0:3], v16 offset:17424
    v_mfma_f32_16x16x32_bf16 v[88:91], a[116:119], a[4:7], v[88:91]
    buffer_load_dwordx2 v[242:243], v12, s[56:59], 0 offen offset:128
    v_mfma_f32_16x16x32_bf16 v[92:95], a[120:123], a[4:7], v[92:95]
    v_mfma_f32_16x16x32_bf16 v[96:99], a[124:127], a[4:7], v[96:99]
    buffer_load_dwordx2 v[244:245], v0, s[96:99], 0 offen offset:1024 sc1
    v_mfma_f32_16x16x32_bf16 v[100:103], a[128:131], a[4:7], v[100:103]
    v_mfma_f32_16x16x32_bf16 v[104:107], a[112:115], a[8:11], v[104:107]
    ds_read_b128 a[4:7], v16 offset:17680
    v_mfma_f32_16x16x32_bf16 v[108:111], a[116:119], a[8:11], v[108:111]
    v_mfma_f32_16x16x32_bf16 v[112:115], a[120:123], a[8:11], v[112:115]
    s_add_u32 s12, s10, 81920
    buffer_load_dwordx4 a[32:35], v11, s[44:47], s12 offen offset:0 sc1
    v_mfma_f32_16x16x32_bf16 v[116:119], a[124:127], a[8:11], v[116:119]
    v_mfma_f32_16x16x32_bf16 v[120:123], a[128:131], a[8:11], v[120:123]
    v_mfma_f32_16x16x32_bf16 v[124:127], a[112:115], a[12:15], v[124:127]
    ds_read_b128 a[8:11], v17 offset:17424
    v_mfma_f32_16x16x32_bf16 v[128:131], a[116:119], a[12:15], v[128:131]
    buffer_load_dwordx4 a[36:39], v11, s[44:47], s12 offen offset:1024 sc1
    v_mfma_f32_16x16x32_bf16 v[132:135], a[120:123], a[12:15], v[132:135]
    v_mfma_f32_16x16x32_bf16 v[136:139], a[124:127], a[12:15], v[136:139]
    v_mfma_f32_16x16x32_bf16 v[140:143], a[128:131], a[12:15], v[140:143]
    s_waitcnt lgkmcnt(3)
    v_mfma_f32_16x16x32_bf16 v[144:147], a[112:115], a[16:19], v[144:147]
    ds_read_b128 a[12:15], v17 offset:17680
    v_mfma_f32_16x16x32_bf16 v[148:151], a[116:119], a[16:19], v[148:151]
    buffer_load_dwordx4 a[40:43], v11, s[44:47], s12 offen offset:2048 sc1
    v_mfma_f32_16x16x32_bf16 v[152:155], a[120:123], a[16:19], v[152:155]
    v_mfma_f32_16x16x32_bf16 v[156:159], a[124:127], a[16:19], v[156:159]
    buffer_load_dwordx4 a[44:47], v11, s[44:47], s12 offen offset:3072 sc1
    v_mfma_f32_16x16x32_bf16 v[160:163], a[128:131], a[16:19], v[160:163]
    v_mfma_f32_16x16x32_bf16 v[164:167], a[112:115], a[20:23], v[164:167]
    ds_read_b128 a[16:19], v18 offset:17424
    v_mfma_f32_16x16x32_bf16 v[168:171], a[116:119], a[20:23], v[168:171]
    v_mfma_f32_16x16x32_bf16 v[172:175], a[120:123], a[20:23], v[172:175]
    buffer_load_dwordx4 a[48:51], v1, s[44:47], s12 offen sc1
    v_mfma_f32_16x16x32_bf16 v[176:179], a[124:127], a[20:23], v[176:179]
    v_mfma_f32_16x16x32_bf16 v[180:183], a[128:131], a[20:23], v[180:183]
    v_mfma_f32_16x16x32_bf16 v[184:187], a[112:115], a[24:27], v[184:187]
    ds_read_b128 a[20:23], v18 offset:17680
    v_mfma_f32_16x16x32_bf16 v[188:191], a[116:119], a[24:27], v[188:191]
    s_mov_b64 exec, 0xfff
    buffer_load_dword v249, v249, s[92:95], 0 offen sc1
    s_mov_b64 exec, -1
    v_mfma_f32_16x16x32_bf16 v[192:195], a[120:123], a[24:27], v[192:195]
    v_mfma_f32_16x16x32_bf16 v[196:199], a[124:127], a[24:27], v[196:199]
    s_add_u32 m0, s8, 16
    s_add_u32 s11, s64, 524288
    buffer_load_dwordx4 v4, s[40:43], s11 offen sc1 lds
    v_mfma_f32_16x16x32_bf16 v[200:203], a[128:131], a[24:27], v[200:203]
    v_mfma_f32_16x16x32_bf16 v[204:207], a[112:115], a[28:31], v[204:207]
    ds_read_b128 a[24:27], v19 offset:17424
    v_mfma_f32_16x16x32_bf16 v[208:211], a[116:119], a[28:31], v[208:211]
    v_mfma_f32_16x16x32_bf16 v[212:215], a[120:123], a[28:31], v[212:215]
    s_add_u32 m0, s8, 1072
    s_add_u32 s11, s65, 524288
    buffer_load_dwordx4 v11, s[40:43], s11 offen sc1 lds
    v_mfma_f32_16x16x32_bf16 v[216:219], a[124:127], a[28:31], v[216:219]
    v_mfma_f32_16x16x32_bf16 v[220:223], a[128:131], a[28:31], v[220:223]
    s_waitcnt vmcnt(34) lgkmcnt(3)
    v_mfma_f32_16x16x32_bf16 v[64:67], a[132:135], a[0:3], v[64:67]
    ds_read_b128 a[28:31], v19 offset:17680
    v_mfma_f32_16x16x32_bf16 v[68:71], a[136:139], a[0:3], v[68:71]
    v_mfma_f32_16x16x32_bf16 v[72:75], a[140:143], a[0:3], v[72:75]
    s_add_u32 m0, s8, 2128
    s_add_u32 s11, s66, 524288
    buffer_load_dwordx4 v11, s[40:43], s11 offen sc1 lds
    v_mfma_f32_16x16x32_bf16 v[76:79], a[144:147], a[0:3], v[76:79]
    v_mfma_f32_16x16x32_bf16 v[80:83], a[148:151], a[0:3], v[80:83]
    v_mfma_f32_16x16x32_bf16 v[84:87], a[132:135], a[4:7], v[84:87]
    ds_read_b128 a[0:3], v16 offset:17440
    v_mfma_f32_16x16x32_bf16 v[88:91], a[136:139], a[4:7], v[88:91]
    v_mfma_f32_16x16x32_bf16 v[92:95], a[140:143], a[4:7], v[92:95]
    s_add_u32 m0, s8, 4368
    s_add_u32 s11, s64, 589824
    buffer_load_dwordx4 v4, s[40:43], s11 offen sc1 lds
    v_mfma_f32_16x16x32_bf16 v[96:99], a[144:147], a[4:7], v[96:99]
    v_mfma_f32_16x16x32_bf16 v[100:103], a[148:151], a[4:7], v[100:103]
    v_mfma_f32_16x16x32_bf16 v[104:107], a[132:135], a[8:11], v[104:107]
    ds_read_b128 a[4:7], v16 offset:17696
    v_mfma_f32_16x16x32_bf16 v[108:111], a[136:139], a[8:11], v[108:111]
    v_mfma_f32_16x16x32_bf16 v[112:115], a[140:143], a[8:11], v[112:115]
    s_add_u32 m0, s8, 5424
    s_add_u32 s11, s65, 589824
    buffer_load_dwordx4 v11, s[40:43], s11 offen sc1 lds
    v_mfma_f32_16x16x32_bf16 v[116:119], a[144:147], a[8:11], v[116:119]
    v_mfma_f32_16x16x32_bf16 v[120:123], a[148:151], a[8:11], v[120:123]
    v_mfma_f32_16x16x32_bf16 v[124:127], a[132:135], a[12:15], v[124:127]
    ds_read_b128 a[8:11], v17 offset:17440
    v_mfma_f32_16x16x32_bf16 v[128:131], a[136:139], a[12:15], v[128:131]
    v_mfma_f32_16x16x32_bf16 v[132:135], a[140:143], a[12:15], v[132:135]
    s_add_u32 m0, s8, 6480
    s_add_u32 s11, s66, 589824
    buffer_load_dwordx4 v11, s[40:43], s11 offen sc1 lds
    v_mfma_f32_16x16x32_bf16 v[136:139], a[144:147], a[12:15], v[136:139]
    v_mfma_f32_16x16x32_bf16 v[140:143], a[148:151], a[12:15], v[140:143]
    s_waitcnt lgkmcnt(3)
    v_mfma_f32_16x16x32_bf16 v[144:147], a[132:135], a[16:19], v[144:147]
    ds_read_b128 a[12:15], v17 offset:17696
    v_mfma_f32_16x16x32_bf16 v[148:151], a[136:139], a[16:19], v[148:151]
    v_mfma_f32_16x16x32_bf16 v[152:155], a[140:143], a[16:19], v[152:155]
    s_add_u32 s12, s10, 87040
    buffer_load_dwordx4 a[52:55], v11, s[44:47], s12 offen offset:0 sc1
    v_mfma_f32_16x16x32_bf16 v[156:159], a[144:147], a[16:19], v[156:159]
    v_mfma_f32_16x16x32_bf16 v[160:163], a[148:151], a[16:19], v[160:163]
    v_mfma_f32_16x16x32_bf16 v[164:167], a[132:135], a[20:23], v[164:167]
    ds_read_b128 a[16:19], v18 offset:17440
    v_mfma_f32_16x16x32_bf16 v[168:171], a[136:139], a[20:23], v[168:171]
    v_mfma_f32_16x16x32_bf16 v[172:175], a[140:143], a[20:23], v[172:175]
    buffer_load_dwordx4 a[56:59], v11, s[44:47], s12 offen offset:1024 sc1
    v_mfma_f32_16x16x32_bf16 v[176:179], a[144:147], a[20:23], v[176:179]
    v_mfma_f32_16x16x32_bf16 v[180:183], a[148:151], a[20:23], v[180:183]
    v_mfma_f32_16x16x32_bf16 v[184:187], a[132:135], a[24:27], v[184:187]
    ds_read_b128 a[20:23], v18 offset:17696
    v_mfma_f32_16x16x32_bf16 v[188:191], a[136:139], a[24:27], v[188:191]
    v_mfma_f32_16x16x32_bf16 v[192:195], a[140:143], a[24:27], v[192:195]
    buffer_load_dwordx4 a[60:63], v11, s[44:47], s12 offen offset:2048 sc1
    v_mfma_f32_16x16x32_bf16 v[196:199], a[144:147], a[24:27], v[196:199]
    v_mfma_f32_16x16x32_bf16 v[200:203], a[148:151], a[24:27], v[200:203]
    v_mfma_f32_16x16x32_bf16 v[204:207], a[132:135], a[28:31], v[204:207]
    ds_read_b128 a[24:27], v19 offset:17440
    v_mfma_f32_16x16x32_bf16 v[208:211], a[136:139], a[28:31], v[208:211]
    v_mfma_f32_16x16x32_bf16 v[212:215], a[140:143], a[28:31], v[212:215]
    buffer_load_dwordx4 a[64:67], v11, s[44:47], s12 offen offset:3072 sc1
    v_mfma_f32_16x16x32_bf16 v[216:219], a[144:147], a[28:31], v[216:219]
    v_mfma_f32_16x16x32_bf16 v[220:223], a[148:151], a[28:31], v[220:223]
    s_waitcnt vmcnt(32)
    s_waitcnt lgkmcnt(3)
    v_mfma_f32_16x16x32_bf16 v[64:67], a[152:155], a[0:3], v[64:67]
    ds_read_b128 a[28:31], v19 offset:17696
    v_mfma_f32_16x16x32_bf16 v[68:71], a[156:159], a[0:3], v[68:71]
    v_mfma_f32_16x16x32_bf16 v[72:75], a[160:163], a[0:3], v[72:75]
    ds_read_b128 a[192:195], v19 offset:19520
    v_mfma_f32_16x16x32_bf16 v[76:79], a[164:167], a[0:3], v[76:79]
    s_mov_b64 exec, 0xfffff
    buffer_load_dword v56, v47, s[92:95], s87 offen sc1
    s_mov_b64 exec, -1
    v_mfma_f32_16x16x32_bf16 v[80:83], a[168:171], a[0:3], v[80:83]
    v_mfma_f32_16x16x32_bf16 v[84:87], a[152:155], a[4:7], v[84:87]
    ds_read_b128 a[0:3], v16 offset:19520
    v_mfma_f32_16x16x32_bf16 v[88:91], a[156:159], a[4:7], v[88:91]
    v_mfma_f32_16x16x32_bf16 v[92:95], a[160:163], a[4:7], v[92:95]
    ds_read_b128 a[196:199], v19 offset:19776
    v_mfma_f32_16x16x32_bf16 v[96:99], a[164:167], a[4:7], v[96:99]
    v_mfma_f32_16x16x32_bf16 v[100:103], a[168:171], a[4:7], v[100:103]
    buffer_load_dwordx4 a[68:71], v1, s[44:47], s12 offen sc1
    v_mfma_f32_16x16x32_bf16 v[104:107], a[152:155], a[8:11], v[104:107]
    ds_read_b128 a[4:7], v16 offset:19776
    v_mfma_f32_16x16x32_bf16 v[108:111], a[156:159], a[8:11], v[108:111]
    v_mfma_f32_16x16x32_bf16 v[112:115], a[160:163], a[8:11], v[112:115]
    v_mfma_f32_16x16x32_bf16 v[116:119], a[164:167], a[8:11], v[116:119]
    s_add_u32 m0, s8, 3184
    s_add_u32 s11, s67, 524288
    buffer_load_dwordx4 v5, s[40:43], s11 offen sc1 lds
    v_mfma_f32_16x16x32_bf16 v[120:123], a[168:171], a[8:11], v[120:123]
    v_mfma_f32_16x16x32_bf16 v[124:127], a[152:155], a[12:15], v[124:127]
    ds_read_b128 a[8:11], v17 offset:19520
    v_mfma_f32_16x16x32_bf16 v[128:131], a[156:159], a[12:15], v[128:131]
    v_mfma_f32_16x16x32_bf16 v[132:135], a[160:163], a[12:15], v[132:135]
    v_mfma_f32_16x16x32_bf16 v[136:139], a[164:167], a[12:15], v[136:139]
    s_add_u32 m0, s8, 7536
    s_add_u32 s11, s67, 589824
    buffer_load_dwordx4 v5, s[40:43], s11 offen sc1 lds
    v_mfma_f32_16x16x32_bf16 v[140:143], a[168:171], a[12:15], v[140:143]
    s_waitcnt lgkmcnt(5)
    v_mfma_f32_16x16x32_bf16 v[144:147], a[152:155], a[16:19], v[144:147]
    ds_read_b128 a[12:15], v17 offset:19776
    v_mfma_f32_16x16x32_bf16 v[148:151], a[156:159], a[16:19], v[148:151]
    v_mfma_f32_16x16x32_bf16 v[152:155], a[160:163], a[16:19], v[152:155]
    v_mfma_f32_16x16x32_bf16 v[156:159], a[164:167], a[16:19], v[156:159]
    s_add_u32 s12, s10, 92160
    buffer_load_dwordx4 a[72:75], v11, s[44:47], s12 offen offset:0 sc1
    v_mfma_f32_16x16x32_bf16 v[160:163], a[168:171], a[16:19], v[160:163]
    v_mfma_f32_16x16x32_bf16 v[164:167], a[152:155], a[20:23], v[164:167]
    ds_read_b128 a[16:19], v18 offset:19520
    v_mfma_f32_16x16x32_bf16 v[168:171], a[156:159], a[20:23], v[168:171]
    v_mfma_f32_16x16x32_bf16 v[172:175], a[160:163], a[20:23], v[172:175]
    v_mfma_f32_16x16x32_bf16 v[176:179], a[164:167], a[20:23], v[176:179]
    buffer_load_dwordx4 a[76:79], v11, s[44:47], s12 offen offset:1024 sc1
    v_mfma_f32_16x16x32_bf16 v[180:183], a[168:171], a[20:23], v[180:183]
    v_mfma_f32_16x16x32_bf16 v[184:187], a[152:155], a[24:27], v[184:187]
    ds_read_b128 a[20:23], v18 offset:19776
    v_mfma_f32_16x16x32_bf16 v[188:191], a[156:159], a[24:27], v[188:191]
    v_mfma_f32_16x16x32_bf16 v[192:195], a[160:163], a[24:27], v[192:195]
    buffer_load_dwordx4 a[80:83], v11, s[44:47], s12 offen offset:2048 sc1
    v_mfma_f32_16x16x32_bf16 v[196:199], a[164:167], a[24:27], v[196:199]
    v_mfma_f32_16x16x32_bf16 v[200:203], a[168:171], a[24:27], v[200:203]
    v_mfma_f32_16x16x32_bf16 v[204:207], a[152:155], a[28:31], v[204:207]
    v_mfma_f32_16x16x32_bf16 v[208:211], a[156:159], a[28:31], v[208:211]
    v_mfma_f32_16x16x32_bf16 v[212:215], a[160:163], a[28:31], v[212:215]
    buffer_load_dwordx4 a[84:87], v11, s[44:47], s12 offen offset:3072 sc1
    v_mfma_f32_16x16x32_bf16 v[216:219], a[164:167], a[28:31], v[216:219]
    v_mfma_f32_16x16x32_bf16 v[220:223], a[168:171], a[28:31], v[220:223]
    s_waitcnt vmcnt(7)
    s_mov_b32 s15, 0
c1_ef_chk:
    v_cmp_eq_u32 vcc, s7, v56
    s_add_u32 s15, s15, 1
    s_and_b32 s14, vcc_lo, 0xfffff
    s_cmp_eq_u32 s14, 0xfffff
    s_cbranch_scc1 c1_ef_ok
    s_cmp_ge_u32 s15, 0x40000
    s_cbranch_scc1 c1_ef_ok
    s_sleep 8
    s_mov_b64 exec, 0xfffff
    buffer_load_dword v56, v47, s[92:95], s87 offen sc1
    s_mov_b64 exec, -1
    s_waitcnt vmcnt(0)
    s_branch c1_ef_chk
c1_ef_ok:
    s_waitcnt lgkmcnt(3)
    v_mfma_f32_16x16x32_bf16 v[64:67], a[172:175], a[0:3], v[64:67]
    v_mfma_f32_16x16x32_bf16 v[68:71], a[176:179], a[0:3], v[68:71]
    buffer_load_dwordx4 v[24:27], v3, s[92:95], s48 offen offset:0 sc1
    v_mfma_f32_16x16x32_bf16 v[72:75], a[180:183], a[0:3], v[72:75]
    ds_read_b128 a[200:203], v19 offset:19536
    v_mfma_f32_16x16x32_bf16 v[76:79], a[184:187], a[0:3], v[76:79]
    v_mfma_f32_16x16x32_bf16 v[80:83], a[188:191], a[0:3], v[80:83]
    buffer_load_dwordx4 v[28:31], v3, s[92:95], s48 offen offset:64 sc1
    v_mfma_f32_16x16x32_bf16 v[84:87], a[172:175], a[4:7], v[84:87]
    ds_read_b128 a[0:3], v16 offset:19536
    v_mfma_f32_16x16x32_bf16 v[88:91], a[176:179], a[4:7], v[88:91]
    v_mfma_f32_16x16x32_bf16 v[92:95], a[180:183], a[4:7], v[92:95]
    ds_read_b128 a[204:207], v19 offset:19792
    v_mfma_f32_16x16x32_bf16 v[96:99], a[184:187], a[4:7], v[96:99]
    buffer_load_dwordx4 v[32:35], v3, s[92:95], s48 offen offset:128 sc1
    v_mfma_f32_16x16x32_bf16 v[100:103], a[188:191], a[4:7], v[100:103]
    v_mfma_f32_16x16x32_bf16 v[104:107], a[172:175], a[8:11], v[104:107]
    ds_read_b128 a[4:7], v16 offset:19792
    v_mfma_f32_16x16x32_bf16 v[108:111], a[176:179], a[8:11], v[108:111]
    buffer_load_dwordx4 v[36:39], v3, s[92:95], s48 offen offset:192 sc1
    v_mfma_f32_16x16x32_bf16 v[112:115], a[180:183], a[8:11], v[112:115]
    v_mfma_f32_16x16x32_bf16 v[116:119], a[184:187], a[8:11], v[116:119]
    buffer_load_dwordx4 v[40:43], v3, s[92:95], s48 offen offset:256 sc1
    v_mfma_f32_16x16x32_bf16 v[120:123], a[188:191], a[8:11], v[120:123]
    s_waitcnt lgkmcnt(4)
    v_mfma_f32_16x16x32_bf16 v[124:127], a[172:175], a[12:15], v[124:127]
    ds_read_b128 a[8:11], v17 offset:19536
    v_mfma_f32_16x16x32_bf16 v[128:131], a[176:179], a[12:15], v[128:131]
    v_mfma_f32_16x16x32_bf16 v[132:135], a[180:183], a[12:15], v[132:135]
    buffer_load_dwordx4 a[88:91], v1, s[44:47], s12 offen sc1
    v_mfma_f32_16x16x32_bf16 v[136:139], a[184:187], a[12:15], v[136:139]
    s_add_u32 s12, s10, 97280
    buffer_load_dwordx4 a[92:95], v11, s[44:47], s12 offen offset:0 sc1
    v_mfma_f32_16x16x32_bf16 v[140:143], a[188:191], a[12:15], v[140:143]
    v_mfma_f32_16x16x32_bf16 v[144:147], a[172:175], a[16:19], v[144:147]
    ds_read_b128 a[12:15], v17 offset:19792
    v_mfma_f32_16x16x32_bf16 v[148:151], a[176:179], a[16:19], v[148:151]
    buffer_load_dwordx4 a[96:99], v11, s[44:47], s12 offen offset:1024 sc1
    v_mfma_f32_16x16x32_bf16 v[152:155], a[180:183], a[16:19], v[152:155]
    v_mfma_f32_16x16x32_bf16 v[156:159], a[184:187], a[16:19], v[156:159]
    buffer_load_dwordx4 a[100:103], v11, s[44:47], s12 offen offset:2048 sc1
    v_mfma_f32_16x16x32_bf16 v[160:163], a[188:191], a[16:19], v[160:163]
    v_mfma_f32_16x16x32_bf16 v[164:167], a[172:175], a[20:23], v[164:167]
    ds_read_b128 a[16:19], v18 offset:19536
    v_mfma_f32_16x16x32_bf16 v[168:171], a[176:179], a[20:23], v[168:171]
    buffer_load_dwordx4 a[104:107], v11, s[44:47], s12 offen offset:3072 sc1
    v_mfma_f32_16x16x32_bf16 v[172:175], a[180:183], a[20:23], v[172:175]
    v_mfma_f32_16x16x32_bf16 v[176:179], a[184:187], a[20:23], v[176:179]
    buffer_load_dwordx4 a[108:111], v1, s[44:47], s12 offen sc1
    v_mfma_f32_16x16x32_bf16 v[180:183], a[188:191], a[20:23], v[180:183]
    s_waitcnt lgkmcnt(2)
    v_mfma_f32_16x16x32_bf16 v[64:67], a[32:35], a[0:3], v[64:67]
    ds_read_b128 a[20:23], v18 offset:19792
    v_mfma_f32_16x16x32_bf16 v[68:71], a[36:39], a[0:3], v[68:71]
    v_mfma_f32_16x16x32_bf16 v[72:75], a[40:43], a[0:3], v[72:75]
    ds_read_b128 a[208:211], v19 offset:19552
    v_mfma_f32_16x16x32_bf16 v[76:79], a[44:47], a[0:3], v[76:79]
    s_add_u32 s12, s10, 102400
    buffer_load_dwordx4 a[112:115], v11, s[44:47], s12 offen offset:0 sc1
    v_mfma_f32_16x16x32_bf16 v[80:83], a[48:51], a[0:3], v[80:83]
    v_mfma_f32_16x16x32_bf16 v[84:87], a[32:35], a[4:7], v[84:87]
    ds_read_b128 a[0:3], v16 offset:19552
    v_mfma_f32_16x16x32_bf16 v[88:91], a[36:39], a[4:7], v[88:91]
    buffer_load_dwordx4 a[116:119], v11, s[44:47], s12 offen offset:1024 sc1
    v_mfma_f32_16x16x32_bf16 v[92:95], a[40:43], a[4:7], v[92:95]
    ds_read_b128 a[212:215], v19 offset:19808
    v_mfma_f32_16x16x32_bf16 v[96:99], a[44:47], a[4:7], v[96:99]
    v_mfma_f32_16x16x32_bf16 v[100:103], a[48:51], a[4:7], v[100:103]
    v_mfma_f32_16x16x32_bf16 v[104:107], a[32:35], a[8:11], v[104:107]
    ds_read_b128 a[4:7], v16 offset:19808
    v_mfma_f32_16x16x32_bf16 v[108:111], a[36:39], a[8:11], v[108:111]
    buffer_load_dwordx4 a[120:123], v11, s[44:47], s12 offen offset:2048 sc1
    v_mfma_f32_16x16x32_bf16 v[112:115], a[40:43], a[8:11], v[112:115]
    v_mfma_f32_16x16x32_bf16 v[116:119], a[44:47], a[8:11], v[116:119]
    buffer_load_dwordx4 a[124:127], v11, s[44:47], s12 offen offset:3072 sc1
    v_mfma_f32_16x16x32_bf16 v[120:123], a[48:51], a[8:11], v[120:123]
    s_waitcnt lgkmcnt(4)
    v_mfma_f32_16x16x32_bf16 v[124:127], a[32:35], a[12:15], v[124:127]
    ds_read_b128 a[8:11], v17 offset:19552
    v_mfma_f32_16x16x32_bf16 v[128:131], a[36:39], a[12:15], v[128:131]
    v_mfma_f32_16x16x32_bf16 v[132:135], a[40:43], a[12:15], v[132:135]
    v_mfma_f32_16x16x32_bf16 v[136:139], a[44:47], a[12:15], v[136:139]
    buffer_load_dwordx4 a[128:131], v1, s[44:47], s12 offen sc1
    v_mfma_f32_16x16x32_bf16 v[140:143], a[48:51], a[12:15], v[140:143]
    v_mfma_f32_16x16x32_bf16 v[144:147], a[32:35], a[16:19], v[144:147]
    ds_read_b128 a[12:15], v17 offset:19808
    v_mfma_f32_16x16x32_bf16 v[148:151], a[36:39], a[16:19], v[148:151]
    s_add_u32 s12, s10, 107520
    buffer_load_dwordx4 a[132:135], v11, s[44:47], s12 offen offset:0 sc1
    v_mfma_f32_16x16x32_bf16 v[152:155], a[40:43], a[16:19], v[152:155]
    v_mfma_f32_16x16x32_bf16 v[156:159], a[44:47], a[16:19], v[156:159]
    v_mfma_f32_16x16x32_bf16 v[160:163], a[48:51], a[16:19], v[160:163]
    buffer_load_dwordx4 a[136:139], v11, s[44:47], s12 offen offset:1024 sc1
    v_mfma_f32_16x16x32_bf16 v[164:167], a[32:35], a[20:23], v[164:167]
    ds_read_b128 a[16:19], v18 offset:19552
    v_mfma_f32_16x16x32_bf16 v[168:171], a[36:39], a[20:23], v[168:171]
    v_mfma_f32_16x16x32_bf16 v[172:175], a[40:43], a[20:23], v[172:175]
    buffer_load_dwordx4 a[140:143], v11, s[44:47], s12 offen offset:2048 sc1
    v_mfma_f32_16x16x32_bf16 v[176:179], a[44:47], a[20:23], v[176:179]
    v_mfma_f32_16x16x32_bf16 v[180:183], a[48:51], a[20:23], v[180:183]
    ds_read_b128 a[20:23], v18 offset:19808
    s_waitcnt vmcnt(14)
    v_add_u32 v16, v16, v13
    v_add_u32 v17, v17, v13
    v_add_u32 v18, v18, v13
    v_add_u32 v19, v19, v13
    s_waitcnt lgkmcnt(3)
    v_mfma_f32_16x16x32_bf16 v[64:67], a[52:55], a[0:3], v[64:67]
    v_mfma_f32_16x16x32_bf16 v[68:71], a[56:59], a[0:3], v[68:71]
    v_add_f32 v184, v184, v24
    v_add_f32 v185, v185, v25
    v_mfma_f32_16x16x32_bf16 v[72:75], a[60:63], a[0:3], v[72:75]
    ds_read_b128 a[216:219], v19 offset:32
    v_mfma_f32_16x16x32_bf16 v[76:79], a[64:67], a[0:3], v[76:79]
    buffer_load_dwordx4 a[144:147], v11, s[44:47], s12 offen offset:3072 sc1
    v_mfma_f32_16x16x32_bf16 v[80:83], a[68:71], a[0:3], v[80:83]
    v_add_f32 v186, v186, v26
    v_add_f32 v187, v187, v27
    v_mfma_f32_16x16x32_bf16 v[84:87], a[52:55], a[4:7], v[84:87]
    ds_read_b128 a[0:3], v16 offset:32
    v_mfma_f32_16x16x32_bf16 v[88:91], a[56:59], a[4:7], v[88:91]
    v_add_f32 v204, v204, v24
    v_add_f32 v205, v205, v25
    v_mfma_f32_16x16x32_bf16 v[92:95], a[60:63], a[4:7], v[92:95]
    ds_read_b128 a[220:223], v19 offset:288
    v_mfma_f32_16x16x32_bf16 v[96:99], a[64:67], a[4:7], v[96:99]
    buffer_load_dwordx4 a[148:151], v1, s[44:47], s12 offen sc1
    v_mfma_f32_16x16x32_bf16 v[100:103], a[68:71], a[4:7], v[100:103]
    v_add_f32 v206, v206, v26
    v_add_f32 v207, v207, v27
    v_mfma_f32_16x16x32_bf16 v[104:107], a[52:55], a[8:11], v[104:107]
    ds_read_b128 a[4:7], v16 offset:288
    v_mfma_f32_16x16x32_bf16 v[108:111], a[56:59], a[8:11], v[108:111]
    v_add_f32 v188, v188, v28
    v_add_f32 v189, v189, v29
    v_mfma_f32_16x16x32_bf16 v[112:115], a[60:63], a[8:11], v[112:115]
    s_add_u32 s12, s10, 112640
    buffer_load_dwordx4 a[152:155], v11, s[44:47], s12 offen offset:0 sc1
    v_mfma_f32_16x16x32_bf16 v[116:119], a[64:67], a[8:11], v[116:119]
    v_add_f32 v190, v190, v30
    v_add_f32 v191, v191, v31
    v_mfma_f32_16x16x32_bf16 v[120:123], a[68:71], a[8:11], v[120:123]
    s_waitcnt lgkmcnt(4)
    v_mfma_f32_16x16x32_bf16 v[124:127], a[52:55], a[12:15], v[124:127]
    ds_read_b128 a[8:11], v17 offset:32
    v_mfma_f32_16x16x32_bf16 v[128:131], a[56:59], a[12:15], v[128:131]
    v_add_f32 v208, v208, v28
    v_add_f32 v209, v209, v29
    v_mfma_f32_16x16x32_bf16 v[132:135], a[60:63], a[12:15], v[132:135]
    buffer_load_dwordx4 a[156:159], v11, s[44:47], s12 offen offset:1024 sc1
    v_mfma_f32_16x16x32_bf16 v[136:139], a[64:67], a[12:15], v[136:139]
    v_add_f32 v210, v210, v30
    v_add_f32 v211, v211, v31
    v_mfma_f32_16x16x32_bf16 v[140:143], a[68:71], a[12:15], v[140:143]
    buffer_load_dwordx4 a[160:163], v11, s[44:47], s12 offen offset:2048 sc1
    v_mfma_f32_16x16x32_bf16 v[144:147], a[52:55], a[16:19], v[144:147]
    ds_read_b128 a[12:15], v17 offset:288
    v_mfma_f32_16x16x32_bf16 v[148:151], a[56:59], a[16:19], v[148:151]
    v_add_f32 v192, v192, v32
    v_add_f32 v193, v193, v33
    v_mfma_f32_16x16x32_bf16 v[152:155], a[60:63], a[16:19], v[152:155]
    v_add_f32 v194, v194, v34
    v_add_f32 v195, v195, v35
    v_mfma_f32_16x16x32_bf16 v[156:159], a[64:67], a[16:19], v[156:159]
    buffer_load_dwordx4 a[164:167], v11, s[44:47], s12 offen offset:3072 sc1
    v_mfma_f32_16x16x32_bf16 v[160:163], a[68:71], a[16:19], v[160:163]
    v_add_f32 v212, v212, v32
    v_add_f32 v213, v213, v33
    v_mfma_f32_16x16x32_bf16 v[164:167], a[52:55], a[20:23], v[164:167]
    ds_read_b128 a[16:19], v18 offset:32
    v_mfma_f32_16x16x32_bf16 v[168:171], a[56:59], a[20:23], v[168:171]
    v_add_f32 v214, v214, v34
    v_add_f32 v215, v215, v35
    v_mfma_f32_16x16x32_bf16 v[172:175], a[60:63], a[20:23], v[172:175]
    buffer_load_dwordx4 a[168:171], v1, s[44:47], s12 offen sc1
    v_mfma_f32_16x16x32_bf16 v[176:179], a[64:67], a[20:23], v[176:179]
    v_add_f32 v196, v196, v36
    v_add_f32 v197, v197, v37
    v_mfma_f32_16x16x32_bf16 v[180:183], a[68:71], a[20:23], v[180:183]
    ds_read_b128 a[20:23], v18 offset:288
    s_waitcnt vmcnt(20)
    v_add_u32 v16, v16, v14
    v_add_u32 v17, v17, v14
    v_add_u32 v18, v18, v14
    v_add_u32 v19, v19, v14
    v_add_u32 v4, v16, v15
    v_add_u32 v5, v17, v15
    v_add_u32 v6, v18, v15
    v_add_u32 v8, v19, v15
    s_waitcnt lgkmcnt(3)
    v_mfma_f32_16x16x32_bf16 v[64:67], a[72:75], a[0:3], v[64:67]
    v_mfma_f32_16x16x32_bf16 v[68:71], a[76:79], a[0:3], v[68:71]
    v_add_f32 v198, v198, v38
    v_add_f32 v199, v199, v39
    v_mfma_f32_16x16x32_bf16 v[72:75], a[80:83], a[0:3], v[72:75]
    ds_read_b128 a[224:227], v19 offset:2144
    v_mfma_f32_16x16x32_bf16 v[76:79], a[84:87], a[0:3], v[76:79]
    ds_read_b128 a[248:251], v8 offset:2112
    v_mfma_f32_16x16x32_bf16 v[80:83], a[88:91], a[0:3], v[80:83]
    v_add_f32 v216, v216, v36
    v_add_f32 v217, v217, v37
    v_mfma_f32_16x16x32_bf16 v[84:87], a[72:75], a[4:7], v[84:87]
    ds_read_b128 a[0:3], v16 offset:2144
    v_mfma_f32_16x16x32_bf16 v[88:91], a[76:79], a[4:7], v[88:91]
    v_add_f32 v218, v218, v38
    v_add_f32 v219, v219, v39
    v_mfma_f32_16x16x32_bf16 v[92:95], a[80:83], a[4:7], v[92:95]
    ds_read_b128 a[228:231], v19 offset:2400
    v_mfma_f32_16x16x32_bf16 v[96:99], a[84:87], a[4:7], v[96:99]
    ds_read_b128 a[252:255], v8 offset:2368
    v_mfma_f32_16x16x32_bf16 v[100:103], a[88:91], a[4:7], v[100:103]
    v_add_f32 v200, v200, v40
    v_add_f32 v201, v201, v41
    v_mfma_f32_16x16x32_bf16 v[104:107], a[72:75], a[8:11], v[104:107]
    ds_read_b128 a[4:7], v4 offset:0
    v_mfma_f32_16x16x32_bf16 v[108:111], a[76:79], a[8:11], v[108:111]
    v_add_f32 v202, v202, v42
    v_add_f32 v203, v203, v43
    v_mfma_f32_16x16x32_bf16 v[112:115], a[80:83], a[8:11], v[112:115]
    ds_read_b128 a[232:235], v8 offset:0
    v_mfma_f32_16x16x32_bf16 v[116:119], a[84:87], a[8:11], v[116:119]
    v_add_f32 v220, v220, v40
    v_add_f32 v221, v221, v41
    v_mfma_f32_16x16x32_bf16 v[120:123], a[88:91], a[8:11], v[120:123]
    s_waitcnt lgkmcnt(7)
    v_mfma_f32_16x16x32_bf16 v[124:127], a[72:75], a[12:15], v[124:127]
    ds_read_b128 a[8:11], v4 offset:1056
    v_mfma_f32_16x16x32_bf16 v[128:131], a[76:79], a[12:15], v[128:131]
    v_add_f32 v222, v222, v42
    v_add_f32 v223, v223, v43
    v_mfma_f32_16x16x32_bf16 v[132:135], a[80:83], a[12:15], v[132:135]
    ds_read_b128 a[236:239], v8 offset:256
    v_mfma_f32_16x16x32_bf16 v[136:139], a[84:87], a[12:15], v[136:139]
    v_lshlrev_b32 v24, 16, v224
    v_lshlrev_b32 v44, 16, v234
    v_mfma_f32_16x16x32_bf16 v[140:143], a[88:91], a[12:15], v[140:143]
    v_and_b32 v25, 0xffff0000, v224
    v_and_b32 v45, 0xffff0000, v234
    v_mfma_f32_16x16x32_bf16 v[144:147], a[72:75], a[16:19], v[144:147]
    ds_read_b128 a[12:15], v4 offset:2112
    v_mfma_f32_16x16x32_bf16 v[148:151], a[76:79], a[16:19], v[148:151]
    v_lshlrev_b32 v26, 16, v225
    v_lshlrev_b32 v46, 16, v235
    v_mfma_f32_16x16x32_bf16 v[152:155], a[80:83], a[16:19], v[152:155]
    ds_read_b128 a[240:243], v8 offset:1056
    v_mfma_f32_16x16x32_bf16 v[156:159], a[84:87], a[16:19], v[156:159]
    v_and_b32 v27, 0xffff0000, v225
    v_and_b32 v47, 0xffff0000, v235
    v_mfma_f32_16x16x32_bf16 v[160:163], a[88:91], a[16:19], v[160:163]
    v_lshlrev_b32 v28, 16, v226
    v_lshlrev_b32 v48, 16, v236
    v_mfma_f32_16x16x32_bf16 v[164:167], a[72:75], a[20:23], v[164:167]
    v_mfma_f32_16x16x32_bf16 v[168:171], a[76:79], a[20:23], v[168:171]
    v_and_b32 v29, 0xffff0000, v226
    v_and_b32 v49, 0xffff0000, v236
    v_mfma_f32_16x16x32_bf16 v[172:175], a[80:83], a[20:23], v[172:175]
    ds_read_b128 a[244:247], v8 offset:1312
    v_mfma_f32_16x16x32_bf16 v[176:179], a[84:87], a[20:23], v[176:179]
    v_lshlrev_b32 v30, 16, v227
    v_lshlrev_b32 v50, 16, v237
    v_mfma_f32_16x16x32_bf16 v[180:183], a[88:91], a[20:23], v[180:183]
    s_waitcnt vmcnt(0) lgkmcnt(2)
    v_mfma_f32_16x16x32_bf16 v[64:67], a[92:95], a[0:3], v[64:67]
    ds_read_b128 a[16:19], v16 offset:2400
    v_mfma_f32_16x16x32_bf16 v[68:71], a[96:99], a[0:3], v[68:71]
    v_and_b32 v31, 0xffff0000, v227
    v_and_b32 v51, 0xffff0000, v237
    v_mfma_f32_16x16x32_bf16 v[72:75], a[100:103], a[0:3], v[72:75]
    v_lshlrev_b32 v32, 16, v228
    v_lshlrev_b32 v52, 16, v238
    v_mfma_f32_16x16x32_bf16 v[76:79], a[104:107], a[0:3], v[76:79]
    v_and_b32 v33, 0xffff0000, v228
    v_and_b32 v53, 0xffff0000, v238
    v_mfma_f32_16x16x32_bf16 v[80:83], a[108:111], a[0:3], v[80:83]
    v_lshlrev_b32 v34, 16, v229
    v_lshlrev_b32 v54, 16, v239
    v_mfma_f32_16x16x32_bf16 v[64:67], a[112:115], a[4:7], v[64:67]
    ds_read_b128 a[20:23], v4 offset:256
    v_mfma_f32_16x16x32_bf16 v[68:71], a[116:119], a[4:7], v[68:71]
    v_and_b32 v35, 0xffff0000, v229
    v_and_b32 v55, 0xffff0000, v239
    v_mfma_f32_16x16x32_bf16 v[72:75], a[120:123], a[4:7], v[72:75]
    v_lshlrev_b32 v36, 16, v230
    v_lshlrev_b32 v56, 16, v240
    v_mfma_f32_16x16x32_bf16 v[76:79], a[124:127], a[4:7], v[76:79]
    v_and_b32 v37, 0xffff0000, v230
    v_and_b32 v57, 0xffff0000, v240
    v_mfma_f32_16x16x32_bf16 v[80:83], a[128:131], a[4:7], v[80:83]
    v_lshlrev_b32 v38, 16, v231
    v_lshlrev_b32 v58, 16, v241
    v_mfma_f32_16x16x32_bf16 v[64:67], a[132:135], a[8:11], v[64:67]
    ds_read_b128 a[24:27], v4 offset:1312
    v_mfma_f32_16x16x32_bf16 v[68:71], a[136:139], a[8:11], v[68:71]
    v_and_b32 v39, 0xffff0000, v231
    v_and_b32 v59, 0xffff0000, v241
    v_mfma_f32_16x16x32_bf16 v[72:75], a[140:143], a[8:11], v[72:75]
    v_lshlrev_b32 v40, 16, v232
    v_lshlrev_b32 v60, 16, v242
    v_mfma_f32_16x16x32_bf16 v[76:79], a[144:147], a[8:11], v[76:79]
    v_and_b32 v41, 0xffff0000, v232
    v_and_b32 v61, 0xffff0000, v242
    v_mfma_f32_16x16x32_bf16 v[80:83], a[148:151], a[8:11], v[80:83]
    v_lshlrev_b32 v42, 16, v233
    v_lshlrev_b32 v62, 16, v243
    v_mfma_f32_16x16x32_bf16 v[64:67], a[152:155], a[12:15], v[64:67]
    ds_read_b128 a[28:31], v4 offset:2368
    v_mfma_f32_16x16x32_bf16 v[68:71], a[156:159], a[12:15], v[68:71]
    v_and_b32 v43, 0xffff0000, v233
    v_and_b32 v63, 0xffff0000, v243
    v_mfma_f32_16x16x32_bf16 v[72:75], a[160:163], a[12:15], v[72:75]
    v_mov_b32 v246, 0
    v_mov_b32 v247, 0
    v_mfma_f32_16x16x32_bf16 v[76:79], a[164:167], a[12:15], v[76:79]
    v_mov_b32 v250, 0
    v_mov_b32 v251, 0
    v_mfma_f32_16x16x32_bf16 v[80:83], a[168:171], a[12:15], v[80:83]
    s_waitcnt lgkmcnt(0)
    v_mfma_f32_16x16x32_bf16 v[84:87], a[92:95], a[16:19], v[84:87]
    ds_read_b128 a[0:3], v17 offset:2144
    v_mfma_f32_16x16x32_bf16 v[88:91], a[96:99], a[16:19], v[88:91]
    v_mfma_f32_16x16x32_bf16 v[92:95], a[100:103], a[16:19], v[92:95]
    v_mfma_f32_16x16x32_bf16 v[96:99], a[104:107], a[16:19], v[96:99]
    ds_write_b128 v20, v[64:67] offset:0
    v_mfma_f32_16x16x32_bf16 v[100:103], a[108:111], a[16:19], v[100:103]
    v_mfma_f32_16x16x32_bf16 v[84:87], a[112:115], a[20:23], v[84:87]
    ds_read_b128 a[4:7], v5 offset:0
    v_mfma_f32_16x16x32_bf16 v[88:91], a[116:119], a[20:23], v[88:91]
    v_mfma_f32_16x16x32_bf16 v[92:95], a[120:123], a[20:23], v[92:95]
    ds_write_b128 v20, v[68:71] offset:1024
    v_mfma_f32_16x16x32_bf16 v[96:99], a[124:127], a[20:23], v[96:99]
    v_mfma_f32_16x16x32_bf16 v[100:103], a[128:131], a[20:23], v[100:103]
    v_mfma_f32_16x16x32_bf16 v[84:87], a[132:135], a[24:27], v[84:87]
    ds_read_b128 a[8:11], v5 offset:1056
    v_mfma_f32_16x16x32_bf16 v[88:91], a[136:139], a[24:27], v[88:91]
    ds_write_b128 v20, v[72:75] offset:2048
    v_mfma_f32_16x16x32_bf16 v[92:95], a[140:143], a[24:27], v[92:95]
    v_mfma_f32_16x16x32_bf16 v[96:99], a[144:147], a[24:27], v[96:99]
    v_mfma_f32_16x16x32_bf16 v[100:103], a[148:151], a[24:27], v[100:103]
    ds_write_b128 v20, v[76:79] offset:3072
    v_mfma_f32_16x16x32_bf16 v[84:87], a[152:155], a[28:31], v[84:87]
    ds_read_b128 a[12:15], v5 offset:2112
    v_mfma_f32_16x16x32_bf16 v[88:91], a[156:159], a[28:31], v[88:91]
    v_mfma_f32_16x16x32_bf16 v[92:95], a[160:163], a[28:31], v[92:95]
    v_mfma_f32_16x16x32_bf16 v[96:99], a[164:167], a[28:31], v[96:99]
    ds_write_b128 v20, v[80:83] offset:4096
    v_mfma_f32_16x16x32_bf16 v[100:103], a[168:171], a[28:31], v[100:103]
    s_waitcnt lgkmcnt(1)
    v_mfma_f32_16x16x32_bf16 v[104:107], a[92:95], a[0:3], v[104:107]
    ds_read_b128 a[16:19], v17 offset:2400
    v_mfma_f32_16x16x32_bf16 v[108:111], a[96:99], a[0:3], v[108:111]
    v_mfma_f32_16x16x32_bf16 v[112:115], a[100:103], a[0:3], v[112:115]
    v_mfma_f32_16x16x32_bf16 v[116:119], a[104:107], a[0:3], v[116:119]
    ds_write_b128 v20, v[84:87] offset:5120
    v_mfma_f32_16x16x32_bf16 v[120:123], a[108:111], a[0:3], v[120:123]
    v_mfma_f32_16x16x32_bf16 v[104:107], a[112:115], a[4:7], v[104:107]
    ds_read_b128 a[20:23], v5 offset:256
    v_mfma_f32_16x16x32_bf16 v[108:111], a[116:119], a[4:7], v[108:111]
    v_mfma_f32_16x16x32_bf16 v[112:115], a[120:123], a[4:7], v[112:115]
    ds_write_b128 v20, v[88:91] offset:6144
    v_mfma_f32_16x16x32_bf16 v[116:119], a[124:127], a[4:7], v[116:119]
    v_mfma_f32_16x16x32_bf16 v[120:123], a[128:131], a[4:7], v[120:123]
    v_mfma_f32_16x16x32_bf16 v[104:107], a[132:135], a[8:11], v[104:107]
    ds_read_b128 a[24:27], v5 offset:1312
    v_mfma_f32_16x16x32_bf16 v[108:111], a[136:139], a[8:11], v[108:111]
    ds_write_b128 v20, v[92:95] offset:7168
    v_mfma_f32_16x16x32_bf16 v[112:115], a[140:143], a[8:11], v[112:115]
    v_mfma_f32_16x16x32_bf16 v[116:119], a[144:147], a[8:11], v[116:119]
    v_mfma_f32_16x16x32_bf16 v[120:123], a[148:151], a[8:11], v[120:123]
    ds_write_b128 v20, v[96:99] offset:8192
    v_mfma_f32_16x16x32_bf16 v[104:107], a[152:155], a[12:15], v[104:107]
    ds_read_b128 a[28:31], v5 offset:2368
    v_mfma_f32_16x16x32_bf16 v[108:111], a[156:159], a[12:15], v[108:111]
    v_mfma_f32_16x16x32_bf16 v[112:115], a[160:163], a[12:15], v[112:115]
    v_mfma_f32_16x16x32_bf16 v[116:119], a[164:167], a[12:15], v[116:119]
    ds_write_b128 v20, v[100:103] offset:9216
    v_mfma_f32_16x16x32_bf16 v[120:123], a[168:171], a[12:15], v[120:123]
    s_waitcnt lgkmcnt(1)
    v_mfma_f32_16x16x32_bf16 v[124:127], a[92:95], a[16:19], v[124:127]
    ds_read_b128 a[0:3], v18 offset:2144
    v_mfma_f32_16x16x32_bf16 v[128:131], a[96:99], a[16:19], v[128:131]
    v_mfma_f32_16x16x32_bf16 v[132:135], a[100:103], a[16:19], v[132:135]
    v_mfma_f32_16x16x32_bf16 v[136:139], a[104:107], a[16:19], v[136:139]
    ds_write_b128 v20, v[104:107] offset:10240
    v_mfma_f32_16x16x32_bf16 v[140:143], a[108:111], a[16:19], v[140:143]
    v_mfma_f32_16x16x32_bf16 v[124:127], a[112:115], a[20:23], v[124:127]
    ds_read_b128 a[4:7], v6 offset:0
    v_mfma_f32_16x16x32_bf16 v[128:131], a[116:119], a[20:23], v[128:131]
    v_mfma_f32_16x16x32_bf16 v[132:135], a[120:123], a[20:23], v[132:135]
    ds_write_b128 v20, v[108:111] offset:11264
    v_mfma_f32_16x16x32_bf16 v[136:139], a[124:127], a[20:23], v[136:139]
    v_mfma_f32_16x16x32_bf16 v[140:143], a[128:131], a[20:23], v[140:143]
    v_mfma_f32_16x16x32_bf16 v[124:127], a[132:135], a[24:27], v[124:127]
    ds_read_b128 a[8:11], v6 offset:1056
    v_mfma_f32_16x16x32_bf16 v[128:131], a[136:139], a[24:27], v[128:131]
    ds_write_b128 v20, v[112:115] offset:12288
    v_mfma_f32_16x16x32_bf16 v[132:135], a[140:143], a[24:27], v[132:135]
    v_mfma_f32_16x16x32_bf16 v[136:139], a[144:147], a[24:27], v[136:139]
    v_mfma_f32_16x16x32_bf16 v[140:143], a[148:151], a[24:27], v[140:143]
    ds_write_b128 v20, v[116:119] offset:13312
    v_mfma_f32_16x16x32_bf16 v[124:127], a[152:155], a[28:31], v[124:127]
    ds_read_b128 a[12:15], v6 offset:2112
    v_mfma_f32_16x16x32_bf16 v[128:131], a[156:159], a[28:31], v[128:131]
    v_mfma_f32_16x16x32_bf16 v[132:135], a[160:163], a[28:31], v[132:135]
    v_mfma_f32_16x16x32_bf16 v[136:139], a[164:167], a[28:31], v[136:139]
    ds_write_b128 v20, v[120:123] offset:14336
    v_mfma_f32_16x16x32_bf16 v[140:143], a[168:171], a[28:31], v[140:143]
    s_waitcnt lgkmcnt(1)
    v_mfma_f32_16x16x32_bf16 v[144:147], a[92:95], a[0:3], v[144:147]
    ds_read_b128 a[16:19], v18 offset:2400
    v_mfma_f32_16x16x32_bf16 v[148:151], a[96:99], a[0:3], v[148:151]
    v_mfma_f32_16x16x32_bf16 v[152:155], a[100:103], a[0:3], v[152:155]
    v_mfma_f32_16x16x32_bf16 v[156:159], a[104:107], a[0:3], v[156:159]
    ds_write_b128 v20, v[124:127] offset:15360
    v_mfma_f32_16x16x32_bf16 v[160:163], a[108:111], a[0:3], v[160:163]
    v_mfma_f32_16x16x32_bf16 v[144:147], a[112:115], a[4:7], v[144:147]
    ds_read_b128 a[20:23], v6 offset:256
    v_mfma_f32_16x16x32_bf16 v[148:151], a[116:119], a[4:7], v[148:151]
    v_mfma_f32_16x16x32_bf16 v[152:155], a[120:123], a[4:7], v[152:155]
    ds_write_b128 v20, v[128:131] offset:16384
    v_mfma_f32_16x16x32_bf16 v[156:159], a[124:127], a[4:7], v[156:159]
    v_mfma_f32_16x16x32_bf16 v[160:163], a[128:131], a[4:7], v[160:163]
    v_mfma_f32_16x16x32_bf16 v[144:147], a[132:135], a[8:11], v[144:147]
    ds_read_b128 a[24:27], v6 offset:1312
    v_mfma_f32_16x16x32_bf16 v[148:151], a[136:139], a[8:11], v[148:151]
    ds_write_b128 v20, v[132:135] offset:17408
    v_mfma_f32_16x16x32_bf16 v[152:155], a[140:143], a[8:11], v[152:155]
    v_mfma_f32_16x16x32_bf16 v[156:159], a[144:147], a[8:11], v[156:159]
    v_mfma_f32_16x16x32_bf16 v[160:163], a[148:151], a[8:11], v[160:163]
    ds_write_b128 v20, v[136:139] offset:18432
    v_mfma_f32_16x16x32_bf16 v[144:147], a[152:155], a[12:15], v[144:147]
    ds_read_b128 a[28:31], v6 offset:2368
    v_mfma_f32_16x16x32_bf16 v[148:151], a[156:159], a[12:15], v[148:151]
    v_mfma_f32_16x16x32_bf16 v[152:155], a[160:163], a[12:15], v[152:155]
    v_mfma_f32_16x16x32_bf16 v[156:159], a[164:167], a[12:15], v[156:159]
    ds_write_b128 v20, v[140:143] offset:19456
    v_mfma_f32_16x16x32_bf16 v[160:163], a[168:171], a[12:15], v[160:163]
    s_waitcnt lgkmcnt(1)
    v_mfma_f32_16x16x32_bf16 v[164:167], a[92:95], a[16:19], v[164:167]
    v_mfma_f32_16x16x32_bf16 v[168:171], a[96:99], a[16:19], v[168:171]
    v_mfma_f32_16x16x32_bf16 v[172:175], a[100:103], a[16:19], v[172:175]
    v_mfma_f32_16x16x32_bf16 v[176:179], a[104:107], a[16:19], v[176:179]
    ds_write_b128 v20, v[144:147] offset:20480
    v_mfma_f32_16x16x32_bf16 v[180:183], a[108:111], a[16:19], v[180:183]
    v_mfma_f32_16x16x32_bf16 v[164:167], a[112:115], a[20:23], v[164:167]
    v_mfma_f32_16x16x32_bf16 v[168:171], a[116:119], a[20:23], v[168:171]
    v_mfma_f32_16x16x32_bf16 v[172:175], a[120:123], a[20:23], v[172:175]
    ds_write_b128 v20, v[148:151] offset:21504
    v_mfma_f32_16x16x32_bf16 v[176:179], a[124:127], a[20:23], v[176:179]
    v_mfma_f32_16x16x32_bf16 v[180:183], a[128:131], a[20:23], v[180:183]
    v_mfma_f32_16x16x32_bf16 v[164:167], a[132:135], a[24:27], v[164:167]
    v_mfma_f32_16x16x32_bf16 v[168:171], a[136:139], a[24:27], v[168:171]
    ds_write_b128 v20, v[152:155] offset:22528
    v_mfma_f32_16x16x32_bf16 v[172:175], a[140:143], a[24:27], v[172:175]
    v_mfma_f32_16x16x32_bf16 v[176:179], a[144:147], a[24:27], v[176:179]
    v_mfma_f32_16x16x32_bf16 v[180:183], a[148:151], a[24:27], v[180:183]
    ds_write_b128 v20, v[156:159] offset:23552
    v_mfma_f32_16x16x32_bf16 v[164:167], a[152:155], a[28:31], v[164:167]
    v_mfma_f32_16x16x32_bf16 v[168:171], a[156:159], a[28:31], v[168:171]
    v_mfma_f32_16x16x32_bf16 v[172:175], a[160:163], a[28:31], v[172:175]
    v_mfma_f32_16x16x32_bf16 v[176:179], a[164:167], a[28:31], v[176:179]
    ds_write_b128 v20, v[160:163] offset:24576
    v_mfma_f32_16x16x32_bf16 v[180:183], a[168:171], a[28:31], v[180:183]
    v_mfma_f32_16x16x32_bf16 v[184:187], a[172:175], a[192:195], v[184:187]
    v_mfma_f32_16x16x32_bf16 v[204:207], a[172:175], a[196:199], v[204:207]
    v_mfma_f32_16x16x32_bf16 v[184:187], a[32:35], a[200:203], v[184:187]
    v_mfma_f32_16x16x32_bf16 v[204:207], a[32:35], a[204:207], v[204:207]
    ds_write_b128 v20, v[164:167] offset:25600
    v_mfma_f32_16x16x32_bf16 v[184:187], a[52:55], a[208:211], v[184:187]
    v_mfma_f32_16x16x32_bf16 v[204:207], a[52:55], a[212:215], v[204:207]
    ds_write_b128 v20, v[168:171] offset:26624
    v_mfma_f32_16x16x32_bf16 v[184:187], a[72:75], a[216:219], v[184:187]
    v_mfma_f32_16x16x32_bf16 v[204:207], a[72:75], a[220:223], v[204:207]
    ds_write_b128 v20, v[172:175] offset:27648
    v_mfma_f32_16x16x32_bf16 v[184:187], a[92:95], a[224:227], v[184:187]
    v_mfma_f32_16x16x32_bf16 v[204:207], a[92:95], a[228:231], v[204:207]
    ds_write_b128 v20, v[176:179] offset:28672
    v_mfma_f32_16x16x32_bf16 v[184:187], a[112:115], a[232:235], v[184:187]
    v_mfma_f32_16x16x32_bf16 v[204:207], a[112:115], a[236:239], v[204:207]
    ds_write_b128 v20, v[180:183] offset:29696
    v_mfma_f32_16x16x32_bf16 v[184:187], a[132:135], a[240:243], v[184:187]
    v_mfma_f32_16x16x32_bf16 v[204:207], a[132:135], a[244:247], v[204:207]
    s_waitcnt lgkmcnt(0)
    s_barrier
    v_mfma_f32_16x16x32_bf16 v[184:187], a[152:155], a[248:251], v[184:187]
    ds_read_b128 v[64:67], v21 offset:0
    ds_read_b128 v[84:87], v21 offset:5120
    v_mfma_f32_16x16x32_bf16 v[204:207], a[152:155], a[252:255], v[204:207]
    ds_read_b128 v[104:107], v22 offset:0
    ds_read_b128 v[124:127], v22 offset:5120
    v_mfma_f32_16x16x32_bf16 v[188:191], a[176:179], a[192:195], v[188:191]
    ds_read_b128 v[144:147], v23 offset:0
    ds_read_b128 v[164:167], v23 offset:5120
    v_mfma_f32_16x16x32_bf16 v[208:211], a[176:179], a[196:199], v[208:211]
    ds_read_b128 v[68:71], v21 offset:1024
    ds_read_b128 v[88:91], v21 offset:6144
    v_mfma_f32_16x16x32_bf16 v[188:191], a[36:39], a[200:203], v[188:191]
    ds_read_b128 v[108:111], v22 offset:1024
    ds_read_b128 v[128:131], v22 offset:6144
    v_mfma_f32_16x16x32_bf16 v[208:211], a[36:39], a[204:207], v[208:211]
    ds_read_b128 v[148:151], v23 offset:1024
    ds_read_b128 v[168:171], v23 offset:6144
    v_mfma_f32_16x16x32_bf16 v[188:191], a[56:59], a[208:211], v[188:191]
    ds_read_b128 v[72:75], v21 offset:2048
    ds_read_b128 v[92:95], v21 offset:7168
    v_mfma_f32_16x16x32_bf16 v[208:211], a[56:59], a[212:215], v[208:211]
    ds_read_b128 v[112:115], v22 offset:2048
    ds_read_b128 v[132:135], v22 offset:7168
    v_mfma_f32_16x16x32_bf16 v[188:191], a[76:79], a[216:219], v[188:191]
    ds_read_b128 v[152:155], v23 offset:2048
    ds_read_b128 v[172:175], v23 offset:7168
    v_mfma_f32_16x16x32_bf16 v[208:211], a[76:79], a[220:223], v[208:211]
    ds_read_b128 v[76:79], v21 offset:3072
    ds_read_b128 v[96:99], v21 offset:8192
    v_mfma_f32_16x16x32_bf16 v[188:191], a[96:99], a[224:227], v[188:191]
    ds_read_b128 v[116:119], v22 offset:3072
    ds_read_b128 v[136:139], v22 offset:8192
    v_mfma_f32_16x16x32_bf16 v[208:211], a[96:99], a[228:231], v[208:211]
    ds_read_b128 v[156:159], v23 offset:3072
    ds_read_b128 v[176:179], v23 offset:8192
    v_mfma_f32_16x16x32_bf16 v[188:191], a[116:119], a[232:235], v[188:191]
    ds_read_b128 v[80:83], v21 offset:4096
    ds_read_b128 v[100:103], v21 offset:9216
    v_mfma_f32_16x16x32_bf16 v[208:211], a[116:119], a[236:239], v[208:211]
    ds_read_b128 v[120:123], v22 offset:4096
    ds_read_b128 v[140:143], v22 offset:9216
    v_mfma_f32_16x16x32_bf16 v[188:191], a[136:139], a[240:243], v[188:191]
    ds_read_b128 v[160:163], v23 offset:4096
    ds_read_b128 v[180:183], v23 offset:9216
    v_mfma_f32_16x16x32_bf16 v[208:211], a[136:139], a[244:247], v[208:211]
    v_mfma_f32_16x16x32_bf16 v[188:191], a[156:159], a[248:251], v[188:191]
    s_waitcnt lgkmcnt(15)
    v_mfma_f32_16x16x32_bf16 v[208:211], a[156:159], a[252:255], v[208:211]
    v_add_f32 v64, v64, v104
    v_add_f32 v65, v65, v105
    v_mfma_f32_16x16x32_bf16 v[192:195], a[180:183], a[192:195], v[192:195]
    v_add_f32 v66, v66, v106
    v_add_f32 v67, v67, v107
    v_mfma_f32_16x16x32_bf16 v[212:215], a[180:183], a[196:199], v[212:215]
    v_add_f32 v84, v84, v124
    v_add_f32 v85, v85, v125
    v_mfma_f32_16x16x32_bf16 v[192:195], a[40:43], a[200:203], v[192:195]
    v_add_f32 v86, v86, v126
    v_add_f32 v87, v87, v127
    v_mfma_f32_16x16x32_bf16 v[212:215], a[40:43], a[204:207], v[212:215]
    v_add_f32 v64, v64, v144
    v_add_f32 v65, v65, v145
    v_mfma_f32_16x16x32_bf16 v[192:195], a[60:63], a[208:211], v[192:195]
    v_add_f32 v66, v66, v146
    v_add_f32 v67, v67, v147
    v_mfma_f32_16x16x32_bf16 v[212:215], a[60:63], a[212:215], v[212:215]
    v_add_f32 v84, v84, v164
    v_add_f32 v85, v85, v165
    v_mfma_f32_16x16x32_bf16 v[192:195], a[80:83], a[216:219], v[192:195]
    v_add_f32 v86, v86, v166
    v_add_f32 v87, v87, v167
    v_mfma_f32_16x16x32_bf16 v[212:215], a[80:83], a[220:223], v[212:215]
    v_add_f32 v184, v184, v64
    v_add_f32 v185, v185, v65
    v_mfma_f32_16x16x32_bf16 v[192:195], a[100:103], a[224:227], v[192:195]
    v_add_f32 v186, v186, v66
    v_add_f32 v187, v187, v67
    v_mfma_f32_16x16x32_bf16 v[212:215], a[100:103], a[228:231], v[212:215]
    v_add_f32 v204, v204, v84
    v_add_f32 v205, v205, v85
    v_mfma_f32_16x16x32_bf16 v[192:195], a[120:123], a[232:235], v[192:195]
    v_add_f32 v206, v206, v86
    v_add_f32 v207, v207, v87
    v_mfma_f32_16x16x32_bf16 v[212:215], a[120:123], a[236:239], v[212:215]
    v_add_f32 v246, v246, v184
    v_add_f32 v247, v247, v185
    v_mfma_f32_16x16x32_bf16 v[192:195], a[140:143], a[240:243], v[192:195]
    v_fma_f32 v250, v184, v184, v250
    v_fma_f32 v251, v185, v185, v251
    v_mfma_f32_16x16x32_bf16 v[212:215], a[140:143], a[244:247], v[212:215]
    v_add_f32 v246, v246, v186
    v_add_f32 v247, v247, v187
    v_mfma_f32_16x16x32_bf16 v[192:195], a[160:163], a[248:251], v[192:195]
    v_fma_f32 v250, v186, v186, v250
    v_fma_f32 v251, v187, v187, v251
    v_mfma_f32_16x16x32_bf16 v[212:215], a[160:163], a[252:255], v[212:215]
    v_add_f32 v246, v246, v204
    v_add_f32 v247, v247, v205
    v_mfma_f32_16x16x32_bf16 v[196:199], a[184:187], a[192:195], v[196:199]
    v_fma_f32 v250, v204, v204, v250
    v_fma_f32 v251, v205, v205, v251
    v_mfma_f32_16x16x32_bf16 v[216:219], a[184:187], a[196:199], v[216:219]
    v_add_f32 v246, v246, v206
    v_add_f32 v247, v247, v207
    v_mfma_f32_16x16x32_bf16 v[196:199], a[44:47], a[200:203], v[196:199]
    v_fma_f32 v250, v206, v206, v250
    v_fma_f32 v251, v207, v207, v251
    v_mfma_f32_16x16x32_bf16 v[216:219], a[44:47], a[204:207], v[216:219]
    v_mfma_f32_16x16x32_bf16 v[196:199], a[64:67], a[208:211], v[196:199]
    v_add_f32 v68, v68, v108
    v_add_f32 v69, v69, v109
    v_mfma_f32_16x16x32_bf16 v[216:219], a[64:67], a[212:215], v[216:219]
    v_add_f32 v70, v70, v110
    v_add_f32 v71, v71, v111
    v_mfma_f32_16x16x32_bf16 v[196:199], a[84:87], a[216:219], v[196:199]
    v_add_f32 v88, v88, v128
    v_add_f32 v89, v89, v129
    v_mfma_f32_16x16x32_bf16 v[216:219], a[84:87], a[220:223], v[216:219]
    v_add_f32 v90, v90, v130
    v_add_f32 v91, v91, v131
    v_mfma_f32_16x16x32_bf16 v[196:199], a[104:107], a[224:227], v[196:199]
    v_add_f32 v68, v68, v148
    v_add_f32 v69, v69, v149
    v_mfma_f32_16x16x32_bf16 v[216:219], a[104:107], a[228:231], v[216:219]
    v_add_f32 v70, v70, v150
    v_add_f32 v71, v71, v151
    v_mfma_f32_16x16x32_bf16 v[196:199], a[124:127], a[232:235], v[196:199]
    v_add_f32 v88, v88, v168
    v_add_f32 v89, v89, v169
    v_mfma_f32_16x16x32_bf16 v[216:219], a[124:127], a[236:239], v[216:219]
    v_add_f32 v90, v90, v170
    v_add_f32 v91, v91, v171
    v_mfma_f32_16x16x32_bf16 v[196:199], a[144:147], a[240:243], v[196:199]
    v_add_f32 v188, v188, v68
    v_add_f32 v189, v189, v69
    v_mfma_f32_16x16x32_bf16 v[216:219], a[144:147], a[244:247], v[216:219]
    v_add_f32 v190, v190, v70
    v_add_f32 v191, v191, v71
    v_mfma_f32_16x16x32_bf16 v[196:199], a[164:167], a[248:251], v[196:199]
    v_add_f32 v208, v208, v88
    v_add_f32 v209, v209, v89
    v_mfma_f32_16x16x32_bf16 v[216:219], a[164:167], a[252:255], v[216:219]
    v_add_f32 v210, v210, v90
    v_add_f32 v211, v211, v91
    v_mfma_f32_16x16x32_bf16 v[200:203], a[188:191], a[192:195], v[200:203]
    v_add_f32 v246, v246, v188
    v_add_f32 v247, v247, v189
    v_mfma_f32_16x16x32_bf16 v[220:223], a[188:191], a[196:199], v[220:223]
    v_fma_f32 v250, v188, v188, v250
    v_fma_f32 v251, v189, v189, v251
    v_mfma_f32_16x16x32_bf16 v[200:203], a[48:51], a[200:203], v[200:203]
    v_add_f32 v246, v246, v190
    v_add_f32 v247, v247, v191
    v_mfma_f32_16x16x32_bf16 v[220:223], a[48:51], a[204:207], v[220:223]
    v_fma_f32 v250, v190, v190, v250
    v_fma_f32 v251, v191, v191, v251
    v_mfma_f32_16x16x32_bf16 v[200:203], a[68:71], a[208:211], v[200:203]
    v_add_f32 v246, v246, v208
    v_add_f32 v247, v247, v209
    v_mfma_f32_16x16x32_bf16 v[220:223], a[68:71], a[212:215], v[220:223]
    v_fma_f32 v250, v208, v208, v250
    v_fma_f32 v251, v209, v209, v251
    v_mfma_f32_16x16x32_bf16 v[200:203], a[88:91], a[216:219], v[200:203]
    v_add_f32 v246, v246, v210
    v_add_f32 v247, v247, v211
    v_mfma_f32_16x16x32_bf16 v[220:223], a[88:91], a[220:223], v[220:223]
    v_fma_f32 v250, v210, v210, v250
    v_fma_f32 v251, v211, v211, v251
    v_mfma_f32_16x16x32_bf16 v[200:203], a[108:111], a[224:227], v[200:203]
    s_waitcnt lgkmcnt(12)
    v_mfma_f32_16x16x32_bf16 v[220:223], a[108:111], a[228:231], v[220:223]
    v_add_f32 v72, v72, v112
    v_add_f32 v73, v73, v113
    v_mfma_f32_16x16x32_bf16 v[200:203], a[128:131], a[232:235], v[200:203]
    v_add_f32 v74, v74, v114
    v_add_f32 v75, v75, v115
    v_mfma_f32_16x16x32_bf16 v[220:223], a[128:131], a[236:239], v[220:223]
    v_add_f32 v92, v92, v132
    v_add_f32 v93, v93, v133
    v_mfma_f32_16x16x32_bf16 v[200:203], a[148:151], a[240:243], v[200:203]
    v_add_f32 v94, v94, v134
    v_add_f32 v95, v95, v135
    v_mfma_f32_16x16x32_bf16 v[220:223], a[148:151], a[244:247], v[220:223]
    v_add_f32 v72, v72, v152
    v_add_f32 v73, v73, v153
    v_mfma_f32_16x16x32_bf16 v[200:203], a[168:171], a[248:251], v[200:203]
    v_add_f32 v74, v74, v154
    v_add_f32 v75, v75, v155
    v_mfma_f32_16x16x32_bf16 v[220:223], a[168:171], a[252:255], v[220:223]
    v_add_f32 v92, v92, v172
    v_add_f32 v93, v93, v173
    v_pk_add_f32 v[94:95], v[94:95], v[174:175]
    v_pk_add_f32 v[192:193], v[192:193], v[72:73]
    v_pk_add_f32 v[194:195], v[194:195], v[74:75]
    v_pk_add_f32 v[212:213], v[212:213], v[92:93]
    v_pk_add_f32 v[214:215], v[214:215], v[94:95]
    v_pk_add_f32 v[246:247], v[246:247], v[192:193]
    v_pk_fma_f32 v[250:251], v[192:193], v[192:193], v[250:251]
    v_pk_add_f32 v[246:247], v[246:247], v[194:195]
    v_pk_fma_f32 v[250:251], v[194:195], v[194:195], v[250:251]
    v_pk_add_f32 v[246:247], v[246:247], v[212:213]
    v_pk_fma_f32 v[250:251], v[212:213], v[212:213], v[250:251]
    v_pk_add_f32 v[246:247], v[246:247], v[214:215]
    v_pk_fma_f32 v[250:251], v[214:215], v[214:215], v[250:251]
    s_waitcnt lgkmcnt(6)
    v_pk_add_f32 v[76:77], v[76:77], v[116:117]
    v_pk_add_f32 v[78:79], v[78:79], v[118:119]
    v_pk_add_f32 v[96:97], v[96:97], v[136:137]
    v_pk_add_f32 v[98:99], v[98:99], v[138:139]
    v_pk_add_f32 v[76:77], v[76:77], v[156:157]
    v_pk_add_f32 v[78:79], v[78:79], v[158:159]
    v_pk_add_f32 v[96:97], v[96:97], v[176:177]
    v_pk_add_f32 v[98:99], v[98:99], v[178:179]
    v_pk_add_f32 v[196:197], v[196:197], v[76:77]
    v_pk_add_f32 v[198:199], v[198:199], v[78:79]
    v_pk_add_f32 v[216:217], v[216:217], v[96:97]
    v_pk_add_f32 v[218:219], v[218:219], v[98:99]
    v_pk_add_f32 v[246:247], v[246:247], v[196:197]
    v_pk_fma_f32 v[250:251], v[196:197], v[196:197], v[250:251]
    v_pk_add_f32 v[246:247], v[246:247], v[198:199]
    v_pk_fma_f32 v[250:251], v[198:199], v[198:199], v[250:251]
    v_pk_add_f32 v[246:247], v[246:247], v[216:217]
    v_pk_fma_f32 v[250:251], v[216:217], v[216:217], v[250:251]
    v_pk_add_f32 v[246:247], v[246:247], v[218:219]
    v_pk_fma_f32 v[250:251], v[218:219], v[218:219], v[250:251]
    s_waitcnt lgkmcnt(0)
    v_pk_add_f32 v[80:81], v[80:81], v[120:121]
    v_pk_add_f32 v[82:83], v[82:83], v[122:123]
    v_pk_add_f32 v[100:101], v[100:101], v[140:141]
    v_pk_add_f32 v[102:103], v[102:103], v[142:143]
    v_pk_add_f32 v[80:81], v[80:81], v[160:161]
    v_pk_add_f32 v[82:83], v[82:83], v[162:163]
    v_pk_add_f32 v[100:101], v[100:101], v[180:181]
    v_pk_add_f32 v[102:103], v[102:103], v[182:183]
    v_pk_add_f32 v[200:201], v[200:201], v[80:81]
    v_pk_add_f32 v[202:203], v[202:203], v[82:83]
    v_pk_add_f32 v[220:221], v[220:221], v[100:101]
    v_pk_add_f32 v[222:223], v[222:223], v[102:103]
    v_pk_add_f32 v[246:247], v[246:247], v[200:201]
    v_pk_fma_f32 v[250:251], v[200:201], v[200:201], v[250:251]
    v_pk_add_f32 v[246:247], v[246:247], v[202:203]
    v_pk_fma_f32 v[250:251], v[202:203], v[202:203], v[250:251]
    v_pk_add_f32 v[246:247], v[246:247], v[220:221]
    v_pk_fma_f32 v[250:251], v[220:221], v[220:221], v[250:251]
    v_pk_add_f32 v[246:247], v[246:247], v[222:223]
    v_pk_fma_f32 v[250:251], v[222:223], v[222:223], v[250:251]
    v_add_f32 v6, v246, v247
    v_add_f32 v7, v250, v251
    s_nop 0
    v_add_f32_dpp v6, v6, v6 row_shr:1 row_mask:0xf bank_mask:0xf bound_ctrl:0
    v_add_f32_dpp v7, v7, v7 row_shr:1 row_mask:0xf bank_mask:0xf bound_ctrl:0
    s_nop 0
    v_add_f32_dpp v6, v6, v6 row_shr:2 row_mask:0xf bank_mask:0xf bound_ctrl:0
    v_add_f32_dpp v7, v7, v7 row_shr:2 row_mask:0xf bank_mask:0xf bound_ctrl:0
    s_nop 0
    v_add_f32_dpp v6, v6, v6 row_shr:4 row_mask:0xf bank_mask:0xf bound_ctrl:0
    v_add_f32_dpp v7, v7, v7 row_shr:4 row_mask:0xf bank_mask:0xf bound_ctrl:0
    s_nop 0
    v_add_f32_dpp v6, v6, v6 row_shr:8 row_mask:0xf bank_mask:0xf bound_ctrl:0
    v_add_f32_dpp v7, v7, v7 row_shr:8 row_mask:0xf bank_mask:0xf bound_ctrl:0
    s_nop 0
    v_add_f32_dpp v6, v6, v6 row_bcast:15 row_mask:0xa bank_mask:0xf
    v_add_f32_dpp v7, v7, v7 row_bcast:15 row_mask:0xa bank_mask:0xf
    s_nop 0
    v_add_f32_dpp v6, v6, v6 row_bcast:31 row_mask:0xc bank_mask:0xf
    v_add_f32_dpp v7, v7, v7 row_bcast:31 row_mask:0xc bank_mask:0xf
    s_lshl_b32 s11, s3, 3
    s_add_u32 s11, s11, 40704
    v_mov_b32 v8, s11
    s_mov_b32 exec_lo, 0
    s_mov_b32 exec_hi, 0x80000000
    ds_write_b64 v8, v[6:7]
    s_mov_b64 exec, -1
    s_waitcnt lgkmcnt(0)
    s_barrier
    s_cmp_lg_u32 s3, 0
    s_cbranch_scc1 c1_wait
    v_mov_b32 v6, 0
    v_mov_b32 v7, 0
    v_lshlrev_b32 v8, 3, v2
    s_mov_b64 exec, 0xf
    ds_read_b64 v[6:7], v8 offset:40704
    s_mov_b64 exec, -1
    s_waitcnt lgkmcnt(0)
    v_add_f32_dpp v6, v6, v6 row_shr:1 row_mask:0xf bank_mask:0xf bound_ctrl:0
    v_add_f32_dpp v7, v7, v7 row_shr:1 row_mask:0xf bank_mask:0xf bound_ctrl:0
    s_nop 0
    v_add_f32_dpp v6, v6, v6 row_shr:2 row_mask:0xf bank_mask:0xf bound_ctrl:0
    v_add_f32_dpp v7, v7, v7 row_shr:2 row_mask:0xf bank_mask:0xf bound_ctrl:0
    s_nop 0
    v_add_f32_dpp v6, v6, v6 row_shr:4 row_mask:0xf bank_mask:0xf bound_ctrl:0
    v_add_f32_dpp v7, v7, v7 row_shr:4 row_mask:0xf bank_mask:0xf bound_ctrl:0
    s_nop 0
    v_add_f32_dpp v6, v6, v6 row_shr:8 row_mask:0xf bank_mask:0xf bound_ctrl:0
    v_add_f32_dpp v7, v7, v7 row_shr:8 row_mask:0xf bank_mask:0xf bound_ctrl:0
    s_lshr_b32 s12, s6, 1
    v_readlane_b32 s84, v6, 15
    v_readlane_b32 s85, v7, 15
    v_add_u32 v105, 0x9e3779b1, v244
    v_add_u32 v107, 0x7f4a7c15, v245
    v_mov_b32 v104, s84
    v_mov_b32 v106, s85
    s_lshl_b32 s86, s12, 4
    v_mov_b32 v108, s86
    s_mov_b64 exec, 1
    buffer_store_dwordx4 v[104:107], v108, s[96:99], 0 offen sc1
    s_mov_b64 exec, -1
    v_mbcnt_lo_u32_b32 v109, -1, 0
    v_lshlrev_b32 v109, 4, v109
    s_mov_b32 s58, 0xbfb8aa3b
    s_mov_b32 s59, 0xbfb8aa3b
    v_pk_mul_f32 v[24:25], v[24:25], s[58:59]
    v_pk_mul_f32 v[44:45], v[44:45], s[58:59]
    v_pk_mul_f32 v[26:27], v[26:27], s[58:59]
    v_pk_mul_f32 v[46:47], v[46:47], s[58:59]
    v_pk_mul_f32 v[28:29], v[28:29], s[58:59]
    v_pk_mul_f32 v[48:49], v[48:49], s[58:59]
    v_pk_mul_f32 v[30:31], v[30:31], s[58:59]
    v_pk_mul_f32 v[50:51], v[50:51], s[58:59]
    v_pk_mul_f32 v[32:33], v[32:33], s[58:59]
    v_pk_mul_f32 v[52:53], v[52:53], s[58:59]
    v_pk_mul_f32 v[34:35], v[34:35], s[58:59]
    v_pk_mul_f32 v[54:55], v[54:55], s[58:59]
    v_pk_mul_f32 v[36:37], v[36:37], s[58:59]
    v_pk_mul_f32 v[56:57], v[56:57], s[58:59]
    v_pk_mul_f32 v[38:39], v[38:39], s[58:59]
    v_pk_mul_f32 v[58:59], v[58:59], s[58:59]
    v_pk_mul_f32 v[40:41], v[40:41], s[58:59]
    v_pk_mul_f32 v[60:61], v[60:61], s[58:59]
    v_pk_mul_f32 v[42:43], v[42:43], s[58:59]
    v_pk_mul_f32 v[62:63], v[62:63], s[58:59]
    v_pk_mul_f32 v[184:185], v[184:185], v[24:25]
    v_pk_mul_f32 v[186:187], v[186:187], v[26:27]
    v_pk_mul_f32 v[204:205], v[204:205], v[24:25]
    v_pk_mul_f32 v[206:207], v[206:207], v[26:27]
    v_pk_mul_f32 v[188:189], v[188:189], v[28:29]
    v_pk_mul_f32 v[190:191], v[190:191], v[30:31]
    v_pk_mul_f32 v[208:209], v[208:209], v[28:29]
    v_pk_mul_f32 v[210:211], v[210:211], v[30:31]
    v_pk_mul_f32 v[192:193], v[192:193], v[32:33]
    v_pk_mul_f32 v[194:195], v[194:195], v[34:35]
    v_pk_mul_f32 v[212:213], v[212:213], v[32:33]
    v_pk_mul_f32 v[214:215], v[214:215], v[34:35]
    v_pk_mul_f32 v[196:197], v[196:197], v[36:37]
    v_pk_mul_f32 v[198:199], v[198:199], v[38:39]
    v_pk_mul_f32 v[216:217], v[216:217], v[36:37]
    v_pk_mul_f32 v[218:219], v[218:219], v[38:39]
    v_pk_mul_f32 v[200:201], v[200:201], v[40:41]
    v_pk_mul_f32 v[202:203], v[202:203], v[42:43]
    v_pk_mul_f32 v[220:221], v[220:221], v[40:41]
    v_pk_mul_f32 v[222:223], v[222:223], v[42:43]
    v_lshrrev_b32 v110, 3, v2
    v_mul_u32_u24 v110, 4352, v110
    v_bfe_u32 v111, v2, 1, 2
    v_mul_u32_u24 v111, 1056, v111
    v_and_b32 v116, 1, v2
    v_mul_u32_u24 v116, 1040, v116
    v_add3_u32 v110, v110, v111, v116
    v_add_u32 v110, s8, v110
    v_mov_b32 v112, 0
    v_mov_b32 v113, 0
    v_mov_b32 v114, 0
    v_mov_b32 v115, 0
    ds_write_b128 v110, v[112:115]
    v_and_b32 v110, 15, v2
    v_lshrrev_b32 v111, 4, v2
    v_lshlrev_b32 v110, 4, v110
    v_add_u32 v110, s8, v110
    v_mul_u32_u24 v116, 4352, v111
    v_add_u32 v110, v110, v116
    v_lshrrev_b32 v111, 1, v111
    v_mul_i32_i24 v13, -7648, v111
    v_mul_i32_i24 v14, -1056, v111
    v_lshlrev_b32 v15, 4, v111
    s_xor_b32 s14, s3, 3
    s_bfe_u32 s15, s14, 0x10001
    s_and_b32 s14, s14, 1
    s_mul_i32 s15, s15, 1056
    s_lshl_b32 s14, s14, 9
    s_add_u32 s14, s14, s15
    v_add_u32 v16, s14, v110
    s_xor_b32 s14, s3, 2
    s_bfe_u32 s15, s14, 0x10001
    s_and_b32 s14, s14, 1
    s_mul_i32 s15, s15, 1056
    s_lshl_b32 s14, s14, 9
    s_add_u32 s14, s14, s15
    v_add_u32 v17, s14, v110
    s_xor_b32 s14, s3, 1
    s_bfe_u32 s15, s14, 0x10001
    s_and_b32 s14, s14, 1
    s_mul_i32 s15, s15, 1056
    s_lshl_b32 s14, s14, 9
    s_add_u32 s14, s14, s15
    v_add_u32 v18, s14, v110
    s_xor_b32 s14, s3, 0
    s_bfe_u32 s15, s14, 0x10001
    s_and_b32 s14, s14, 1
    s_mul_i32 s15, s15, 1056
    s_lshl_b32 s14, s14, 9
    s_add_u32 s14, s14, s15
    v_add_u32 v19, s14, v110
    s_add_u32 s14, s8, 8704
    v_add_u32 v20, s14, v11
    s_xor_b32 s14, s3, 3
    s_mul_i32 s14, s14, 40960
    s_add_u32 s14, s14, 8704
    v_add_u32 v21, s14, v11
    s_xor_b32 s14, s3, 2
    s_mul_i32 s14, s14, 40960
    s_add_u32 s14, s14, 18944
    v_add_u32 v22, s14, v11
    s_xor_b32 s14, s3, 1
    s_mul_i32 s14, s14, 40960
    s_add_u32 s14, s14, 29184
    v_add_u32 v23, s14, v11
    s_max_u32 s14, s6, 1
    s_sub_u32 s14, s14, s6
    s_mul_i32 s14, s14, 0x7fff0000
    v_add_u32 v4, s14, v11
    s_min_u32 s14, s6, 61
    s_sub_u32 s14, s6, s14
    s_mul_i32 s14, s14, 0x7fff0000
    v_add_u32 v5, s14, v11
    v_and_b32 v3, 15, v2
    v_lshlrev_b32 v3, 13, v3
    v_bfe_u32 v117, v2, 4, 1
    v_lshl_add_u32 v3, v117, 5, v3
    v_lshrrev_b32 v117, 5, v2
    v_lshl_add_u32 v3, v117, 4, v3
    s_mul_i32 s14, s5, 320
    s_mul_i32 s15, s4, 80
    s_add_u32 s14, s14, s15
    s_lshl_b32 s14, s14, 13
    s_lshl_b32 s15, s6, 7
    s_add_u32 s14, s14, s15
    s_lshl_b32 s15, s3, 6
    s_add_u32 s14, s14, s15
    v_add_u32 v3, s14, v3
    v_cmp_ne_u32 vcc, s9, v249
    s_add_u32 s14, s7, 1
    v_mov_b32 v252, s14
    v_mov_b32 v253, s14
    v_mov_b32 v254, s14
    v_mov_b32 v255, s14
    s_lshr_b32 s14, vcc_lo, s3
    s_mov_b32 s1, 0
    s_bfe_u32 s15, s14, 0x10004
    s_lshl_b32 s0, 1, s15
    s_and_b32 s15, s14, 1
    s_lshl_b32 s15, 4, s15
    s_or_b32 s0, s0, s15
    s_bfe_u32 s15, s14, 0x10008
    s_lshl_b32 s15, 16, s15
    s_or_b32 s0, s0, s15
    s_add_u32 s13, s13, 0x10000
    v_add_u32 v248, 0x10000, v248
    s_mov_b32 exec_lo, -1
    s_mov_b32 exec_hi, 0
    s_mov_b32 s87, 0
    buffer_load_dwordx4 v[144:147], v109, s[96:99], 0 offen sc1
    s_sleep 7
    buffer_load_dwordx4 v[148:151], v109, s[96:99], 0 offen sc1
c1_poll:
    s_waitcnt vmcnt(1)
    v_cmp_eq_u32 vcc, v145, v105
    v_cmp_eq_u32 s[84:85], v147, v107
    v_mov_b32 v100, v144
    v_mov_b32 v102, v146
    s_and_b32 s84, s84, vcc_lo
    s_cmp_eq_u32 s84, -1
    s_cbranch_scc1 c1_polldone
    buffer_load_dwordx4 v[144:147], v109, s[96:99], 0 offen sc1
    s_waitcnt vmcnt(1)
    v_cmp_eq_u32 vcc, v149, v105
    v_cmp_eq_u32 s[84:85], v151, v107
    v_mov_b32 v100, v148
    v_mov_b32 v102, v150
    s_and_b32 s84, s84, vcc_lo
    s_cmp_eq_u32 s84, -1
    s_cbranch_scc1 c1_polldone
    buffer_load_dwordx4 v[148:151], v109, s[96:99], 0 offen sc1
    s_add_u32 s87, s87, 1
    s_cmp_lt_u32 s87, 0x20000
    s_cbranch_scc1 c1_poll
c1_polldone:
    s_mov_b64 exec, -1
    v_add_f32_dpp v100, v100, v100 row_shr:1 row_mask:0xf bank_mask:0xf bound_ctrl:0
    v_add_f32_dpp v102, v102, v102 row_shr:1 row_mask:0xf bank_mask:0xf bound_ctrl:0
    s_nop 0
    v_add_f32_dpp v100, v100, v100 row_shr:2 row_mask:0xf bank_mask:0xf bound_ctrl:0
    v_add_f32_dpp v102, v102, v102 row_shr:2 row_mask:0xf bank_mask:0xf bound_ctrl:0
    s_nop 0
    v_add_f32_dpp v100, v100, v100 row_shr:4 row_mask:0xf bank_mask:0xf bound_ctrl:0
    v_add_f32_dpp v102, v102, v102 row_shr:4 row_mask:0xf bank_mask:0xf bound_ctrl:0
    s_nop 0
    v_add_f32_dpp v100, v100, v100 row_shr:8 row_mask:0xf bank_mask:0xf bound_ctrl:0
    v_add_f32_dpp v102, v102, v102 row_shr:8 row_mask:0xf bank_mask:0xf bound_ctrl:0
    s_nop 0
    v_add_f32_dpp v100, v100, v100 row_bcast:15 row_mask:0xa bank_mask:0xf
    v_add_f32_dpp v102, v102, v102 row_bcast:15 row_mask:0xa bank_mask:0xf
    v_mul_f32 v100, 0x364ccccd, v100
    v_mul_f32 v101, 0x364ccccd, v102
    v_fma_f32 v101, -v100, v100, v101
    v_max_f32 v101, 0, v101
    v_add_f32 v101, 0x3727c5ac, v101
    v_rsq_f32 v101, v101
    v_mov_b32 v108, 40832
    s_mov_b32 exec_lo, 0x80000000
    s_mov_b32 exec_hi, 0
    ds_write_b64 v108, v[100:101]
    s_cmp_lg_u32 s12, 0
    s_cbranch_scc1 c1_noepoch
    s_mov_b64 exec, 1
    v_mov_b32 v106, v105
    buffer_store_dwordx2 v[106:107], v109, s[96:99], 0 offen offset:1024 sc1
c1_noepoch:
    s_mov_b64 exec, -1
    s_waitcnt lgkmcnt(0)
    s_branch c1_wait2
c1_wait:
    s_mov_b32 s58, 0xbfb8aa3b
    s_mov_b32 s59, 0xbfb8aa3b
    v_pk_mul_f32 v[24:25], v[24:25], s[58:59]
    v_pk_mul_f32 v[44:45], v[44:45], s[58:59]
    v_pk_mul_f32 v[26:27], v[26:27], s[58:59]
    v_pk_mul_f32 v[46:47], v[46:47], s[58:59]
    v_pk_mul_f32 v[28:29], v[28:29], s[58:59]
    v_pk_mul_f32 v[48:49], v[48:49], s[58:59]
    v_pk_mul_f32 v[30:31], v[30:31], s[58:59]
    v_pk_mul_f32 v[50:51], v[50:51], s[58:59]
    v_pk_mul_f32 v[32:33], v[32:33], s[58:59]
    v_pk_mul_f32 v[52:53], v[52:53], s[58:59]
    v_pk_mul_f32 v[34:35], v[34:35], s[58:59]
    v_pk_mul_f32 v[54:55], v[54:55], s[58:59]
    v_pk_mul_f32 v[36:37], v[36:37], s[58:59]
    v_pk_mul_f32 v[56:57], v[56:57], s[58:59]
    v_pk_mul_f32 v[38:39], v[38:39], s[58:59]
    v_pk_mul_f32 v[58:59], v[58:59], s[58:59]
    v_pk_mul_f32 v[40:41], v[40:41], s[58:59]
    v_pk_mul_f32 v[60:61], v[60:61], s[58:59]
    v_pk_mul_f32 v[42:43], v[42:43], s[58:59]
    v_pk_mul_f32 v[62:63], v[62:63], s[58:59]
    v_pk_mul_f32 v[184:185], v[184:185], v[24:25]
    v_pk_mul_f32 v[186:187], v[186:187], v[26:27]
    v_pk_mul_f32 v[204:205], v[204:205], v[24:25]
    v_pk_mul_f32 v[206:207], v[206:207], v[26:27]
    v_pk_mul_f32 v[188:189], v[188:189], v[28:29]
    v_pk_mul_f32 v[190:191], v[190:191], v[30:31]
    v_pk_mul_f32 v[208:209], v[208:209], v[28:29]
    v_pk_mul_f32 v[210:211], v[210:211], v[30:31]
    v_pk_mul_f32 v[192:193], v[192:193], v[32:33]
    v_pk_mul_f32 v[194:195], v[194:195], v[34:35]
    v_pk_mul_f32 v[212:213], v[212:213], v[32:33]
    v_pk_mul_f32 v[214:215], v[214:215], v[34:35]
    v_pk_mul_f32 v[196:197], v[196:197], v[36:37]
    v_pk_mul_f32 v[198:199], v[198:199], v[38:39]
    v_pk_mul_f32 v[216:217], v[216:217], v[36:37]
    v_pk_mul_f32 v[218:219], v[218:219], v[38:39]
    v_pk_mul_f32 v[200:201], v[200:201], v[40:41]
    v_pk_mul_f32 v[202:203], v[202:203], v[42:43]
    v_pk_mul_f32 v[220:221], v[220:221], v[40:41]
    v_pk_mul_f32 v[222:223], v[222:223], v[42:43]
    v_lshrrev_b32 v110, 3, v2
    v_mul_u32_u24 v110, 4352, v110
    v_bfe_u32 v111, v2, 1, 2
    v_mul_u32_u24 v111, 1056, v111
    v_and_b32 v116, 1, v2
    v_mul_u32_u24 v116, 1040, v116
    v_add3_u32 v110, v110, v111, v116
    v_add_u32 v110, s8, v110
    v_mov_b32 v112, 0
    v_mov_b32 v113, 0
    v_mov_b32 v114, 0
    v_mov_b32 v115, 0
    ds_write_b128 v110, v[112:115]
    v_and_b32 v110, 15, v2
    v_lshrrev_b32 v111, 4, v2
    v_lshlrev_b32 v110, 4, v110
    v_add_u32 v110, s8, v110
    v_mul_u32_u24 v116, 4352, v111
    v_add_u32 v110, v110, v116
    v_lshrrev_b32 v111, 1, v111
    v_mul_i32_i24 v13, -7648, v111
    v_mul_i32_i24 v14, -1056, v111
    v_lshlrev_b32 v15, 4, v111
    s_xor_b32 s14, s3, 3
    s_bfe_u32 s15, s14, 0x10001
    s_and_b32 s14, s14, 1
    s_mul_i32 s15, s15, 1056
    s_lshl_b32 s14, s14, 9
    s_add_u32 s14, s14, s15
    v_add_u32 v16, s14, v110
    s_xor_b32 s14, s3, 2
    s_bfe_u32 s15, s14, 0x10001
    s_and_b32 s14, s14, 1
    s_mul_i32 s15, s15, 1056
    s_lshl_b32 s14, s14, 9
    s_add_u32 s14, s14, s15
    v_add_u32 v17, s14, v110
    s_xor_b32 s14, s3, 1
    s_bfe_u32 s15, s14, 0x10001
    s_and_b32 s14, s14, 1
    s_mul_i32 s15, s15, 1056
    s_lshl_b32 s14, s14, 9
    s_add_u32 s14, s14, s15
    v_add_u32 v18, s14, v110
    s_xor_b32 s14, s3, 0
    s_bfe_u32 s15, s14, 0x10001
    s_and_b32 s14, s14, 1
    s_mul_i32 s15, s15, 1056
    s_lshl_b32 s14, s14, 9
    s_add_u32 s14, s14, s15
    v_add_u32 v19, s14, v110
    s_add_u32 s14, s8, 8704
    v_add_u32 v20, s14, v11
    s_xor_b32 s14, s3, 3
    s_mul_i32 s14, s14, 40960
    s_add_u32 s14, s14, 8704
    v_add_u32 v21, s14, v11
    s_xor_b32 s14, s3, 2
    s_mul_i32 s14, s14, 40960
    s_add_u32 s14, s14, 18944
    v_add_u32 v22, s14, v11
    s_xor_b32 s14, s3, 1
    s_mul_i32 s14, s14, 40960
    s_add_u32 s14, s14, 29184
    v_add_u32 v23, s14, v11
    s_max_u32 s14, s6, 1
    s_sub_u32 s14, s14, s6
    s_mul_i32 s14, s14, 0x7fff0000
    v_add_u32 v4, s14, v11
    s_min_u32 s14, s6, 61
    s_sub_u32 s14, s6, s14
    s_mul_i32 s14, s14, 0x7fff0000
    v_add_u32 v5, s14, v11
    v_and_b32 v3, 15, v2
    v_lshlrev_b32 v3, 13, v3
    v_bfe_u32 v117, v2, 4, 1
    v_lshl_add_u32 v3, v117, 5, v3
    v_lshrrev_b32 v117, 5, v2
    v_lshl_add_u32 v3, v117, 4, v3
    s_mul_i32 s14, s5, 320
    s_mul_i32 s15, s4, 80
    s_add_u32 s14, s14, s15
    s_lshl_b32 s14, s14, 13
    s_lshl_b32 s15, s6, 7
    s_add_u32 s14, s14, s15
    s_lshl_b32 s15, s3, 6
    s_add_u32 s14, s14, s15
    v_add_u32 v3, s14, v3
    v_cmp_ne_u32 vcc, s9, v249
    s_add_u32 s14, s7, 1
    v_mov_b32 v252, s14
    v_mov_b32 v253, s14
    v_mov_b32 v254, s14
    v_mov_b32 v255, s14
    s_lshr_b32 s14, vcc_lo, s3
    s_mov_b32 s1, 0
    s_bfe_u32 s15, s14, 0x10004
    s_lshl_b32 s0, 1, s15
    s_and_b32 s15, s14, 1
    s_lshl_b32 s15, 4, s15
    s_or_b32 s0, s0, s15
    s_bfe_u32 s15, s14, 0x10008
    s_lshl_b32 s15, 16, s15
    s_or_b32 s0, s0, s15
    s_add_u32 s13, s13, 0x10000
    v_add_u32 v248, 0x10000, v248
c1_wait2:
    s_mov_b32 s52, 0
    s_mov_b32 s53, 131072
    s_mov_b32 s54, 262144
    s_mov_b32 s55, 393216
    s_mov_b32 s56, 524288
    v_mov_b32 v8, 40832
    s_waitcnt lgkmcnt(0)
    s_barrier
    ds_read_b64 v[6:7], v8
    s_add_u32 s44, s38, 0x200000
    s_addc_u32 s45, s39, 0
    s_mov_b32 s46, 0x1cc000
    s_mov_b32 s47, 0x00020000
    s_waitcnt lgkmcnt(0)
    v_mul_f32 v6, v6, v7
    v_sub_f32 v6, 0, v6
    v_pk_fma_f32 v[44:45], v[24:25], v[6:7], v[44:45] op_sel_hi:[1,0,1]
    v_pk_fma_f32 v[46:47], v[26:27], v[6:7], v[46:47] op_sel_hi:[1,0,1]
    s_add_u32 s12, s10, 0
    buffer_load_dwordx4 a[32:35], v11, s[44:47], s12 offen offset:0 sc1
    buffer_load_dwordx4 a[36:39], v11, s[44:47], s12 offen offset:1024 sc1
    v_pk_fma_f32 v[184:185], v[184:185], v[6:7], v[44:45] op_sel:[0,1,0] op_sel_hi:[1,1,1]
    v_pk_fma_f32 v[186:187], v[186:187], v[6:7], v[46:47] op_sel:[0,1,0] op_sel_hi:[1,1,1]
    v_pk_fma_f32 v[204:205], v[204:205], v[6:7], v[44:45] op_sel:[0,1,0] op_sel_hi:[1,1,1]
    v_pk_fma_f32 v[206:207], v[206:207], v[6:7], v[46:47] op_sel:[0,1,0] op_sel_hi:[1,1,1]
    v_exp_f32 v64, v184
    v_exp_f32 v65, v185
    v_exp_f32 v66, v186
    v_exp_f32 v67, v187
    v_exp_f32 v68, v204
    v_exp_f32 v69, v205
    v_exp_f32 v70, v206
    v_exp_f32 v71, v207
    buffer_load_dwordx4 a[40:43], v11, s[44:47], s12 offen offset:2048 sc1
    buffer_load_dwordx4 a[44:47], v11, s[44:47], s12 offen offset:3072 sc1
    v_pk_fma_f32 v[64:65], v[64:65], s[58:59], s[58:59]
    v_pk_fma_f32 v[66:67], v[66:67], s[58:59], s[58:59]
    v_pk_fma_f32 v[68:69], v[68:69], s[58:59], s[58:59]
    v_pk_fma_f32 v[70:71], v[70:71], s[58:59], s[58:59]
    v_rcp_f32 v64, v64
    v_rcp_f32 v65, v65
    v_rcp_f32 v66, v66
    v_rcp_f32 v67, v67
    v_rcp_f32 v68, v68
    v_rcp_f32 v69, v69
    v_rcp_f32 v70, v70
    v_rcp_f32 v71, v71
    buffer_load_dwordx4 a[48:51], v1, s[44:47], s12 offen sc1
    s_add_u32 s12, s10, 5120
    buffer_load_dwordx4 a[52:55], v11, s[44:47], s12 offen offset:0 sc1
    v_pk_mul_f32 v[184:185], v[184:185], v[64:65]
    v_pk_mul_f32 v[186:187], v[186:187], v[66:67]
    v_cvt_pk_bf16_f32 v224, v184, v185
    v_cvt_pk_bf16_f32 v225, v186, v187
    v_pk_mul_f32 v[204:205], v[204:205], v[68:69]
    v_pk_mul_f32 v[206:207], v[206:207], v[70:71]
    v_cvt_pk_bf16_f32 v226, v204, v205
    v_cvt_pk_bf16_f32 v227, v206, v207
    s_nop 0
    v_permlane16_swap_b32 v224, v226
    v_permlane16_swap_b32 v225, v227
    buffer_store_dwordx4 v[224:227], v9, s[60:63], s52 offen sc1
    v_pk_fma_f32 v[48:49], v[28:29], v[6:7], v[48:49] op_sel_hi:[1,0,1]
    v_pk_fma_f32 v[50:51], v[30:31], v[6:7], v[50:51] op_sel_hi:[1,0,1]
    buffer_load_dwordx4 a[56:59], v11, s[44:47], s12 offen offset:1024 sc1
    buffer_load_dwordx4 a[60:63], v11, s[44:47], s12 offen offset:2048 sc1
    v_pk_fma_f32 v[188:189], v[188:189], v[6:7], v[48:49] op_sel:[0,1,0] op_sel_hi:[1,1,1]
    v_pk_fma_f32 v[190:191], v[190:191], v[6:7], v[50:51] op_sel:[0,1,0] op_sel_hi:[1,1,1]
    v_pk_fma_f32 v[208:209], v[208:209], v[6:7], v[48:49] op_sel:[0,1,0] op_sel_hi:[1,1,1]
    v_pk_fma_f32 v[210:211], v[210:211], v[6:7], v[50:51] op_sel:[0,1,0] op_sel_hi:[1,1,1]
    v_exp_f32 v72, v188
    v_exp_f32 v73, v189
    v_exp_f32 v74, v190
    v_exp_f32 v75, v191
    v_exp_f32 v76, v208
    v_exp_f32 v77, v209
    v_exp_f32 v78, v210
    v_exp_f32 v79, v211
    buffer_load_dwordx4 a[64:67], v11, s[44:47], s12 offen offset:3072 sc1
    buffer_load_dwordx4 a[68:71], v1, s[44:47], s12 offen sc1
    v_pk_fma_f32 v[72:73], v[72:73], s[58:59], s[58:59]
    v_pk_fma_f32 v[74:75], v[74:75], s[58:59], s[58:59]
    v_pk_fma_f32 v[76:77], v[76:77], s[58:59], s[58:59]
    v_pk_fma_f32 v[78:79], v[78:79], s[58:59], s[58:59]
    v_rcp_f32 v72, v72
    v_rcp_f32 v73, v73
    v_rcp_f32 v74, v74
    v_rcp_f32 v75, v75
    v_rcp_f32 v76, v76
    v_rcp_f32 v77, v77
    v_rcp_f32 v78, v78
    v_rcp_f32 v79, v79
    v_pk_mul_f32 v[188:189], v[188:189], v[72:73]
    v_pk_mul_f32 v[190:191], v[190:191], v[74:75]
    v_cvt_pk_bf16_f32 v228, v188, v189
    v_cvt_pk_bf16_f32 v229, v190, v191
    v_pk_mul_f32 v[208:209], v[208:209], v[76:77]
    v_pk_mul_f32 v[210:211], v[210:211], v[78:79]
    v_cvt_pk_bf16_f32 v230, v208, v209
    v_cvt_pk_bf16_f32 v231, v210, v211
    s_nop 0
    v_permlane16_swap_b32 v228, v230
    v_permlane16_swap_b32 v229, v231
    buffer_store_dwordx4 v[228:231], v9, s[60:63], s53 offen sc1
    v_pk_fma_f32 v[52:53], v[32:33], v[6:7], v[52:53] op_sel_hi:[1,0,1]
    v_pk_fma_f32 v[54:55], v[34:35], v[6:7], v[54:55] op_sel_hi:[1,0,1]
    v_pk_fma_f32 v[192:193], v[192:193], v[6:7], v[52:53] op_sel:[0,1,0] op_sel_hi:[1,1,1]
    v_pk_fma_f32 v[194:195], v[194:195], v[6:7], v[54:55] op_sel:[0,1,0] op_sel_hi:[1,1,1]
    v_pk_fma_f32 v[212:213], v[212:213], v[6:7], v[52:53] op_sel:[0,1,0] op_sel_hi:[1,1,1]
    v_pk_fma_f32 v[214:215], v[214:215], v[6:7], v[54:55] op_sel:[0,1,0] op_sel_hi:[1,1,1]
    v_exp_f32 v64, v192
    v_exp_f32 v65, v193
    v_exp_f32 v66, v194
    v_exp_f32 v67, v195
    v_exp_f32 v68, v212
    v_exp_f32 v69, v213
    v_exp_f32 v70, v214
    v_exp_f32 v71, v215
    v_pk_fma_f32 v[64:65], v[64:65], s[58:59], s[58:59]
    v_pk_fma_f32 v[66:67], v[66:67], s[58:59], s[58:59]
    v_pk_fma_f32 v[68:69], v[68:69], s[58:59], s[58:59]
    v_pk_fma_f32 v[70:71], v[70:71], s[58:59], s[58:59]
    v_rcp_f32 v64, v64
    v_rcp_f32 v65, v65
    v_rcp_f32 v66, v66
    v_rcp_f32 v67, v67
    v_rcp_f32 v68, v68
    v_rcp_f32 v69, v69
    v_rcp_f32 v70, v70
    v_rcp_f32 v71, v71
    v_pk_mul_f32 v[192:193], v[192:193], v[64:65]
    v_pk_mul_f32 v[194:195], v[194:195], v[66:67]
    v_cvt_pk_bf16_f32 v232, v192, v193
    v_cvt_pk_bf16_f32 v233, v194, v195
    v_pk_mul_f32 v[212:213], v[212:213], v[68:69]
    v_pk_mul_f32 v[214:215], v[214:215], v[70:71]
    v_cvt_pk_bf16_f32 v234, v212, v213
    v_cvt_pk_bf16_f32 v235, v214, v215
    s_nop 0
    v_permlane16_swap_b32 v232, v234
    v_permlane16_swap_b32 v233, v235
    buffer_store_dwordx4 v[232:235], v9, s[60:63], s54 offen sc1
    v_pk_fma_f32 v[56:57], v[36:37], v[6:7], v[56:57] op_sel_hi:[1,0,1]
    v_pk_fma_f32 v[58:59], v[38:39], v[6:7], v[58:59] op_sel_hi:[1,0,1]
    v_pk_fma_f32 v[196:197], v[196:197], v[6:7], v[56:57] op_sel:[0,1,0] op_sel_hi:[1,1,1]
    v_pk_fma_f32 v[198:199], v[198:199], v[6:7], v[58:59] op_sel:[0,1,0] op_sel_hi:[1,1,1]
    v_pk_fma_f32 v[216:217], v[216:217], v[6:7], v[56:57] op_sel:[0,1,0] op_sel_hi:[1,1,1]
    v_pk_fma_f32 v[218:219], v[218:219], v[6:7], v[58:59] op_sel:[0,1,0] op_sel_hi:[1,1,1]
    v_exp_f32 v72, v196
    v_exp_f32 v73, v197
    v_exp_f32 v74, v198
    v_exp_f32 v75, v199
    v_exp_f32 v76, v216
    v_exp_f32 v77, v217
    v_exp_f32 v78, v218
    v_exp_f32 v79, v219
    v_pk_fma_f32 v[72:73], v[72:73], s[58:59], s[58:59]
    v_pk_fma_f32 v[74:75], v[74:75], s[58:59], s[58:59]
    v_pk_fma_f32 v[76:77], v[76:77], s[58:59], s[58:59]
    v_pk_fma_f32 v[78:79], v[78:79], s[58:59], s[58:59]
    v_rcp_f32 v72, v72
    v_rcp_f32 v73, v73
    v_rcp_f32 v74, v74
    v_rcp_f32 v75, v75
    v_rcp_f32 v76, v76
    v_rcp_f32 v77, v77
    v_rcp_f32 v78, v78
    v_rcp_f32 v79, v79
    v_pk_mul_f32 v[196:197], v[196:197], v[72:73]
    v_pk_mul_f32 v[198:199], v[198:199], v[74:75]
    v_cvt_pk_bf16_f32 v236, v196, v197
    v_cvt_pk_bf16_f32 v237, v198, v199
    v_pk_mul_f32 v[216:217], v[216:217], v[76:77]
    v_pk_mul_f32 v[218:219], v[218:219], v[78:79]
    v_cvt_pk_bf16_f32 v238, v216, v217
    v_cvt_pk_bf16_f32 v239, v218, v219
    s_nop 0
    v_permlane16_swap_b32 v236, v238
    v_permlane16_swap_b32 v237, v239
    buffer_store_dwordx4 v[236:239], v9, s[60:63], s55 offen sc1
    v_pk_fma_f32 v[60:61], v[40:41], v[6:7], v[60:61] op_sel_hi:[1,0,1]
    v_pk_fma_f32 v[62:63], v[42:43], v[6:7], v[62:63] op_sel_hi:[1,0,1]
    v_pk_fma_f32 v[200:201], v[200:201], v[6:7], v[60:61] op_sel:[0,1,0] op_sel_hi:[1,1,1]
    v_pk_fma_f32 v[202:203], v[202:203], v[6:7], v[62:63] op_sel:[0,1,0] op_sel_hi:[1,1,1]
    v_pk_fma_f32 v[220:221], v[220:221], v[6:7], v[60:61] op_sel:[0,1,0] op_sel_hi:[1,1,1]
    v_pk_fma_f32 v[222:223], v[222:223], v[6:7], v[62:63] op_sel:[0,1,0] op_sel_hi:[1,1,1]
    v_exp_f32 v64, v200
    v_exp_f32 v65, v201
    v_exp_f32 v66, v202
    v_exp_f32 v67, v203
    v_exp_f32 v68, v220
    v_exp_f32 v69, v221
    v_exp_f32 v70, v222
    v_exp_f32 v71, v223
    v_pk_fma_f32 v[64:65], v[64:65], s[58:59], s[58:59]
    v_pk_fma_f32 v[66:67], v[66:67], s[58:59], s[58:59]
    v_pk_fma_f32 v[68:69], v[68:69], s[58:59], s[58:59]
    v_pk_fma_f32 v[70:71], v[70:71], s[58:59], s[58:59]
    v_rcp_f32 v64, v64
    v_rcp_f32 v65, v65
    v_rcp_f32 v66, v66
    v_rcp_f32 v67, v67
    v_rcp_f32 v68, v68
    v_rcp_f32 v69, v69
    v_rcp_f32 v70, v70
    v_rcp_f32 v71, v71
    v_pk_mul_f32 v[200:201], v[200:201], v[64:65]
    v_pk_mul_f32 v[202:203], v[202:203], v[66:67]
    v_cvt_pk_bf16_f32 v240, v200, v201
    v_cvt_pk_bf16_f32 v241, v202, v203
    v_pk_mul_f32 v[220:221], v[220:221], v[68:69]
    v_pk_mul_f32 v[222:223], v[222:223], v[70:71]
    v_cvt_pk_bf16_f32 v242, v220, v221
    v_cvt_pk_bf16_f32 v243, v222, v223
    s_nop 0
    v_permlane16_swap_b32 v240, v242
    v_permlane16_swap_b32 v241, v243
    buffer_store_dwordx4 v[240:243], v9, s[60:63], s56 offen sc1
    s_lshl_b32 s14, s3, 2
    s_add_u32 s14, s14, s13
    s_waitcnt vmcnt(0)
    s_mov_b64 exec, 1
    buffer_store_dword v10, v0, s[92:95], s14 offen
    s_mov_b64 exec, -1
    s_add_u32 s40, s38, 0xa00000
    s_addc_u32 s41, s39, 0
    s_mov_b32 s42, 0x500000
    s_mov_b32 s43, 0x00020000
    s_cmp_lt_u32 s3, 2
    s_cselect_b32 s96, s66, s65
    s_cselect_b32 s97, s65, s66
    s_cselect_b32 s11, 1056, 0
    s_cselect_b32 s12, 0, 1056
    s_add_u32 s98, s8, s11
    s_add_u32 s99, s8, s12
    s_and_b64 exec, s[0:1], 3
    buffer_load_dwordx4 v[252:255], v248, s[92:95], 0 offen sc1
    s_mov_b64 exec, -1
    s_waitcnt vmcnt(0)
    s_mov_b32 s15, 0
c2_own_chk:
    v_min3_u32 v250, v252, v253, v254
    v_max3_u32 v251, v252, v253, v254
    v_min_u32 v250, v250, v255
    v_max_u32 v251, v251, v255
    v_cmp_eq_u32 vcc, s7, v250
    v_cmp_eq_u32 s[50:51], s7, v251
    s_nop 0
    s_and_b64 vcc, vcc, s[50:51]
    s_add_u32 s15, s15, 1
    s_and_b32 s14, vcc_lo, 3
    s_cbranch_scc1 c2_own_ok
    s_cmp_ge_u32 s15, 0x40000
    s_cbranch_scc1 c2_own_ok
    s_cmp_ge_u32 s15, 24
    s_cbranch_scc1 c2_own_both
    s_cmp_lg_u32 s15, 5
    s_cbranch_scc1 c2_own_nofs
    s_lshl_b32 s14, s3, 2
    s_add_u32 s14, s14, s13
    s_add_u32 s14, s14, 0x8000
    s_mov_b64 exec, 1
    buffer_store_dword v10, v0, s[92:95], s14 offen sc1
    s_mov_b64 exec, -1
c2_own_nofs:
    s_and_b64 exec, s[0:1], 3
    buffer_load_dwordx4 v[252:255], v248, s[92:95], 0 offen sc1
    s_mov_b64 exec, -1
    s_waitcnt vmcnt(0)
    s_branch c2_own_chk
c2_own_both:
    s_mov_b64 exec, 3
    buffer_load_dwordx4 v[252:255], v248, s[92:95], 0 offen sc1
    s_mov_b64 exec, -1
    s_waitcnt vmcnt(0)
    s_branch c2_own_chk
c2_own_ok:
    s_add_u32 m0, s98, 1072
    s_add_u32 s11, s96, 0
    buffer_load_dwordx4 v11, s[40:43], s11 offen sc1 lds
    s_add_u32 m0, s98, 5424
    s_add_u32 s11, s96, 65536
    buffer_load_dwordx4 v11, s[40:43], s11 offen sc1 lds
    s_add_u32 m0, s98, 9776
    s_add_u32 s11, s96, 131072
    buffer_load_dwordx4 v11, s[40:43], s11 offen sc1 lds
    s_add_u32 m0, s98, 14128
    s_add_u32 s11, s96, 196608
    buffer_load_dwordx4 v11, s[40:43], s11 offen sc1 lds
    s_add_u32 m0, s99, 1072
    s_add_u32 s11, s97, 0
    buffer_load_dwordx4 v11, s[40:43], s11 offen sc1 lds
    s_add_u32 m0, s99, 5424
    s_add_u32 s11, s97, 65536
    buffer_load_dwordx4 v11, s[40:43], s11 offen sc1 lds
    s_add_u32 m0, s99, 9776
    s_add_u32 s11, s97, 131072
    buffer_load_dwordx4 v11, s[40:43], s11 offen sc1 lds
    s_add_u32 m0, s99, 14128
    s_add_u32 s11, s97, 196608
    buffer_load_dwordx4 v11, s[40:43], s11 offen sc1 lds
    s_lshl_b32 s14, s3, 2
    s_add_u32 s14, s14, s13
    s_add_u32 s14, s14, 0x8000
    s_mov_b64 exec, 1
    buffer_store_dword v10, v0, s[92:95], s14 offen sc1
    s_mov_b64 exec, -1
    s_waitcnt lgkmcnt(0)
    s_mov_b32 s52, s16
    s_mov_b32 s53, s17
    s_mov_b32 s54, 0x500000
    s_mov_b32 s55, 0x00020000
    s_mov_b32 s60, s34
    s_mov_b32 s61, s35
    s_mov_b32 s62, 0x500000
    s_mov_b32 s63, 0x00020000
    s_mov_b32 s56, 131072
    s_mov_b32 s57, 262144
    s_mov_b32 s58, 393216
    s_mov_b32 s59, 524288
    s_waitcnt vmcnt(5)
    ds_read_b128 a[0:3], v16 offset:1056
    ds_read_b128 a[4:7], v16 offset:1312
    ds_read_b128 a[8:11], v17 offset:1056
    ds_read_b128 a[12:15], v17 offset:1312
    s_waitcnt lgkmcnt(0)
    v_mfma_f32_16x16x32_bf16 v[64:67], a[0:3], a[32:35], 0
    v_mfma_f32_16x16x32_bf16 v[68:71], a[0:3], a[36:39], 0
    v_mfma_f32_16x16x32_bf16 v[72:75], a[0:3], a[40:43], 0
    s_add_u32 m0, s8, 18480
    s_add_u32 s11, s65, 262144
    buffer_load_dwordx4 v11, s[40:43], s11 offen sc1 lds
    v_mfma_f32_16x16x32_bf16 v[76:79], a[0:3], a[44:47], 0
    v_mfma_f32_16x16x32_bf16 v[80:83], a[0:3], a[48:51], 0
    s_add_u32 m0, s8, 19536
    s_add_u32 s11, s66, 262144
    buffer_load_dwordx4 v11, s[40:43], s11 offen sc1 lds
    v_mfma_f32_16x16x32_bf16 v[84:87], a[4:7], a[32:35], 0
    ds_read_b128 a[0:3], v16 offset:1072
    v_mfma_f32_16x16x32_bf16 v[88:91], a[4:7], a[36:39], 0
    v_mfma_f32_16x16x32_bf16 v[92:95], a[4:7], a[40:43], 0
    s_add_u32 m0, s8, 22832
    s_add_u32 s11, s65, 327680
    buffer_load_dwordx4 v11, s[40:43], s11 offen sc1 lds
    v_mfma_f32_16x16x32_bf16 v[96:99], a[4:7], a[44:47], 0
    v_mfma_f32_16x16x32_bf16 v[100:103], a[4:7], a[48:51], 0
    s_waitcnt vmcnt(4)
    ds_read_b128 a[16:19], v18 offset:1056
    ds_read_b128 a[20:23], v18 offset:1312
    ds_read_b128 a[24:27], v19 offset:1056
    ds_read_b128 a[28:31], v19 offset:1312
    v_mfma_f32_16x16x32_bf16 v[104:107], a[8:11], a[32:35], 0
    ds_read_b128 a[4:7], v16 offset:1328
    v_mfma_f32_16x16x32_bf16 v[108:111], a[8:11], a[36:39], 0
    s_add_u32 m0, s8, 23888
    s_add_u32 s11, s66, 327680
    buffer_load_dwordx4 v11, s[40:43], s11 offen sc1 lds
    v_mfma_f32_16x16x32_bf16 v[112:115], a[8:11], a[40:43], 0
    v_mfma_f32_16x16x32_bf16 v[116:119], a[8:11], a[44:47], 0
    s_add_u32 m0, s8, 27184
    s_add_u32 s11, s65, 393216
    buffer_load_dwordx4 v11, s[40:43], s11 offen sc1 lds
    v_mfma_f32_16x16x32_bf16 v[120:123], a[8:11], a[48:51], 0
    v_mfma_f32_16x16x32_bf16 v[124:127], a[12:15], a[32:35], 0
    ds_read_b128 a[8:11], v17 offset:1072
    v_mfma_f32_16x16x32_bf16 v[128:131], a[12:15], a[36:39], 0
    s_add_u32 m0, s8, 28240
    s_add_u32 s11, s66, 393216
    buffer_load_dwordx4 v11, s[40:43], s11 offen sc1 lds
    v_mfma_f32_16x16x32_bf16 v[132:135], a[12:15], a[40:43], 0
    v_mfma_f32_16x16x32_bf16 v[136:139], a[12:15], a[44:47], 0
    v_mfma_f32_16x16x32_bf16 v[140:143], a[12:15], a[48:51], 0
    s_waitcnt lgkmcnt(2)
    v_mfma_f32_16x16x32_bf16 v[144:147], a[16:19], a[32:35], 0
    ds_read_b128 a[12:15], v17 offset:1328
    v_mfma_f32_16x16x32_bf16 v[148:151], a[16:19], a[36:39], 0
    s_add_u32 m0, s8, 31536
    s_add_u32 s11, s65, 458752
    buffer_load_dwordx4 v11, s[40:43], s11 offen sc1 lds
    v_mfma_f32_16x16x32_bf16 v[152:155], a[16:19], a[40:43], 0
    v_mfma_f32_16x16x32_bf16 v[156:159], a[16:19], a[44:47], 0
    s_add_u32 m0, s8, 32592
    s_add_u32 s11, s66, 458752
    buffer_load_dwordx4 v11, s[40:43], s11 offen sc1 lds
    v_mfma_f32_16x16x32_bf16 v[160:163], a[16:19], a[48:51], 0
    v_mfma_f32_16x16x32_bf16 v[164:167], a[20:23], a[32:35], 0
    ds_read_b128 a[16:19], v18 offset:1072
    v_mfma_f32_16x16x32_bf16 v[168:171], a[20:23], a[36:39], 0
    s_add_u32 s12, s10, 10240
    buffer_load_dwordx4 a[72:75], v11, s[44:47], s12 offen offset:0 sc1
    v_mfma_f32_16x16x32_bf16 v[172:175], a[20:23], a[40:43], 0
    v_mfma_f32_16x16x32_bf16 v[176:179], a[20:23], a[44:47], 0
    buffer_load_dwordx4 a[76:79], v11, s[44:47], s12 offen offset:1024 sc1
    v_mfma_f32_16x16x32_bf16 v[180:183], a[20:23], a[48:51], 0
    v_mfma_f32_16x16x32_bf16 v[184:187], a[24:27], a[32:35], 0
    ds_read_b128 a[20:23], v18 offset:1328
    v_mfma_f32_16x16x32_bf16 v[188:191], a[24:27], a[36:39], 0
    v_mfma_f32_16x16x32_bf16 v[192:195], a[24:27], a[40:43], 0
    buffer_load_dwordx4 a[80:83], v11, s[44:47], s12 offen offset:2048 sc1
    v_mfma_f32_16x16x32_bf16 v[196:199], a[24:27], a[44:47], 0
    v_mfma_f32_16x16x32_bf16 v[200:203], a[24:27], a[48:51], 0
    buffer_load_dwordx4 a[84:87], v11, s[44:47], s12 offen offset:3072 sc1
    v_mfma_f32_16x16x32_bf16 v[204:207], a[28:31], a[32:35], 0
    ds_read_b128 a[24:27], v19 offset:1072
    v_mfma_f32_16x16x32_bf16 v[208:211], a[28:31], a[36:39], 0
    v_mfma_f32_16x16x32_bf16 v[212:215], a[28:31], a[40:43], 0
    buffer_load_dwordx4 a[88:91], v1, s[44:47], s12 offen sc1
    v_mfma_f32_16x16x32_bf16 v[216:219], a[28:31], a[44:47], 0
    v_mfma_f32_16x16x32_bf16 v[220:223], a[28:31], a[48:51], 0
    s_waitcnt lgkmcnt(3)
    v_mfma_f32_16x16x32_bf16 v[64:67], a[0:3], a[52:55], v[64:67]
    ds_read_b128 a[28:31], v19 offset:1328
    v_mfma_f32_16x16x32_bf16 v[68:71], a[0:3], a[56:59], v[68:71]
    v_mfma_f32_16x16x32_bf16 v[72:75], a[0:3], a[60:63], v[72:75]
    s_add_u32 s12, s10, 15360
    buffer_load_dwordx4 a[92:95], v11, s[44:47], s12 offen offset:0 sc1
    v_mfma_f32_16x16x32_bf16 v[76:79], a[0:3], a[64:67], v[76:79]
    v_mfma_f32_16x16x32_bf16 v[80:83], a[0:3], a[68:71], v[80:83]
    v_mfma_f32_16x16x32_bf16 v[84:87], a[4:7], a[52:55], v[84:87]
    ds_read_b128 a[0:3], v16 offset:1088
    v_mfma_f32_16x16x32_bf16 v[88:91], a[4:7], a[56:59], v[88:91]
    v_mfma_f32_16x16x32_bf16 v[92:95], a[4:7], a[60:63], v[92:95]
    buffer_load_dwordx4 a[96:99], v11, s[44:47], s12 offen offset:1024 sc1
    v_mfma_f32_16x16x32_bf16 v[96:99], a[4:7], a[64:67], v[96:99]
    v_mfma_f32_16x16x32_bf16 v[100:103], a[4:7], a[68:71], v[100:103]
    v_mfma_f32_16x16x32_bf16 v[104:107], a[8:11], a[52:55], v[104:107]
    ds_read_b128 a[4:7], v16 offset:1344
    v_mfma_f32_16x16x32_bf16 v[108:111], a[8:11], a[56:59], v[108:111]
    v_mfma_f32_16x16x32_bf16 v[112:115], a[8:11], a[60:63], v[112:115]
    buffer_load_dwordx4 a[100:103], v11, s[44:47], s12 offen offset:2048 sc1
    v_mfma_f32_16x16x32_bf16 v[116:119], a[8:11], a[64:67], v[116:119]
    v_mfma_f32_16x16x32_bf16 v[120:123], a[8:11], a[68:71], v[120:123]
    v_mfma_f32_16x16x32_bf16 v[124:127], a[12:15], a[52:55], v[124:127]
    ds_read_b128 a[8:11], v17 offset:1088
    v_mfma_f32_16x16x32_bf16 v[128:131], a[12:15], a[56:59], v[128:131]
    v_mfma_f32_16x16x32_bf16 v[132:135], a[12:15], a[60:63], v[132:135]
    buffer_load_dwordx4 a[104:107], v11, s[44:47], s12 offen offset:3072 sc1
    v_mfma_f32_16x16x32_bf16 v[136:139], a[12:15], a[64:67], v[136:139]
    v_mfma_f32_16x16x32_bf16 v[140:143], a[12:15], a[68:71], v[140:143]
    s_waitcnt lgkmcnt(3)
    v_mfma_f32_16x16x32_bf16 v[144:147], a[16:19], a[52:55], v[144:147]
    ds_read_b128 a[12:15], v17 offset:1344
    v_mfma_f32_16x16x32_bf16 v[148:151], a[16:19], a[56:59], v[148:151]
    v_mfma_f32_16x16x32_bf16 v[152:155], a[16:19], a[60:63], v[152:155]
    buffer_load_dwordx4 a[108:111], v1, s[44:47], s12 offen sc1
    v_mfma_f32_16x16x32_bf16 v[156:159], a[16:19], a[64:67], v[156:159]
    v_mfma_f32_16x16x32_bf16 v[160:163], a[16:19], a[68:71], v[160:163]
    v_mfma_f32_16x16x32_bf16 v[164:167], a[20:23], a[52:55], v[164:167]
    ds_read_b128 a[16:19], v18 offset:1088
    v_mfma_f32_16x16x32_bf16 v[168:171], a[20:23], a[56:59], v[168:171]
    v_mfma_f32_16x16x32_bf16 v[172:175], a[20:23], a[60:63], v[172:175]
    s_add_u32 s12, s10, 20480
    buffer_load_dwordx4 a[112:115], v11, s[44:47], s12 offen offset:0 sc1
    v_mfma_f32_16x16x32_bf16 v[176:179], a[20:23], a[64:67], v[176:179]
    v_mfma_f32_16x16x32_bf16 v[180:183], a[20:23], a[68:71], v[180:183]
    v_mfma_f32_16x16x32_bf16 v[184:187], a[24:27], a[52:55], v[184:187]
    ds_read_b128 a[20:23], v18 offset:1344
    v_mfma_f32_16x16x32_bf16 v[188:191], a[24:27], a[56:59], v[188:191]
    v_mfma_f32_16x16x32_bf16 v[192:195], a[24:27], a[60:63], v[192:195]
    buffer_load_dwordx4 a[116:119], v11, s[44:47], s12 offen offset:1024 sc1
    v_mfma_f32_16x16x32_bf16 v[196:199], a[24:27], a[64:67], v[196:199]
    v_mfma_f32_16x16x32_bf16 v[200:203], a[24:27], a[68:71], v[200:203]
    v_mfma_f32_16x16x32_bf16 v[204:207], a[28:31], a[52:55], v[204:207]
    ds_read_b128 a[24:27], v19 offset:1088
    v_mfma_f32_16x16x32_bf16 v[208:211], a[28:31], a[56:59], v[208:211]
    v_mfma_f32_16x16x32_bf16 v[212:215], a[28:31], a[60:63], v[212:215]
    buffer_load_dwordx4 a[120:123], v11, s[44:47], s12 offen offset:2048 sc1
    v_mfma_f32_16x16x32_bf16 v[216:219], a[28:31], a[64:67], v[216:219]
    v_mfma_f32_16x16x32_bf16 v[220:223], a[28:31], a[68:71], v[220:223]
    s_waitcnt vmcnt(8)
    s_waitcnt lgkmcnt(3)
    v_mfma_f32_16x16x32_bf16 v[64:67], a[0:3], a[72:75], v[64:67]
    ds_read_b128 a[28:31], v19 offset:1344
    v_mfma_f32_16x16x32_bf16 v[68:71], a[0:3], a[76:79], v[68:71]
    v_mfma_f32_16x16x32_bf16 v[72:75], a[0:3], a[80:83], v[72:75]
    s_and_b64 exec, s[0:1], 12
    buffer_load_dwordx4 v[252:255], v248, s[92:95], 0 offen sc1
    s_mov_b64 exec, -1
    v_mfma_f32_16x16x32_bf16 v[76:79], a[0:3], a[84:87], v[76:79]
    v_mfma_f32_16x16x32_bf16 v[80:83], a[0:3], a[88:91], v[80:83]
    v_mfma_f32_16x16x32_bf16 v[84:87], a[4:7], a[72:75], v[84:87]
    ds_read_b128 a[0:3], v16 offset:18464
    v_mfma_f32_16x16x32_bf16 v[88:91], a[4:7], a[76:79], v[88:91]
    v_mfma_f32_16x16x32_bf16 v[92:95], a[4:7], a[80:83], v[92:95]
    buffer_load_dwordx4 a[124:127], v11, s[44:47], s12 offen offset:3072 sc1
    v_mfma_f32_16x16x32_bf16 v[96:99], a[4:7], a[84:87], v[96:99]
    v_mfma_f32_16x16x32_bf16 v[100:103], a[4:7], a[88:91], v[100:103]
    v_mfma_f32_16x16x32_bf16 v[104:107], a[8:11], a[72:75], v[104:107]
    ds_read_b128 a[4:7], v16 offset:18720
    v_mfma_f32_16x16x32_bf16 v[108:111], a[8:11], a[76:79], v[108:111]
    buffer_load_dwordx4 a[128:131], v1, s[44:47], s12 offen sc1
    v_mfma_f32_16x16x32_bf16 v[112:115], a[8:11], a[80:83], v[112:115]
    v_mfma_f32_16x16x32_bf16 v[116:119], a[8:11], a[84:87], v[116:119]
    v_mfma_f32_16x16x32_bf16 v[120:123], a[8:11], a[88:91], v[120:123]
    buffer_load_dwordx4 v[24:27], v3, s[52:55], 0 offen
    v_mfma_f32_16x16x32_bf16 v[124:127], a[12:15], a[72:75], v[124:127]
    ds_read_b128 a[8:11], v17 offset:18464
    v_mfma_f32_16x16x32_bf16 v[128:131], a[12:15], a[76:79], v[128:131]
    v_mfma_f32_16x16x32_bf16 v[132:135], a[12:15], a[80:83], v[132:135]
    v_mfma_f32_16x16x32_bf16 v[136:139], a[12:15], a[84:87], v[136:139]
    v_mfma_f32_16x16x32_bf16 v[140:143], a[12:15], a[88:91], v[140:143]
    s_waitcnt lgkmcnt(3)
    v_mfma_f32_16x16x32_bf16 v[144:147], a[16:19], a[72:75], v[144:147]
    ds_read_b128 a[12:15], v17 offset:18720
    v_mfma_f32_16x16x32_bf16 v[148:151], a[16:19], a[76:79], v[148:151]
    s_add_u32 s12, s10, 25600
    buffer_load_dwordx4 a[132:135], v11, s[44:47], s12 offen offset:0 sc1
    v_mfma_f32_16x16x32_bf16 v[152:155], a[16:19], a[80:83], v[152:155]
    v_mfma_f32_16x16x32_bf16 v[156:159], a[16:19], a[84:87], v[156:159]
    v_mfma_f32_16x16x32_bf16 v[160:163], a[16:19], a[88:91], v[160:163]
    buffer_load_dwordx4 a[136:139], v11, s[44:47], s12 offen offset:1024 sc1
    v_mfma_f32_16x16x32_bf16 v[164:167], a[20:23], a[72:75], v[164:167]
    ds_read_b128 a[16:19], v18 offset:18464
    v_mfma_f32_16x16x32_bf16 v[168:171], a[20:23], a[76:79], v[168:171]
    v_mfma_f32_16x16x32_bf16 v[172:175], a[20:23], a[80:83], v[172:175]
    v_mfma_f32_16x16x32_bf16 v[176:179], a[20:23], a[84:87], v[176:179]
    buffer_load_dwordx4 a[140:143], v11, s[44:47], s12 offen offset:2048 sc1
    v_mfma_f32_16x16x32_bf16 v[180:183], a[20:23], a[88:91], v[180:183]
    v_mfma_f32_16x16x32_bf16 v[184:187], a[24:27], a[72:75], v[184:187]
    ds_read_b128 a[20:23], v18 offset:18720
    v_mfma_f32_16x16x32_bf16 v[188:191], a[24:27], a[76:79], v[188:191]
    v_mfma_f32_16x16x32_bf16 v[192:195], a[24:27], a[80:83], v[192:195]
    v_mfma_f32_16x16x32_bf16 v[196:199], a[24:27], a[84:87], v[196:199]
    buffer_load_dwordx4 a[144:147], v11, s[44:47], s12 offen offset:3072 sc1
    v_mfma_f32_16x16x32_bf16 v[200:203], a[24:27], a[88:91], v[200:203]
    v_mfma_f32_16x16x32_bf16 v[204:207], a[28:31], a[72:75], v[204:207]
    ds_read_b128 a[24:27], v19 offset:18464
    v_mfma_f32_16x16x32_bf16 v[208:211], a[28:31], a[76:79], v[208:211]
    v_mfma_f32_16x16x32_bf16 v[212:215], a[28:31], a[80:83], v[212:215]
    buffer_load_dwordx4 a[148:151], v1, s[44:47], s12 offen sc1
    v_mfma_f32_16x16x32_bf16 v[216:219], a[28:31], a[84:87], v[216:219]
    v_mfma_f32_16x16x32_bf16 v[220:223], a[28:31], a[88:91], v[220:223]
    s_waitcnt vmcnt(8)
    s_cmp_eq_u32 s6, 0
    s_cbranch_scc1 c2_h0_ok
    s_mov_b32 s15, 0
c2_h0_chk:
    v_min3_u32 v250, v252, v253, v254
    v_max3_u32 v251, v252, v253, v254
    v_min_u32 v250, v250, v255
    v_max_u32 v251, v251, v255
    v_cmp_eq_u32 vcc, s7, v250
    v_cmp_eq_u32 s[50:51], s7, v251
    s_nop 0
    s_and_b64 vcc, vcc, s[50:51]
    s_add_u32 s15, s15, 1
    s_and_b32 s14, vcc_lo, 12
    s_cbranch_scc1 c2_h0_ok
    s_cmp_ge_u32 s15, 0x40000
    s_cbranch_scc1 c2_h0_ok
    s_cmp_ge_u32 s15, 24
    s_cbranch_scc1 c2_h0_both
    s_and_b64 exec, s[0:1], 12
    buffer_load_dwordx4 v[252:255], v248, s[92:95], 0 offen sc1
    s_mov_b64 exec, -1
    s_waitcnt vmcnt(0)
    s_branch c2_h0_chk
c2_h0_both:
    s_mov_b64 exec, 12
    buffer_load_dwordx4 v[252:255], v248, s[92:95], 0 offen sc1
    s_mov_b64 exec, -1
    s_waitcnt vmcnt(0)
    s_branch c2_h0_chk
c2_h0_ok:
    s_waitcnt lgkmcnt(3)
    v_mfma_f32_16x16x32_bf16 v[64:67], a[0:3], a[92:95], v[64:67]
    ds_read_b128 a[28:31], v19 offset:18720
    v_mfma_f32_16x16x32_bf16 v[68:71], a[0:3], a[96:99], v[68:71]
    v_mfma_f32_16x16x32_bf16 v[72:75], a[0:3], a[100:103], v[72:75]
    s_add_u32 m0, s8, 16
    s_nop 0
    buffer_load_dwordx4 v4, s[40:43], s64 offen sc1 lds
    v_mfma_f32_16x16x32_bf16 v[76:79], a[0:3], a[104:107], v[76:79]
    v_mfma_f32_16x16x32_bf16 v[80:83], a[0:3], a[108:111], v[80:83]
    v_mfma_f32_16x16x32_bf16 v[84:87], a[4:7], a[92:95], v[84:87]
    ds_read_b128 a[0:3], v16 offset:18480
    v_mfma_f32_16x16x32_bf16 v[88:91], a[4:7], a[96:99], v[88:91]
    v_mfma_f32_16x16x32_bf16 v[92:95], a[4:7], a[100:103], v[92:95]
    s_add_u32 m0, s8, 4368
    s_add_u32 s11, s64, 65536
    buffer_load_dwordx4 v4, s[40:43], s11 offen sc1 lds
    v_mfma_f32_16x16x32_bf16 v[96:99], a[4:7], a[104:107], v[96:99]
    v_mfma_f32_16x16x32_bf16 v[100:103], a[4:7], a[108:111], v[100:103]
    v_mfma_f32_16x16x32_bf16 v[104:107], a[8:11], a[92:95], v[104:107]
    ds_read_b128 a[4:7], v16 offset:18736
    v_mfma_f32_16x16x32_bf16 v[108:111], a[8:11], a[96:99], v[108:111]
    v_mfma_f32_16x16x32_bf16 v[112:115], a[8:11], a[100:103], v[112:115]
    s_add_u32 m0, s8, 8720
    s_add_u32 s11, s64, 131072
    buffer_load_dwordx4 v4, s[40:43], s11 offen sc1 lds
    v_mfma_f32_16x16x32_bf16 v[116:119], a[8:11], a[104:107], v[116:119]
    v_mfma_f32_16x16x32_bf16 v[120:123], a[8:11], a[108:111], v[120:123]
    v_mfma_f32_16x16x32_bf16 v[124:127], a[12:15], a[92:95], v[124:127]
    ds_read_b128 a[8:11], v17 offset:18480
    v_mfma_f32_16x16x32_bf16 v[128:131], a[12:15], a[96:99], v[128:131]
    v_mfma_f32_16x16x32_bf16 v[132:135], a[12:15], a[100:103], v[132:135]
    s_add_u32 m0, s8, 13072
    s_add_u32 s11, s64, 196608
    buffer_load_dwordx4 v4, s[40:43], s11 offen sc1 lds
    v_mfma_f32_16x16x32_bf16 v[136:139], a[12:15], a[104:107], v[136:139]
    v_mfma_f32_16x16x32_bf16 v[140:143], a[12:15], a[108:111], v[140:143]
    s_waitcnt lgkmcnt(3)
    v_mfma_f32_16x16x32_bf16 v[144:147], a[16:19], a[92:95], v[144:147]
    ds_read_b128 a[12:15], v17 offset:18736
    v_mfma_f32_16x16x32_bf16 v[148:151], a[16:19], a[96:99], v[148:151]
    v_mfma_f32_16x16x32_bf16 v[152:155], a[16:19], a[100:103], v[152:155]
    s_add_u32 s12, s10, 30720
    buffer_load_dwordx4 a[152:155], v11, s[44:47], s12 offen offset:0 sc1
    v_mfma_f32_16x16x32_bf16 v[156:159], a[16:19], a[104:107], v[156:159]
    v_mfma_f32_16x16x32_bf16 v[160:163], a[16:19], a[108:111], v[160:163]
    v_mfma_f32_16x16x32_bf16 v[164:167], a[20:23], a[92:95], v[164:167]
    ds_read_b128 a[16:19], v18 offset:18480
    v_mfma_f32_16x16x32_bf16 v[168:171], a[20:23], a[96:99], v[168:171]
    v_mfma_f32_16x16x32_bf16 v[172:175], a[20:23], a[100:103], v[172:175]
    buffer_load_dwordx4 a[156:159], v11, s[44:47], s12 offen offset:1024 sc1
    v_mfma_f32_16x16x32_bf16 v[176:179], a[20:23], a[104:107], v[176:179]
    v_mfma_f32_16x16x32_bf16 v[180:183], a[20:23], a[108:111], v[180:183]
    v_mfma_f32_16x16x32_bf16 v[184:187], a[24:27], a[92:95], v[184:187]
    ds_read_b128 a[20:23], v18 offset:18736
    v_mfma_f32_16x16x32_bf16 v[188:191], a[24:27], a[96:99], v[188:191]
    v_mfma_f32_16x16x32_bf16 v[192:195], a[24:27], a[100:103], v[192:195]
    buffer_load_dwordx4 a[160:163], v11, s[44:47], s12 offen offset:2048 sc1
    v_mfma_f32_16x16x32_bf16 v[196:199], a[24:27], a[104:107], v[196:199]
    v_mfma_f32_16x16x32_bf16 v[200:203], a[24:27], a[108:111], v[200:203]
    v_mfma_f32_16x16x32_bf16 v[204:207], a[28:31], a[92:95], v[204:207]
    ds_read_b128 a[24:27], v19 offset:18480
    v_mfma_f32_16x16x32_bf16 v[208:211], a[28:31], a[96:99], v[208:211]
    v_mfma_f32_16x16x32_bf16 v[212:215], a[28:31], a[100:103], v[212:215]
    buffer_load_dwordx4 a[164:167], v11, s[44:47], s12 offen offset:3072 sc1
    v_mfma_f32_16x16x32_bf16 v[216:219], a[28:31], a[104:107], v[216:219]
    v_mfma_f32_16x16x32_bf16 v[220:223], a[28:31], a[108:111], v[220:223]
    s_waitcnt vmcnt(14) lgkmcnt(3)
    v_mfma_f32_16x16x32_bf16 v[64:67], a[0:3], a[112:115], v[64:67]
    ds_read_b128 a[28:31], v19 offset:18736
    v_mfma_f32_16x16x32_bf16 v[68:71], a[0:3], a[116:119], v[68:71]
    v_mfma_f32_16x16x32_bf16 v[72:75], a[0:3], a[120:123], v[72:75]
    s_and_b64 exec, s[0:1], 48
    buffer_load_dwordx4 v[252:255], v248, s[92:95], 0 offen sc1
    s_mov_b64 exec, -1
    v_mfma_f32_16x16x32_bf16 v[76:79], a[0:3], a[124:127], v[76:79]
    v_mfma_f32_16x16x32_bf16 v[80:83], a[0:3], a[128:131], v[80:83]
    v_mfma_f32_16x16x32_bf16 v[84:87], a[4:7], a[112:115], v[84:87]
    ds_read_b128 a[0:3], v16 offset:18496
    v_mfma_f32_16x16x32_bf16 v[88:91], a[4:7], a[116:119], v[88:91]
    v_mfma_f32_16x16x32_bf16 v[92:95], a[4:7], a[120:123], v[92:95]
    buffer_load_dwordx4 a[168:171], v1, s[44:47], s12 offen sc1
    v_mfma_f32_16x16x32_bf16 v[96:99], a[4:7], a[124:127], v[96:99]
    v_mfma_f32_16x16x32_bf16 v[100:103], a[4:7], a[128:131], v[100:103]
    v_mfma_f32_16x16x32_bf16 v[104:107], a[8:11], a[112:115], v[104:107]
    ds_read_b128 a[4:7], v16 offset:18752
    v_mfma_f32_16x16x32_bf16 v[108:111], a[8:11], a[116:119], v[108:111]
    buffer_load_dwordx4 v[28:31], v3, s[52:55], s56 offen
    v_mfma_f32_16x16x32_bf16 v[112:115], a[8:11], a[120:123], v[112:115]
    v_mfma_f32_16x16x32_bf16 v[116:119], a[8:11], a[124:127], v[116:119]
    v_mfma_f32_16x16x32_bf16 v[120:123], a[8:11], a[128:131], v[120:123]
    s_add_u32 s12, s10, 35840
    buffer_load_dwordx4 a[172:175], v11, s[44:47], s12 offen offset:0 sc1
    v_mfma_f32_16x16x32_bf16 v[124:127], a[12:15], a[112:115], v[124:127]
    ds_read_b128 a[8:11], v17 offset:18496
    v_mfma_f32_16x16x32_bf16 v[128:131], a[12:15], a[116:119], v[128:131]
    v_mfma_f32_16x16x32_bf16 v[132:135], a[12:15], a[120:123], v[132:135]
    v_mfma_f32_16x16x32_bf16 v[136:139], a[12:15], a[124:127], v[136:139]
    v_mfma_f32_16x16x32_bf16 v[140:143], a[12:15], a[128:131], v[140:143]
    s_waitcnt lgkmcnt(3)
    v_mfma_f32_16x16x32_bf16 v[144:147], a[16:19], a[112:115], v[144:147]
    ds_read_b128 a[12:15], v17 offset:18752
    v_mfma_f32_16x16x32_bf16 v[148:151], a[16:19], a[116:119], v[148:151]
    buffer_load_dwordx4 a[176:179], v11, s[44:47], s12 offen offset:1024 sc1
    v_mfma_f32_16x16x32_bf16 v[152:155], a[16:19], a[120:123], v[152:155]
    v_mfma_f32_16x16x32_bf16 v[156:159], a[16:19], a[124:127], v[156:159]
    v_mfma_f32_16x16x32_bf16 v[160:163], a[16:19], a[128:131], v[160:163]
    buffer_load_dwordx4 a[180:183], v11, s[44:47], s12 offen offset:2048 sc1
    v_mfma_f32_16x16x32_bf16 v[164:167], a[20:23], a[112:115], v[164:167]
    ds_read_b128 a[16:19], v18 offset:18496
    v_mfma_f32_16x16x32_bf16 v[168:171], a[20:23], a[116:119], v[168:171]
    v_mfma_f32_16x16x32_bf16 v[172:175], a[20:23], a[120:123], v[172:175]
    v_mfma_f32_16x16x32_bf16 v[176:179], a[20:23], a[124:127], v[176:179]
    buffer_load_dwordx4 a[184:187], v11, s[44:47], s12 offen offset:3072 sc1
    v_mfma_f32_16x16x32_bf16 v[180:183], a[20:23], a[128:131], v[180:183]
    v_mfma_f32_16x16x32_bf16 v[184:187], a[24:27], a[112:115], v[184:187]
    ds_read_b128 a[20:23], v18 offset:18752
    v_mfma_f32_16x16x32_bf16 v[188:191], a[24:27], a[116:119], v[188:191]
    v_mfma_f32_16x16x32_bf16 v[192:195], a[24:27], a[120:123], v[192:195]
    v_mfma_f32_16x16x32_bf16 v[196:199], a[24:27], a[124:127], v[196:199]
    buffer_load_dwordx4 a[188:191], v1, s[44:47], s12 offen sc1
    v_mfma_f32_16x16x32_bf16 v[200:203], a[24:27], a[128:131], v[200:203]
    v_mfma_f32_16x16x32_bf16 v[204:207], a[28:31], a[112:115], v[204:207]
    ds_read_b128 a[24:27], v19 offset:18496
    v_mfma_f32_16x16x32_bf16 v[208:211], a[28:31], a[116:119], v[208:211]
    v_mfma_f32_16x16x32_bf16 v[212:215], a[28:31], a[120:123], v[212:215]
    s_add_u32 s12, s10, 40960
    buffer_load_dwordx4 a[32:35], v11, s[44:47], s12 offen offset:0 sc1
    v_mfma_f32_16x16x32_bf16 v[216:219], a[28:31], a[124:127], v[216:219]
    v_mfma_f32_16x16x32_bf16 v[220:223], a[28:31], a[128:131], v[220:223]
    s_waitcnt vmcnt(8)
    s_cmp_eq_u32 s6, 62
    s_cbranch_scc1 c2_h3_ok
    s_mov_b32 s15, 0
c2_h3_chk:
    v_min3_u32 v250, v252, v253, v254
    v_max3_u32 v251, v252, v253, v254
    v_min_u32 v250, v250, v255
    v_max_u32 v251, v251, v255
    v_cmp_eq_u32 vcc, s7, v250
    v_cmp_eq_u32 s[50:51], s7, v251
    s_nop 0
    s_and_b64 vcc, vcc, s[50:51]
    s_add_u32 s15, s15, 1
    s_and_b32 s14, vcc_lo, 48
    s_cbranch_scc1 c2_h3_ok
    s_cmp_ge_u32 s15, 0x40000
    s_cbranch_scc1 c2_h3_ok
    s_cmp_ge_u32 s15, 24
    s_cbranch_scc1 c2_h3_both
    s_and_b64 exec, s[0:1], 48
    buffer_load_dwordx4 v[252:255], v248, s[92:95], 0 offen sc1
    s_mov_b64 exec, -1
    s_waitcnt vmcnt(0)
    s_branch c2_h3_chk
c2_h3_both:
    s_mov_b64 exec, 48
    buffer_load_dwordx4 v[252:255], v248, s[92:95], 0 offen sc1
    s_mov_b64 exec, -1
    s_waitcnt vmcnt(0)
    s_branch c2_h3_chk
c2_h3_ok:
    s_waitcnt lgkmcnt(3)
    v_mfma_f32_16x16x32_bf16 v[64:67], a[0:3], a[132:135], v[64:67]
    ds_read_b128 a[28:31], v19 offset:18752
    v_mfma_f32_16x16x32_bf16 v[68:71], a[0:3], a[136:139], v[68:71]
    v_mfma_f32_16x16x32_bf16 v[72:75], a[0:3], a[140:143], v[72:75]
    s_add_u32 m0, s8, 3184
    s_nop 0
    buffer_load_dwordx4 v5, s[40:43], s67 offen sc1 lds
    v_mfma_f32_16x16x32_bf16 v[76:79], a[0:3], a[144:147], v[76:79]
    v_mfma_f32_16x16x32_bf16 v[80:83], a[0:3], a[148:151], v[80:83]
    v_mfma_f32_16x16x32_bf16 v[84:87], a[4:7], a[132:135], v[84:87]
    ds_read_b128 a[0:3], v16 offset:0
    v_mfma_f32_16x16x32_bf16 v[88:91], a[4:7], a[136:139], v[88:91]
    v_mfma_f32_16x16x32_bf16 v[92:95], a[4:7], a[140:143], v[92:95]
    s_add_u32 m0, s8, 7536
    s_add_u32 s11, s67, 65536
    buffer_load_dwordx4 v5, s[40:43], s11 offen sc1 lds
    v_mfma_f32_16x16x32_bf16 v[96:99], a[4:7], a[144:147], v[96:99]
    v_mfma_f32_16x16x32_bf16 v[100:103], a[4:7], a[148:151], v[100:103]
    v_mfma_f32_16x16x32_bf16 v[104:107], a[8:11], a[132:135], v[104:107]
    ds_read_b128 a[4:7], v16 offset:256
    v_mfma_f32_16x16x32_bf16 v[108:111], a[8:11], a[136:139], v[108:111]
    v_mfma_f32_16x16x32_bf16 v[112:115], a[8:11], a[140:143], v[112:115]
    s_add_u32 m0, s8, 11888
    s_add_u32 s11, s67, 131072
    buffer_load_dwordx4 v5, s[40:43], s11 offen sc1 lds
    v_mfma_f32_16x16x32_bf16 v[116:119], a[8:11], a[144:147], v[116:119]
    v_mfma_f32_16x16x32_bf16 v[120:123], a[8:11], a[148:151], v[120:123]
    v_mfma_f32_16x16x32_bf16 v[124:127], a[12:15], a[132:135], v[124:127]
    ds_read_b128 a[8:11], v17 offset:0
    v_mfma_f32_16x16x32_bf16 v[128:131], a[12:15], a[136:139], v[128:131]
    v_mfma_f32_16x16x32_bf16 v[132:135], a[12:15], a[140:143], v[132:135]
    s_add_u32 m0, s8, 16240
    s_add_u32 s11, s67, 196608
    buffer_load_dwordx4 v5, s[40:43], s11 offen sc1 lds
    v_mfma_f32_16x16x32_bf16 v[136:139], a[12:15], a[144:147], v[136:139]
    v_mfma_f32_16x16x32_bf16 v[140:143], a[12:15], a[148:151], v[140:143]
    s_waitcnt lgkmcnt(3)
    v_mfma_f32_16x16x32_bf16 v[144:147], a[16:19], a[132:135], v[144:147]
    ds_read_b128 a[12:15], v17 offset:256
    v_mfma_f32_16x16x32_bf16 v[148:151], a[16:19], a[136:139], v[148:151]
    v_mfma_f32_16x16x32_bf16 v[152:155], a[16:19], a[140:143], v[152:155]
    buffer_load_dwordx4 a[36:39], v11, s[44:47], s12 offen offset:1024 sc1
    v_mfma_f32_16x16x32_bf16 v[156:159], a[16:19], a[144:147], v[156:159]
    v_mfma_f32_16x16x32_bf16 v[160:163], a[16:19], a[148:151], v[160:163]
    v_mfma_f32_16x16x32_bf16 v[164:167], a[20:23], a[132:135], v[164:167]
    ds_read_b128 a[16:19], v18 offset:0
    v_mfma_f32_16x16x32_bf16 v[168:171], a[20:23], a[136:139], v[168:171]
    v_mfma_f32_16x16x32_bf16 v[172:175], a[20:23], a[140:143], v[172:175]
    buffer_load_dwordx4 a[40:43], v11, s[44:47], s12 offen offset:2048 sc1
    v_mfma_f32_16x16x32_bf16 v[176:179], a[20:23], a[144:147], v[176:179]
    v_mfma_f32_16x16x32_bf16 v[180:183], a[20:23], a[148:151], v[180:183]
    v_mfma_f32_16x16x32_bf16 v[184:187], a[24:27], a[132:135], v[184:187]
    ds_read_b128 a[20:23], v18 offset:256
    v_mfma_f32_16x16x32_bf16 v[188:191], a[24:27], a[136:139], v[188:191]
    v_mfma_f32_16x16x32_bf16 v[192:195], a[24:27], a[140:143], v[192:195]
    buffer_load_dwordx4 a[44:47], v11, s[44:47], s12 offen offset:3072 sc1
    v_mfma_f32_16x16x32_bf16 v[196:199], a[24:27], a[144:147], v[196:199]
    v_mfma_f32_16x16x32_bf16 v[200:203], a[24:27], a[148:151], v[200:203]
    v_mfma_f32_16x16x32_bf16 v[204:207], a[28:31], a[132:135], v[204:207]
    ds_read_b128 a[24:27], v19 offset:0
    v_mfma_f32_16x16x32_bf16 v[208:211], a[28:31], a[136:139], v[208:211]
    v_mfma_f32_16x16x32_bf16 v[212:215], a[28:31], a[140:143], v[212:215]
    buffer_load_dwordx4 a[48:51], v1, s[44:47], s12 offen sc1
    v_mfma_f32_16x16x32_bf16 v[216:219], a[28:31], a[144:147], v[216:219]
    v_mfma_f32_16x16x32_bf16 v[220:223], a[28:31], a[148:151], v[220:223]
    s_waitcnt vmcnt(15) lgkmcnt(3)
    v_mfma_f32_16x16x32_bf16 v[64:67], a[0:3], a[152:155], v[64:67]
    ds_read_b128 a[28:31], v19 offset:256
    v_mfma_f32_16x16x32_bf16 v[68:71], a[0:3], a[156:159], v[68:71]
    v_mfma_f32_16x16x32_bf16 v[72:75], a[0:3], a[160:163], v[72:75]
    s_add_u32 s12, s10, 46080
    buffer_load_dwordx4 a[52:55], v11, s[44:47], s12 offen offset:0 sc1
    v_mfma_f32_16x16x32_bf16 v[76:79], a[0:3], a[164:167], v[76:79]
    v_mfma_f32_16x16x32_bf16 v[80:83], a[0:3], a[168:171], v[80:83]
    v_mfma_f32_16x16x32_bf16 v[84:87], a[4:7], a[152:155], v[84:87]
    ds_read_b128 a[0:3], v16 offset:16
    v_mfma_f32_16x16x32_bf16 v[88:91], a[4:7], a[156:159], v[88:91]
    v_mfma_f32_16x16x32_bf16 v[92:95], a[4:7], a[160:163], v[92:95]
    buffer_load_dwordx4 a[56:59], v11, s[44:47], s12 offen offset:1024 sc1
    v_mfma_f32_16x16x32_bf16 v[96:99], a[4:7], a[164:167], v[96:99]
    v_mfma_f32_16x16x32_bf16 v[100:103], a[4:7], a[168:171], v[100:103]
    v_mfma_f32_16x16x32_bf16 v[104:107], a[8:11], a[152:155], v[104:107]
    ds_read_b128 a[4:7], v16 offset:272
    v_mfma_f32_16x16x32_bf16 v[108:111], a[8:11], a[156:159], v[108:111]
    v_mfma_f32_16x16x32_bf16 v[112:115], a[8:11], a[160:163], v[112:115]
    buffer_load_dwordx4 a[60:63], v11, s[44:47], s12 offen offset:2048 sc1
    v_mfma_f32_16x16x32_bf16 v[116:119], a[8:11], a[164:167], v[116:119]
    v_mfma_f32_16x16x32_bf16 v[120:123], a[8:11], a[168:171], v[120:123]
    v_mfma_f32_16x16x32_bf16 v[124:127], a[12:15], a[152:155], v[124:127]
    ds_read_b128 a[8:11], v17 offset:16
    v_mfma_f32_16x16x32_bf16 v[128:131], a[12:15], a[156:159], v[128:131]
    v_mfma_f32_16x16x32_bf16 v[132:135], a[12:15], a[160:163], v[132:135]
    buffer_load_dwordx4 a[64:67], v11, s[44:47], s12 offen offset:3072 sc1
    v_mfma_f32_16x16x32_bf16 v[136:139], a[12:15], a[164:167], v[136:139]
    v_mfma_f32_16x16x32_bf16 v[140:143], a[12:15], a[168:171], v[140:143]
    s_waitcnt lgkmcnt(3)
    v_mfma_f32_16x16x32_bf16 v[144:147], a[16:19], a[152:155], v[144:147]
    ds_read_b128 a[12:15], v17 offset:272
    v_mfma_f32_16x16x32_bf16 v[148:151], a[16:19], a[156:159], v[148:151]
    v_mfma_f32_16x16x32_bf16 v[152:155], a[16:19], a[160:163], v[152:155]
    buffer_load_dwordx4 a[68:71], v1, s[44:47], s12 offen sc1
    v_mfma_f32_16x16x32_bf16 v[156:159], a[16:19], a[164:167], v[156:159]
    v_mfma_f32_16x16x32_bf16 v[160:163], a[16:19], a[168:171], v[160:163]
    v_mfma_f32_16x16x32_bf16 v[164:167], a[20:23], a[152:155], v[164:167]
    ds_read_b128 a[16:19], v18 offset:16
    v_mfma_f32_16x16x32_bf16 v[168:171], a[20:23], a[156:159], v[168:171]
    v_mfma_f32_16x16x32_bf16 v[172:175], a[20:23], a[160:163], v[172:175]
    buffer_load_dwordx4 v[32:35], v3, s[52:55], s57 offen
    v_mfma_f32_16x16x32_bf16 v[176:179], a[20:23], a[164:167], v[176:179]
    v_mfma_f32_16x16x32_bf16 v[180:183], a[20:23], a[168:171], v[180:183]
    v_mfma_f32_16x16x32_bf16 v[184:187], a[24:27], a[152:155], v[184:187]
    ds_read_b128 a[20:23], v18 offset:272
    v_mfma_f32_16x16x32_bf16 v[188:191], a[24:27], a[156:159], v[188:191]
    v_mfma_f32_16x16x32_bf16 v[192:195], a[24:27], a[160:163], v[192:195]
    s_add_u32 s12, s10, 51200
    buffer_load_dwordx4 a[72:75], v11, s[44:47], s12 offen offset:0 sc1
    v_mfma_f32_16x16x32_bf16 v[196:199], a[24:27], a[164:167], v[196:199]
    v_mfma_f32_16x16x32_bf16 v[200:203], a[24:27], a[168:171], v[200:203]
    v_mfma_f32_16x16x32_bf16 v[204:207], a[28:31], a[152:155], v[204:207]
    ds_read_b128 a[24:27], v19 offset:16
    v_mfma_f32_16x16x32_bf16 v[208:211], a[28:31], a[156:159], v[208:211]
    v_mfma_f32_16x16x32_bf16 v[212:215], a[28:31], a[160:163], v[212:215]
    buffer_load_dwordx4 a[76:79], v11, s[44:47], s12 offen offset:1024 sc1
    v_mfma_f32_16x16x32_bf16 v[216:219], a[28:31], a[164:167], v[216:219]
    v_mfma_f32_16x16x32_bf16 v[220:223], a[28:31], a[168:171], v[220:223]
    s_waitcnt vmcnt(17) lgkmcnt(3)
    v_mfma_f32_16x16x32_bf16 v[64:67], a[0:3], a[172:175], v[64:67]
    ds_read_b128 a[28:31], v19 offset:272
    v_mfma_f32_16x16x32_bf16 v[68:71], a[0:3], a[176:179], v[68:71]
    v_mfma_f32_16x16x32_bf16 v[72:75], a[0:3], a[180:183], v[72:75]
    buffer_load_dwordx4 a[80:83], v11, s[44:47], s12 offen offset:2048 sc1
    v_mfma_f32_16x16x32_bf16 v[76:79], a[0:3], a[184:187], v[76:79]
    v_mfma_f32_16x16x32_bf16 v[80:83], a[0:3], a[188:191], v[80:83]
    v_mfma_f32_16x16x32_bf16 v[84:87], a[4:7], a[172:175], v[84:87]
    ds_read_b128 a[0:3], v16 offset:32
    v_mfma_f32_16x16x32_bf16 v[88:91], a[4:7], a[176:179], v[88:91]
    v_mfma_f32_16x16x32_bf16 v[92:95], a[4:7], a[180:183], v[92:95]
    buffer_load_dwordx4 a[84:87], v11, s[44:47], s12 offen offset:3072 sc1
    v_mfma_f32_16x16x32_bf16 v[96:99], a[4:7], a[184:187], v[96:99]
    v_mfma_f32_16x16x32_bf16 v[100:103], a[4:7], a[188:191], v[100:103]
    v_mfma_f32_16x16x32_bf16 v[104:107], a[8:11], a[172:175], v[104:107]
    ds_read_b128 a[4:7], v16 offset:288
    v_mfma_f32_16x16x32_bf16 v[108:111], a[8:11], a[176:179], v[108:111]
    v_mfma_f32_16x16x32_bf16 v[112:115], a[8:11], a[180:183], v[112:115]
    buffer_load_dwordx4 a[88:91], v1, s[44:47], s12 offen sc1
    v_mfma_f32_16x16x32_bf16 v[116:119], a[8:11], a[184:187], v[116:119]
    v_mfma_f32_16x16x32_bf16 v[120:123], a[8:11], a[188:191], v[120:123]
    v_mfma_f32_16x16x32_bf16 v[124:127], a[12:15], a[172:175], v[124:127]
    ds_read_b128 a[8:11], v17 offset:32
    v_mfma_f32_16x16x32_bf16 v[128:131], a[12:15], a[176:179], v[128:131]
    v_mfma_f32_16x16x32_bf16 v[132:135], a[12:15], a[180:183], v[132:135]
    s_add_u32 m0, s8, 17424
    s_add_u32 s11, s64, 262144
    buffer_load_dwordx4 v4, s[40:43], s11 offen sc1 lds
    v_mfma_f32_16x16x32_bf16 v[136:139], a[12:15], a[184:187], v[136:139]
    v_mfma_f32_16x16x32_bf16 v[140:143], a[12:15], a[188:191], v[140:143]
    s_waitcnt lgkmcnt(3)
    v_mfma_f32_16x16x32_bf16 v[144:147], a[16:19], a[172:175], v[144:147]
    ds_read_b128 a[12:15], v17 offset:288
    v_mfma_f32_16x16x32_bf16 v[148:151], a[16:19], a[176:179], v[148:151]
    v_mfma_f32_16x16x32_bf16 v[152:155], a[16:19], a[180:183], v[152:155]
    s_add_u32 m0, s8, 21776
    s_add_u32 s11, s64, 327680
    buffer_load_dwordx4 v4, s[40:43], s11 offen sc1 lds
    v_mfma_f32_16x16x32_bf16 v[156:159], a[16:19], a[184:187], v[156:159]
    v_mfma_f32_16x16x32_bf16 v[160:163], a[16:19], a[188:191], v[160:163]
    v_mfma_f32_16x16x32_bf16 v[164:167], a[20:23], a[172:175], v[164:167]
    ds_read_b128 a[16:19], v18 offset:32
    v_mfma_f32_16x16x32_bf16 v[168:171], a[20:23], a[176:179], v[168:171]
    v_mfma_f32_16x16x32_bf16 v[172:175], a[20:23], a[180:183], v[172:175]
    s_add_u32 m0, s8, 26128
    s_add_u32 s11, s64, 393216
    buffer_load_dwordx4 v4, s[40:43], s11 offen sc1 lds
    v_mfma_f32_16x16x32_bf16 v[176:179], a[20:23], a[184:187], v[176:179]
    v_mfma_f32_16x16x32_bf16 v[180:183], a[20:23], a[188:191], v[180:183]
    v_mfma_f32_16x16x32_bf16 v[184:187], a[24:27], a[172:175], v[184:187]
    ds_read_b128 a[20:23], v18 offset:288
    v_mfma_f32_16x16x32_bf16 v[188:191], a[24:27], a[176:179], v[188:191]
    v_mfma_f32_16x16x32_bf16 v[192:195], a[24:27], a[180:183], v[192:195]
    s_add_u32 m0, s8, 30480
    s_add_u32 s11, s64, 458752
    buffer_load_dwordx4 v4, s[40:43], s11 offen sc1 lds
    v_mfma_f32_16x16x32_bf16 v[196:199], a[24:27], a[184:187], v[196:199]
    v_mfma_f32_16x16x32_bf16 v[200:203], a[24:27], a[188:191], v[200:203]
    v_mfma_f32_16x16x32_bf16 v[204:207], a[28:31], a[172:175], v[204:207]
    ds_read_b128 a[24:27], v19 offset:32
    v_mfma_f32_16x16x32_bf16 v[208:211], a[28:31], a[176:179], v[208:211]
    v_mfma_f32_16x16x32_bf16 v[212:215], a[28:31], a[180:183], v[212:215]
    s_add_u32 s12, s10, 56320
    buffer_load_dwordx4 a[92:95], v11, s[44:47], s12 offen offset:0 sc1
    v_mfma_f32_16x16x32_bf16 v[216:219], a[28:31], a[184:187], v[216:219]
    v_mfma_f32_16x16x32_bf16 v[220:223], a[28:31], a[188:191], v[220:223]
    s_waitcnt vmcnt(16)
    s_waitcnt lgkmcnt(3)
    v_mfma_f32_16x16x32_bf16 v[64:67], a[0:3], a[32:35], v[64:67]
    ds_read_b128 a[28:31], v19 offset:288
    v_mfma_f32_16x16x32_bf16 v[68:71], a[0:3], a[36:39], v[68:71]
    v_mfma_f32_16x16x32_bf16 v[72:75], a[0:3], a[40:43], v[72:75]
    buffer_load_dwordx4 a[96:99], v11, s[44:47], s12 offen offset:1024 sc1
    v_mfma_f32_16x16x32_bf16 v[76:79], a[0:3], a[44:47], v[76:79]
    v_mfma_f32_16x16x32_bf16 v[80:83], a[0:3], a[48:51], v[80:83]
    v_mfma_f32_16x16x32_bf16 v[84:87], a[4:7], a[32:35], v[84:87]
    ds_read_b128 a[0:3], v16 offset:2112
    v_mfma_f32_16x16x32_bf16 v[88:91], a[4:7], a[36:39], v[88:91]
    v_mfma_f32_16x16x32_bf16 v[92:95], a[4:7], a[40:43], v[92:95]
    buffer_load_dwordx4 a[100:103], v11, s[44:47], s12 offen offset:2048 sc1
    v_mfma_f32_16x16x32_bf16 v[96:99], a[4:7], a[44:47], v[96:99]
    v_mfma_f32_16x16x32_bf16 v[100:103], a[4:7], a[48:51], v[100:103]
    v_mfma_f32_16x16x32_bf16 v[104:107], a[8:11], a[32:35], v[104:107]
    ds_read_b128 a[4:7], v16 offset:2368
    v_mfma_f32_16x16x32_bf16 v[108:111], a[8:11], a[36:39], v[108:111]
    v_mfma_f32_16x16x32_bf16 v[112:115], a[8:11], a[40:43], v[112:115]
    buffer_load_dwordx4 a[104:107], v11, s[44:47], s12 offen offset:3072 sc1
    v_mfma_f32_16x16x32_bf16 v[116:119], a[8:11], a[44:47], v[116:119]
    v_mfma_f32_16x16x32_bf16 v[120:123], a[8:11], a[48:51], v[120:123]
    v_mfma_f32_16x16x32_bf16 v[124:127], a[12:15], a[32:35], v[124:127]
    ds_read_b128 a[8:11], v17 offset:2112
    v_mfma_f32_16x16x32_bf16 v[128:131], a[12:15], a[36:39], v[128:131]
    v_mfma_f32_16x16x32_bf16 v[132:135], a[12:15], a[40:43], v[132:135]
    buffer_load_dwordx4 a[108:111], v1, s[44:47], s12 offen sc1
    v_mfma_f32_16x16x32_bf16 v[136:139], a[12:15], a[44:47], v[136:139]
    v_mfma_f32_16x16x32_bf16 v[140:143], a[12:15], a[48:51], v[140:143]
    s_waitcnt lgkmcnt(3)
    v_mfma_f32_16x16x32_bf16 v[144:147], a[16:19], a[32:35], v[144:147]
    ds_read_b128 a[12:15], v17 offset:2368
    v_mfma_f32_16x16x32_bf16 v[148:151], a[16:19], a[36:39], v[148:151]
    v_mfma_f32_16x16x32_bf16 v[152:155], a[16:19], a[40:43], v[152:155]
    buffer_load_dwordx4 v[36:39], v3, s[52:55], s58 offen
    v_mfma_f32_16x16x32_bf16 v[156:159], a[16:19], a[44:47], v[156:159]
    v_mfma_f32_16x16x32_bf16 v[160:163], a[16:19], a[48:51], v[160:163]
    v_mfma_f32_16x16x32_bf16 v[164:167], a[20:23], a[32:35], v[164:167]
    ds_read_b128 a[16:19], v18 offset:2112
    v_mfma_f32_16x16x32_bf16 v[168:171], a[20:23], a[36:39], v[168:171]
    v_mfma_f32_16x16x32_bf16 v[172:175], a[20:23], a[40:43], v[172:175]
    s_add_u32 s12, s10, 61440
    buffer_load_dwordx4 a[112:115], v11, s[44:47], s12 offen offset:0 sc1
    v_mfma_f32_16x16x32_bf16 v[176:179], a[20:23], a[44:47], v[176:179]
    v_mfma_f32_16x16x32_bf16 v[180:183], a[20:23], a[48:51], v[180:183]
    v_mfma_f32_16x16x32_bf16 v[184:187], a[24:27], a[32:35], v[184:187]
    ds_read_b128 a[20:23], v18 offset:2368
    v_mfma_f32_16x16x32_bf16 v[188:191], a[24:27], a[36:39], v[188:191]
    v_mfma_f32_16x16x32_bf16 v[192:195], a[24:27], a[40:43], v[192:195]
    buffer_load_dwordx4 a[116:119], v11, s[44:47], s12 offen offset:1024 sc1
    v_mfma_f32_16x16x32_bf16 v[196:199], a[24:27], a[44:47], v[196:199]
    v_mfma_f32_16x16x32_bf16 v[200:203], a[24:27], a[48:51], v[200:203]
    v_mfma_f32_16x16x32_bf16 v[204:207], a[28:31], a[32:35], v[204:207]
    ds_read_b128 a[24:27], v19 offset:2112
    v_mfma_f32_16x16x32_bf16 v[208:211], a[28:31], a[36:39], v[208:211]
    v_mfma_f32_16x16x32_bf16 v[212:215], a[28:31], a[40:43], v[212:215]
    buffer_load_dwordx4 a[120:123], v11, s[44:47], s12 offen offset:2048 sc1
    v_mfma_f32_16x16x32_bf16 v[216:219], a[28:31], a[44:47], v[216:219]
    v_mfma_f32_16x16x32_bf16 v[220:223], a[28:31], a[48:51], v[220:223]
    s_waitcnt vmcnt(19) lgkmcnt(3)
    v_mfma_f32_16x16x32_bf16 v[64:67], a[0:3], a[52:55], v[64:67]
    ds_read_b128 a[28:31], v19 offset:2368
    v_mfma_f32_16x16x32_bf16 v[68:71], a[0:3], a[56:59], v[68:71]
    v_mfma_f32_16x16x32_bf16 v[72:75], a[0:3], a[60:63], v[72:75]
    buffer_load_dwordx4 a[124:127], v11, s[44:47], s12 offen offset:3072 sc1
    v_mfma_f32_16x16x32_bf16 v[76:79], a[0:3], a[64:67], v[76:79]
    v_mfma_f32_16x16x32_bf16 v[80:83], a[0:3], a[68:71], v[80:83]
    v_mfma_f32_16x16x32_bf16 v[84:87], a[4:7], a[52:55], v[84:87]
    ds_read_b128 a[0:3], v16 offset:2128
    v_mfma_f32_16x16x32_bf16 v[88:91], a[4:7], a[56:59], v[88:91]
    v_mfma_f32_16x16x32_bf16 v[92:95], a[4:7], a[60:63], v[92:95]
    buffer_load_dwordx4 a[128:131], v1, s[44:47], s12 offen sc1
    v_mfma_f32_16x16x32_bf16 v[96:99], a[4:7], a[64:67], v[96:99]
    v_mfma_f32_16x16x32_bf16 v[100:103], a[4:7], a[68:71], v[100:103]
    v_mfma_f32_16x16x32_bf16 v[104:107], a[8:11], a[52:55], v[104:107]
    ds_read_b128 a[4:7], v16 offset:2384
    v_mfma_f32_16x16x32_bf16 v[108:111], a[8:11], a[56:59], v[108:111]
    v_mfma_f32_16x16x32_bf16 v[112:115], a[8:11], a[60:63], v[112:115]
    s_add_u32 s12, s10, 66560
    buffer_load_dwordx4 a[132:135], v11, s[44:47], s12 offen offset:0 sc1
    v_mfma_f32_16x16x32_bf16 v[116:119], a[8:11], a[64:67], v[116:119]
    v_mfma_f32_16x16x32_bf16 v[120:123], a[8:11], a[68:71], v[120:123]
    v_mfma_f32_16x16x32_bf16 v[124:127], a[12:15], a[52:55], v[124:127]
    ds_read_b128 a[8:11], v17 offset:2128
    v_mfma_f32_16x16x32_bf16 v[128:131], a[12:15], a[56:59], v[128:131]
    v_mfma_f32_16x16x32_bf16 v[132:135], a[12:15], a[60:63], v[132:135]
    buffer_load_dwordx4 a[136:139], v11, s[44:47], s12 offen offset:1024 sc1
    v_mfma_f32_16x16x32_bf16 v[136:139], a[12:15], a[64:67], v[136:139]
    v_mfma_f32_16x16x32_bf16 v[140:143], a[12:15], a[68:71], v[140:143]
    s_waitcnt lgkmcnt(3)
    v_mfma_f32_16x16x32_bf16 v[144:147], a[16:19], a[52:55], v[144:147]
    ds_read_b128 a[12:15], v17 offset:2384
    v_mfma_f32_16x16x32_bf16 v[148:151], a[16:19], a[56:59], v[148:151]
    v_mfma_f32_16x16x32_bf16 v[152:155], a[16:19], a[60:63], v[152:155]
    buffer_load_dwordx4 a[140:143], v11, s[44:47], s12 offen offset:2048 sc1
    v_mfma_f32_16x16x32_bf16 v[156:159], a[16:19], a[64:67], v[156:159]
    v_mfma_f32_16x16x32_bf16 v[160:163], a[16:19], a[68:71], v[160:163]
    v_mfma_f32_16x16x32_bf16 v[164:167], a[20:23], a[52:55], v[164:167]
    ds_read_b128 a[16:19], v18 offset:2128
    v_mfma_f32_16x16x32_bf16 v[168:171], a[20:23], a[56:59], v[168:171]
    v_mfma_f32_16x16x32_bf16 v[172:175], a[20:23], a[60:63], v[172:175]
    buffer_load_dwordx4 a[144:147], v11, s[44:47], s12 offen offset:3072 sc1
    v_mfma_f32_16x16x32_bf16 v[176:179], a[20:23], a[64:67], v[176:179]
    v_mfma_f32_16x16x32_bf16 v[180:183], a[20:23], a[68:71], v[180:183]
    v_mfma_f32_16x16x32_bf16 v[184:187], a[24:27], a[52:55], v[184:187]
    ds_read_b128 a[20:23], v18 offset:2384
    v_mfma_f32_16x16x32_bf16 v[188:191], a[24:27], a[56:59], v[188:191]
    v_mfma_f32_16x16x32_bf16 v[192:195], a[24:27], a[60:63], v[192:195]
    buffer_load_dwordx4 a[148:151], v1, s[44:47], s12 offen sc1
    v_mfma_f32_16x16x32_bf16 v[196:199], a[24:27], a[64:67], v[196:199]
    v_mfma_f32_16x16x32_bf16 v[200:203], a[24:27], a[68:71], v[200:203]
    v_mfma_f32_16x16x32_bf16 v[204:207], a[28:31], a[52:55], v[204:207]
    ds_read_b128 a[24:27], v19 offset:2128
    v_mfma_f32_16x16x32_bf16 v[208:211], a[28:31], a[56:59], v[208:211]
    v_mfma_f32_16x16x32_bf16 v[212:215], a[28:31], a[60:63], v[212:215]
    s_add_u32 m0, s8, 20592
    s_add_u32 s11, s67, 262144
    buffer_load_dwordx4 v5, s[40:43], s11 offen sc1 lds
    v_mfma_f32_16x16x32_bf16 v[216:219], a[28:31], a[64:67], v[216:219]
    v_mfma_f32_16x16x32_bf16 v[220:223], a[28:31], a[68:71], v[220:223]
    s_waitcnt vmcnt(21) lgkmcnt(3)
    v_mfma_f32_16x16x32_bf16 v[64:67], a[0:3], a[72:75], v[64:67]
    ds_read_b128 a[28:31], v19 offset:2384
    v_mfma_f32_16x16x32_bf16 v[68:71], a[0:3], a[76:79], v[68:71]
    v_mfma_f32_16x16x32_bf16 v[72:75], a[0:3], a[80:83], v[72:75]
    s_add_u32 m0, s8, 24944
    s_add_u32 s11, s67, 327680
    buffer_load_dwordx4 v5, s[40:43], s11 offen sc1 lds
    v_mfma_f32_16x16x32_bf16 v[76:79], a[0:3], a[84:87], v[76:79]
    v_mfma_f32_16x16x32_bf16 v[80:83], a[0:3], a[88:91], v[80:83]
    v_mfma_f32_16x16x32_bf16 v[84:87], a[4:7], a[72:75], v[84:87]
    ds_read_b128 a[0:3], v16 offset:2144
    v_mfma_f32_16x16x32_bf16 v[88:91], a[4:7], a[76:79], v[88:91]
    v_mfma_f32_16x16x32_bf16 v[92:95], a[4:7], a[80:83], v[92:95]
    s_add_u32 m0, s8, 29296
    s_add_u32 s11, s67, 393216
    buffer_load_dwordx4 v5, s[40:43], s11 offen sc1 lds
    v_mfma_f32_16x16x32_bf16 v[96:99], a[4:7], a[84:87], v[96:99]
    v_mfma_f32_16x16x32_bf16 v[100:103], a[4:7], a[88:91], v[100:103]
    v_mfma_f32_16x16x32_bf16 v[104:107], a[8:11], a[72:75], v[104:107]
    ds_read_b128 a[4:7], v16 offset:2400
    v_mfma_f32_16x16x32_bf16 v[108:111], a[8:11], a[76:79], v[108:111]
    v_mfma_f32_16x16x32_bf16 v[112:115], a[8:11], a[80:83], v[112:115]
    s_add_u32 m0, s8, 33648
    s_add_u32 s11, s67, 458752
    buffer_load_dwordx4 v5, s[40:43], s11 offen sc1 lds
    v_mfma_f32_16x16x32_bf16 v[116:119], a[8:11], a[84:87], v[116:119]
    v_mfma_f32_16x16x32_bf16 v[120:123], a[8:11], a[88:91], v[120:123]
    v_mfma_f32_16x16x32_bf16 v[124:127], a[12:15], a[72:75], v[124:127]
    ds_read_b128 a[8:11], v17 offset:2144
    v_mfma_f32_16x16x32_bf16 v[128:131], a[12:15], a[76:79], v[128:131]
    v_mfma_f32_16x16x32_bf16 v[132:135], a[12:15], a[80:83], v[132:135]
    s_add_u32 s12, s10, 71680
    buffer_load_dwordx4 a[152:155], v11, s[44:47], s12 offen offset:0 sc1
    v_mfma_f32_16x16x32_bf16 v[136:139], a[12:15], a[84:87], v[136:139]
    v_mfma_f32_16x16x32_bf16 v[140:143], a[12:15], a[88:91], v[140:143]
    s_waitcnt lgkmcnt(3)
    v_mfma_f32_16x16x32_bf16 v[144:147], a[16:19], a[72:75], v[144:147]
    ds_read_b128 a[12:15], v17 offset:2400
    v_mfma_f32_16x16x32_bf16 v[148:151], a[16:19], a[76:79], v[148:151]
    v_mfma_f32_16x16x32_bf16 v[152:155], a[16:19], a[80:83], v[152:155]
    buffer_load_dwordx4 a[156:159], v11, s[44:47], s12 offen offset:1024 sc1
    v_mfma_f32_16x16x32_bf16 v[156:159], a[16:19], a[84:87], v[156:159]
    v_mfma_f32_16x16x32_bf16 v[160:163], a[16:19], a[88:91], v[160:163]
    v_mfma_f32_16x16x32_bf16 v[164:167], a[20:23], a[72:75], v[164:167]
    ds_read_b128 a[16:19], v18 offset:2144
    v_mfma_f32_16x16x32_bf16 v[168:171], a[20:23], a[76:79], v[168:171]
    v_mfma_f32_16x16x32_bf16 v[172:175], a[20:23], a[80:83], v[172:175]
    buffer_load_dwordx4 a[160:163], v11, s[44:47], s12 offen offset:2048 sc1
    v_mfma_f32_16x16x32_bf16 v[176:179], a[20:23], a[84:87], v[176:179]
    v_mfma_f32_16x16x32_bf16 v[180:183], a[20:23], a[88:91], v[180:183]
    v_mfma_f32_16x16x32_bf16 v[184:187], a[24:27], a[72:75], v[184:187]
    ds_read_b128 a[20:23], v18 offset:2400
    v_mfma_f32_16x16x32_bf16 v[188:191], a[24:27], a[76:79], v[188:191]
    v_mfma_f32_16x16x32_bf16 v[192:195], a[24:27], a[80:83], v[192:195]
    buffer_load_dwordx4 a[164:167], v11, s[44:47], s12 offen offset:3072 sc1
    v_mfma_f32_16x16x32_bf16 v[196:199], a[24:27], a[84:87], v[196:199]
    v_mfma_f32_16x16x32_bf16 v[200:203], a[24:27], a[88:91], v[200:203]
    v_mfma_f32_16x16x32_bf16 v[204:207], a[28:31], a[72:75], v[204:207]
    ds_read_b128 a[24:27], v19 offset:2144
    v_mfma_f32_16x16x32_bf16 v[208:211], a[28:31], a[76:79], v[208:211]
    v_mfma_f32_16x16x32_bf16 v[212:215], a[28:31], a[80:83], v[212:215]
    buffer_load_dwordx4 a[168:171], v1, s[44:47], s12 offen sc1
    v_mfma_f32_16x16x32_bf16 v[216:219], a[28:31], a[84:87], v[216:219]
    v_mfma_f32_16x16x32_bf16 v[220:223], a[28:31], a[88:91], v[220:223]
    ds_read_b128 a[28:31], v19 offset:2400
    s_waitcnt vmcnt(20)
    s_waitcnt lgkmcnt(4)
    v_mfma_f32_16x16x32_bf16 v[64:67], a[0:3], a[92:95], v[64:67]
    v_mfma_f32_16x16x32_bf16 v[68:71], a[0:3], a[96:99], v[68:71]
    v_mfma_f32_16x16x32_bf16 v[72:75], a[0:3], a[100:103], v[72:75]
    buffer_load_dwordx4 v[40:43], v3, s[52:55], s59 offen
    v_mfma_f32_16x16x32_bf16 v[76:79], a[0:3], a[104:107], v[76:79]
    v_mfma_f32_16x16x32_bf16 v[80:83], a[0:3], a[108:111], v[80:83]
    v_mfma_f32_16x16x32_bf16 v[84:87], a[4:7], a[92:95], v[84:87]
    ds_read_b128 a[0:3], v16 offset:17408
    v_mfma_f32_16x16x32_bf16 v[88:91], a[4:7], a[96:99], v[88:91]
    v_mfma_f32_16x16x32_bf16 v[92:95], a[4:7], a[100:103], v[92:95]
    s_add_u32 s12, s10, 76800
    buffer_load_dwordx4 a[172:175], v11, s[44:47], s12 offen offset:0 sc1
    v_mfma_f32_16x16x32_bf16 v[96:99], a[4:7], a[104:107], v[96:99]
    v_mfma_f32_16x16x32_bf16 v[100:103], a[4:7], a[108:111], v[100:103]
    v_mfma_f32_16x16x32_bf16 v[104:107], a[8:11], a[92:95], v[104:107]
    ds_read_b128 a[4:7], v16 offset:17664
    v_mfma_f32_16x16x32_bf16 v[108:111], a[8:11], a[96:99], v[108:111]
    v_mfma_f32_16x16x32_bf16 v[112:115], a[8:11], a[100:103], v[112:115]
    buffer_load_dwordx4 a[176:179], v11, s[44:47], s12 offen offset:1024 sc1
    v_mfma_f32_16x16x32_bf16 v[116:119], a[8:11], a[104:107], v[116:119]
    v_mfma_f32_16x16x32_bf16 v[120:123], a[8:11], a[108:111], v[120:123]
    v_mfma_f32_16x16x32_bf16 v[124:127], a[12:15], a[92:95], v[124:127]
    ds_read_b128 a[8:11], v17 offset:17408
    v_mfma_f32_16x16x32_bf16 v[128:131], a[12:15], a[96:99], v[128:131]
    v_mfma_f32_16x16x32_bf16 v[132:135], a[12:15], a[100:103], v[132:135]
    buffer_load_dwordx4 a[180:183], v11, s[44:47], s12 offen offset:2048 sc1
    v_mfma_f32_16x16x32_bf16 v[136:139], a[12:15], a[104:107], v[136:139]
    v_mfma_f32_16x16x32_bf16 v[140:143], a[12:15], a[108:111], v[140:143]
    s_waitcnt lgkmcnt(3)
    v_mfma_f32_16x16x32_bf16 v[144:147], a[16:19], a[92:95], v[144:147]
    ds_read_b128 a[12:15], v17 offset:17664
    v_mfma_f32_16x16x32_bf16 v[148:151], a[16:19], a[96:99], v[148:151]
    v_mfma_f32_16x16x32_bf16 v[152:155], a[16:19], a[100:103], v[152:155]
    buffer_load_dwordx4 a[184:187], v11, s[44:47], s12 offen offset:3072 sc1
    v_mfma_f32_16x16x32_bf16 v[156:159], a[16:19], a[104:107], v[156:159]
    v_mfma_f32_16x16x32_bf16 v[160:163], a[16:19], a[108:111], v[160:163]
    v_mfma_f32_16x16x32_bf16 v[164:167], a[20:23], a[92:95], v[164:167]
    ds_read_b128 a[16:19], v18 offset:17408
    v_mfma_f32_16x16x32_bf16 v[168:171], a[20:23], a[96:99], v[168:171]
    v_mfma_f32_16x16x32_bf16 v[172:175], a[20:23], a[100:103], v[172:175]
    buffer_load_dwordx4 a[188:191], v1, s[44:47], s12 offen sc1
    v_mfma_f32_16x16x32_bf16 v[176:179], a[20:23], a[104:107], v[176:179]
    v_mfma_f32_16x16x32_bf16 v[180:183], a[20:23], a[108:111], v[180:183]
    v_mfma_f32_16x16x32_bf16 v[184:187], a[24:27], a[92:95], v[184:187]
    ds_read_b128 a[20:23], v18 offset:17664
    v_mfma_f32_16x16x32_bf16 v[188:191], a[24:27], a[96:99], v[188:191]
    v_mfma_f32_16x16x32_bf16 v[192:195], a[24:27], a[100:103], v[192:195]
    s_add_u32 s12, s10, 81920
    buffer_load_dwordx4 a[32:35], v11, s[44:47], s12 offen offset:0 sc1
    v_mfma_f32_16x16x32_bf16 v[196:199], a[24:27], a[104:107], v[196:199]
    v_mfma_f32_16x16x32_bf16 v[200:203], a[24:27], a[108:111], v[200:203]
    v_mfma_f32_16x16x32_bf16 v[204:207], a[28:31], a[92:95], v[204:207]
    ds_read_b128 a[24:27], v19 offset:17408
    v_mfma_f32_16x16x32_bf16 v[208:211], a[28:31], a[96:99], v[208:211]
    v_mfma_f32_16x16x32_bf16 v[212:215], a[28:31], a[100:103], v[212:215]
    buffer_load_dwordx4 a[36:39], v11, s[44:47], s12 offen offset:1024 sc1
    v_mfma_f32_16x16x32_bf16 v[216:219], a[28:31], a[104:107], v[216:219]
    v_mfma_f32_16x16x32_bf16 v[220:223], a[28:31], a[108:111], v[220:223]
    s_waitcnt vmcnt(22) lgkmcnt(3)
    v_mfma_f32_16x16x32_bf16 v[64:67], a[0:3], a[112:115], v[64:67]
    ds_read_b128 a[28:31], v19 offset:17664
    v_mfma_f32_16x16x32_bf16 v[68:71], a[0:3], a[116:119], v[68:71]
    v_mfma_f32_16x16x32_bf16 v[72:75], a[0:3], a[120:123], v[72:75]
    buffer_load_dwordx4 a[40:43], v11, s[44:47], s12 offen offset:2048 sc1
    v_mfma_f32_16x16x32_bf16 v[76:79], a[0:3], a[124:127], v[76:79]
    v_mfma_f32_16x16x32_bf16 v[80:83], a[0:3], a[128:131], v[80:83]
    v_mfma_f32_16x16x32_bf16 v[84:87], a[4:7], a[112:115], v[84:87]
    ds_read_b128 a[0:3], v16 offset:17424
    v_mfma_f32_16x16x32_bf16 v[88:91], a[4:7], a[116:119], v[88:91]
    v_mfma_f32_16x16x32_bf16 v[92:95], a[4:7], a[120:123], v[92:95]
    buffer_load_dwordx4 a[44:47], v11, s[44:47], s12 offen offset:3072 sc1
    v_mfma_f32_16x16x32_bf16 v[96:99], a[4:7], a[124:127], v[96:99]
    v_mfma_f32_16x16x32_bf16 v[100:103], a[4:7], a[128:131], v[100:103]
    v_mfma_f32_16x16x32_bf16 v[104:107], a[8:11], a[112:115], v[104:107]
    ds_read_b128 a[4:7], v16 offset:17680
    v_mfma_f32_16x16x32_bf16 v[108:111], a[8:11], a[116:119], v[108:111]
    v_mfma_f32_16x16x32_bf16 v[112:115], a[8:11], a[120:123], v[112:115]
    buffer_load_dwordx4 a[48:51], v1, s[44:47], s12 offen sc1
    v_mfma_f32_16x16x32_bf16 v[116:119], a[8:11], a[124:127], v[116:119]
    v_mfma_f32_16x16x32_bf16 v[120:123], a[8:11], a[128:131], v[120:123]
    v_mfma_f32_16x16x32_bf16 v[124:127], a[12:15], a[112:115], v[124:127]
    ds_read_b128 a[8:11], v17 offset:17424
    v_mfma_f32_16x16x32_bf16 v[128:131], a[12:15], a[116:119], v[128:131]
    v_mfma_f32_16x16x32_bf16 v[132:135], a[12:15], a[120:123], v[132:135]
    s_add_u32 m0, s8, 16
    s_add_u32 s11, s64, 524288
    buffer_load_dwordx4 v4, s[40:43], s11 offen sc1 lds
    v_mfma_f32_16x16x32_bf16 v[136:139], a[12:15], a[124:127], v[136:139]
    v_mfma_f32_16x16x32_bf16 v[140:143], a[12:15], a[128:131], v[140:143]
    s_waitcnt lgkmcnt(3)
    v_mfma_f32_16x16x32_bf16 v[144:147], a[16:19], a[112:115], v[144:147]
    ds_read_b128 a[12:15], v17 offset:17680
    v_mfma_f32_16x16x32_bf16 v[148:151], a[16:19], a[116:119], v[148:151]
    v_mfma_f32_16x16x32_bf16 v[152:155], a[16:19], a[120:123], v[152:155]
    s_add_u32 m0, s8, 1072
    s_add_u32 s11, s65, 524288
    buffer_load_dwordx4 v11, s[40:43], s11 offen sc1 lds
    v_mfma_f32_16x16x32_bf16 v[156:159], a[16:19], a[124:127], v[156:159]
    v_mfma_f32_16x16x32_bf16 v[160:163], a[16:19], a[128:131], v[160:163]
    v_mfma_f32_16x16x32_bf16 v[164:167], a[20:23], a[112:115], v[164:167]
    ds_read_b128 a[16:19], v18 offset:17424
    v_mfma_f32_16x16x32_bf16 v[168:171], a[20:23], a[116:119], v[168:171]
    v_mfma_f32_16x16x32_bf16 v[172:175], a[20:23], a[120:123], v[172:175]
    s_add_u32 m0, s8, 2128
    s_add_u32 s11, s66, 524288
    buffer_load_dwordx4 v11, s[40:43], s11 offen sc1 lds
    v_mfma_f32_16x16x32_bf16 v[176:179], a[20:23], a[124:127], v[176:179]
    v_mfma_f32_16x16x32_bf16 v[180:183], a[20:23], a[128:131], v[180:183]
    v_mfma_f32_16x16x32_bf16 v[184:187], a[24:27], a[112:115], v[184:187]
    ds_read_b128 a[20:23], v18 offset:17680
    v_mfma_f32_16x16x32_bf16 v[188:191], a[24:27], a[116:119], v[188:191]
    v_mfma_f32_16x16x32_bf16 v[192:195], a[24:27], a[120:123], v[192:195]
    s_add_u32 m0, s8, 4368
    s_add_u32 s11, s64, 589824
    buffer_load_dwordx4 v4, s[40:43], s11 offen sc1 lds
    v_mfma_f32_16x16x32_bf16 v[196:199], a[24:27], a[124:127], v[196:199]
    v_mfma_f32_16x16x32_bf16 v[200:203], a[24:27], a[128:131], v[200:203]
    v_mfma_f32_16x16x32_bf16 v[204:207], a[28:31], a[112:115], v[204:207]
    ds_read_b128 a[24:27], v19 offset:17424
    v_mfma_f32_16x16x32_bf16 v[208:211], a[28:31], a[116:119], v[208:211]
    v_mfma_f32_16x16x32_bf16 v[212:215], a[28:31], a[120:123], v[212:215]
    s_add_u32 m0, s8, 5424
    s_add_u32 s11, s65, 589824
    buffer_load_dwordx4 v11, s[40:43], s11 offen sc1 lds
    v_mfma_f32_16x16x32_bf16 v[216:219], a[28:31], a[124:127], v[216:219]
    v_mfma_f32_16x16x32_bf16 v[220:223], a[28:31], a[128:131], v[220:223]
    s_waitcnt vmcnt(25) lgkmcnt(3)
    v_mfma_f32_16x16x32_bf16 v[64:67], a[0:3], a[132:135], v[64:67]
    ds_read_b128 a[28:31], v19 offset:17680
    v_mfma_f32_16x16x32_bf16 v[68:71], a[0:3], a[136:139], v[68:71]
    v_mfma_f32_16x16x32_bf16 v[72:75], a[0:3], a[140:143], v[72:75]
    s_add_u32 m0, s8, 6480
    s_add_u32 s11, s66, 589824
    buffer_load_dwordx4 v11, s[40:43], s11 offen sc1 lds
    v_mfma_f32_16x16x32_bf16 v[76:79], a[0:3], a[144:147], v[76:79]
    v_mfma_f32_16x16x32_bf16 v[80:83], a[0:3], a[148:151], v[80:83]
    v_mfma_f32_16x16x32_bf16 v[84:87], a[4:7], a[132:135], v[84:87]
    ds_read_b128 a[0:3], v16 offset:17440
    v_mfma_f32_16x16x32_bf16 v[88:91], a[4:7], a[136:139], v[88:91]
    v_mfma_f32_16x16x32_bf16 v[92:95], a[4:7], a[140:143], v[92:95]
    s_add_u32 s12, s10, 87040
    buffer_load_dwordx4 a[52:55], v11, s[44:47], s12 offen offset:0 sc1
    v_mfma_f32_16x16x32_bf16 v[96:99], a[4:7], a[144:147], v[96:99]
    v_mfma_f32_16x16x32_bf16 v[100:103], a[4:7], a[148:151], v[100:103]
    v_mfma_f32_16x16x32_bf16 v[104:107], a[8:11], a[132:135], v[104:107]
    ds_read_b128 a[4:7], v16 offset:17696
    v_mfma_f32_16x16x32_bf16 v[108:111], a[8:11], a[136:139], v[108:111]
    v_mfma_f32_16x16x32_bf16 v[112:115], a[8:11], a[140:143], v[112:115]
    buffer_load_dwordx4 a[56:59], v11, s[44:47], s12 offen offset:1024 sc1
    v_mfma_f32_16x16x32_bf16 v[116:119], a[8:11], a[144:147], v[116:119]
    v_mfma_f32_16x16x32_bf16 v[120:123], a[8:11], a[148:151], v[120:123]
    v_mfma_f32_16x16x32_bf16 v[124:127], a[12:15], a[132:135], v[124:127]
    ds_read_b128 a[8:11], v17 offset:17440
    v_mfma_f32_16x16x32_bf16 v[128:131], a[12:15], a[136:139], v[128:131]
    v_mfma_f32_16x16x32_bf16 v[132:135], a[12:15], a[140:143], v[132:135]
    buffer_load_dwordx4 a[60:63], v11, s[44:47], s12 offen offset:2048 sc1
    v_mfma_f32_16x16x32_bf16 v[136:139], a[12:15], a[144:147], v[136:139]
    v_mfma_f32_16x16x32_bf16 v[140:143], a[12:15], a[148:151], v[140:143]
    s_waitcnt lgkmcnt(3)
    v_mfma_f32_16x16x32_bf16 v[144:147], a[16:19], a[132:135], v[144:147]
    ds_read_b128 a[12:15], v17 offset:17696
    v_mfma_f32_16x16x32_bf16 v[148:151], a[16:19], a[136:139], v[148:151]
    v_mfma_f32_16x16x32_bf16 v[152:155], a[16:19], a[140:143], v[152:155]
    buffer_load_dwordx4 a[64:67], v11, s[44:47], s12 offen offset:3072 sc1
    v_mfma_f32_16x16x32_bf16 v[156:159], a[16:19], a[144:147], v[156:159]
    v_mfma_f32_16x16x32_bf16 v[160:163], a[16:19], a[148:151], v[160:163]
    v_mfma_f32_16x16x32_bf16 v[164:167], a[20:23], a[132:135], v[164:167]
    ds_read_b128 a[16:19], v18 offset:17440
    v_mfma_f32_16x16x32_bf16 v[168:171], a[20:23], a[136:139], v[168:171]
    v_mfma_f32_16x16x32_bf16 v[172:175], a[20:23], a[140:143], v[172:175]
    buffer_load_dwordx4 a[68:71], v1, s[44:47], s12 offen sc1
    v_mfma_f32_16x16x32_bf16 v[176:179], a[20:23], a[144:147], v[176:179]
    v_mfma_f32_16x16x32_bf16 v[180:183], a[20:23], a[148:151], v[180:183]
    v_mfma_f32_16x16x32_bf16 v[184:187], a[24:27], a[132:135], v[184:187]
    ds_read_b128 a[20:23], v18 offset:17696
    v_mfma_f32_16x16x32_bf16 v[188:191], a[24:27], a[136:139], v[188:191]
    v_mfma_f32_16x16x32_bf16 v[192:195], a[24:27], a[140:143], v[192:195]
    s_add_u32 m0, s8, 3184
    s_add_u32 s11, s67, 524288
    buffer_load_dwordx4 v5, s[40:43], s11 offen sc1 lds
    v_mfma_f32_16x16x32_bf16 v[196:199], a[24:27], a[144:147], v[196:199]
    v_mfma_f32_16x16x32_bf16 v[200:203], a[24:27], a[148:151], v[200:203]
    v_mfma_f32_16x16x32_bf16 v[204:207], a[28:31], a[132:135], v[204:207]
    ds_read_b128 a[24:27], v19 offset:17440
    v_mfma_f32_16x16x32_bf16 v[208:211], a[28:31], a[136:139], v[208:211]
    v_mfma_f32_16x16x32_bf16 v[212:215], a[28:31], a[140:143], v[212:215]
    s_add_u32 m0, s8, 7536
    s_add_u32 s11, s67, 589824
    buffer_load_dwordx4 v5, s[40:43], s11 offen sc1 lds
    v_mfma_f32_16x16x32_bf16 v[216:219], a[28:31], a[144:147], v[216:219]
    v_mfma_f32_16x16x32_bf16 v[220:223], a[28:31], a[148:151], v[220:223]
    s_waitcnt vmcnt(24)
    s_waitcnt lgkmcnt(3)
    v_mfma_f32_16x16x32_bf16 v[64:67], a[0:3], a[152:155], v[64:67]
    ds_read_b128 a[28:31], v19 offset:17696
    v_mfma_f32_16x16x32_bf16 v[68:71], a[0:3], a[156:159], v[68:71]
    v_mfma_f32_16x16x32_bf16 v[72:75], a[0:3], a[160:163], v[72:75]
    ds_read_b128 a[192:195], v19 offset:19520
    v_mfma_f32_16x16x32_bf16 v[76:79], a[0:3], a[164:167], v[76:79]
    s_add_u32 s12, s10, 92160
    buffer_load_dwordx4 a[72:75], v11, s[44:47], s12 offen offset:0 sc1
    v_mfma_f32_16x16x32_bf16 v[80:83], a[0:3], a[168:171], v[80:83]
    v_mfma_f32_16x16x32_bf16 v[84:87], a[4:7], a[152:155], v[84:87]
    ds_read_b128 a[0:3], v16 offset:19520
    v_mfma_f32_16x16x32_bf16 v[88:91], a[4:7], a[156:159], v[88:91]
    v_mfma_f32_16x16x32_bf16 v[92:95], a[4:7], a[160:163], v[92:95]
    ds_read_b128 a[196:199], v19 offset:19776
    v_mfma_f32_16x16x32_bf16 v[96:99], a[4:7], a[164:167], v[96:99]
    v_mfma_f32_16x16x32_bf16 v[100:103], a[4:7], a[168:171], v[100:103]
    buffer_load_dwordx4 a[76:79], v11, s[44:47], s12 offen offset:1024 sc1
    v_mfma_f32_16x16x32_bf16 v[104:107], a[8:11], a[152:155], v[104:107]
    ds_read_b128 a[4:7], v16 offset:19776
    v_mfma_f32_16x16x32_bf16 v[108:111], a[8:11], a[156:159], v[108:111]
    v_mfma_f32_16x16x32_bf16 v[112:115], a[8:11], a[160:163], v[112:115]
    v_mfma_f32_16x16x32_bf16 v[116:119], a[8:11], a[164:167], v[116:119]
    buffer_load_dwordx4 a[80:83], v11, s[44:47], s12 offen offset:2048 sc1
    v_mfma_f32_16x16x32_bf16 v[120:123], a[8:11], a[168:171], v[120:123]
    v_mfma_f32_16x16x32_bf16 v[124:127], a[12:15], a[152:155], v[124:127]
    ds_read_b128 a[8:11], v17 offset:19520
    v_mfma_f32_16x16x32_bf16 v[128:131], a[12:15], a[156:159], v[128:131]
    v_mfma_f32_16x16x32_bf16 v[132:135], a[12:15], a[160:163], v[132:135]
    v_mfma_f32_16x16x32_bf16 v[136:139], a[12:15], a[164:167], v[136:139]
    buffer_load_dwordx4 a[84:87], v11, s[44:47], s12 offen offset:3072 sc1
    v_mfma_f32_16x16x32_bf16 v[140:143], a[12:15], a[168:171], v[140:143]
    s_waitcnt lgkmcnt(5)
    v_mfma_f32_16x16x32_bf16 v[144:147], a[16:19], a[152:155], v[144:147]
    ds_read_b128 a[12:15], v17 offset:19776
    v_mfma_f32_16x16x32_bf16 v[148:151], a[16:19], a[156:159], v[148:151]
    v_mfma_f32_16x16x32_bf16 v[152:155], a[16:19], a[160:163], v[152:155]
    v_mfma_f32_16x16x32_bf16 v[156:159], a[16:19], a[164:167], v[156:159]
    buffer_load_dwordx4 a[88:91], v1, s[44:47], s12 offen sc1
    v_mfma_f32_16x16x32_bf16 v[160:163], a[16:19], a[168:171], v[160:163]
    v_mfma_f32_16x16x32_bf16 v[164:167], a[20:23], a[152:155], v[164:167]
    ds_read_b128 a[16:19], v18 offset:19520
    v_mfma_f32_16x16x32_bf16 v[168:171], a[20:23], a[156:159], v[168:171]
    v_mfma_f32_16x16x32_bf16 v[172:175], a[20:23], a[160:163], v[172:175]
    v_mfma_f32_16x16x32_bf16 v[176:179], a[20:23], a[164:167], v[176:179]
    s_add_u32 s12, s10, 97280
    buffer_load_dwordx4 a[92:95], v11, s[44:47], s12 offen offset:0 sc1
    v_mfma_f32_16x16x32_bf16 v[180:183], a[20:23], a[168:171], v[180:183]
    v_mfma_f32_16x16x32_bf16 v[184:187], a[24:27], a[152:155], v[184:187]
    ds_read_b128 a[20:23], v18 offset:19776
    v_mfma_f32_16x16x32_bf16 v[188:191], a[24:27], a[156:159], v[188:191]
    v_mfma_f32_16x16x32_bf16 v[192:195], a[24:27], a[160:163], v[192:195]
    buffer_load_dwordx4 a[96:99], v11, s[44:47], s12 offen offset:1024 sc1
    v_mfma_f32_16x16x32_bf16 v[196:199], a[24:27], a[164:167], v[196:199]
    v_mfma_f32_16x16x32_bf16 v[200:203], a[24:27], a[168:171], v[200:203]
    v_mfma_f32_16x16x32_bf16 v[204:207], a[28:31], a[152:155], v[204:207]
    v_mfma_f32_16x16x32_bf16 v[208:211], a[28:31], a[156:159], v[208:211]
    v_mfma_f32_16x16x32_bf16 v[212:215], a[28:31], a[160:163], v[212:215]
    buffer_load_dwordx4 a[100:103], v11, s[44:47], s12 offen offset:2048 sc1
    v_mfma_f32_16x16x32_bf16 v[216:219], a[28:31], a[164:167], v[216:219]
    v_mfma_f32_16x16x32_bf16 v[220:223], a[28:31], a[168:171], v[220:223]
    s_waitcnt vmcnt(26) lgkmcnt(3)
    v_mfma_f32_16x16x32_bf16 v[64:67], a[0:3], a[172:175], v[64:67]
    v_mfma_f32_16x16x32_bf16 v[68:71], a[0:3], a[176:179], v[68:71]
    v_mfma_f32_16x16x32_bf16 v[72:75], a[0:3], a[180:183], v[72:75]
    ds_read_b128 a[200:203], v19 offset:19536
    v_mfma_f32_16x16x32_bf16 v[76:79], a[0:3], a[184:187], v[76:79]
    buffer_load_dwordx4 a[104:107], v11, s[44:47], s12 offen offset:3072 sc1
    v_mfma_f32_16x16x32_bf16 v[80:83], a[0:3], a[188:191], v[80:83]
    v_mfma_f32_16x16x32_bf16 v[84:87], a[4:7], a[172:175], v[84:87]
    ds_read_b128 a[0:3], v16 offset:19536
    v_mfma_f32_16x16x32_bf16 v[88:91], a[4:7], a[176:179], v[88:91]
    buffer_load_dwordx4 a[108:111], v1, s[44:47], s12 offen sc1
    v_mfma_f32_16x16x32_bf16 v[92:95], a[4:7], a[180:183], v[92:95]
    ds_read_b128 a[204:207], v19 offset:19792
    v_mfma_f32_16x16x32_bf16 v[96:99], a[4:7], a[184:187], v[96:99]
    v_mfma_f32_16x16x32_bf16 v[100:103], a[4:7], a[188:191], v[100:103]
    v_mfma_f32_16x16x32_bf16 v[104:107], a[8:11], a[172:175], v[104:107]
    ds_read_b128 a[4:7], v16 offset:19792
    v_mfma_f32_16x16x32_bf16 v[108:111], a[8:11], a[176:179], v[108:111]
    s_add_u32 s12, s10, 102400
    buffer_load_dwordx4 a[112:115], v11, s[44:47], s12 offen offset:0 sc1
    v_mfma_f32_16x16x32_bf16 v[112:115], a[8:11], a[180:183], v[112:115]
    v_mfma_f32_16x16x32_bf16 v[116:119], a[8:11], a[184:187], v[116:119]
    buffer_load_dwordx4 a[116:119], v11, s[44:47], s12 offen offset:1024 sc1
    v_mfma_f32_16x16x32_bf16 v[120:123], a[8:11], a[188:191], v[120:123]
    s_waitcnt lgkmcnt(4)
    v_mfma_f32_16x16x32_bf16 v[124:127], a[12:15], a[172:175], v[124:127]
    ds_read_b128 a[8:11], v17 offset:19536
    v_mfma_f32_16x16x32_bf16 v[128:131], a[12:15], a[176:179], v[128:131]
    v_mfma_f32_16x16x32_bf16 v[132:135], a[12:15], a[180:183], v[132:135]
    v_mfma_f32_16x16x32_bf16 v[136:139], a[12:15], a[184:187], v[136:139]
    buffer_load_dwordx4 a[120:123], v11, s[44:47], s12 offen offset:2048 sc1
    v_mfma_f32_16x16x32_bf16 v[140:143], a[12:15], a[188:191], v[140:143]
    v_mfma_f32_16x16x32_bf16 v[144:147], a[16:19], a[172:175], v[144:147]
    ds_read_b128 a[12:15], v17 offset:19792
    v_mfma_f32_16x16x32_bf16 v[148:151], a[16:19], a[176:179], v[148:151]
    buffer_load_dwordx4 a[124:127], v11, s[44:47], s12 offen offset:3072 sc1
    v_mfma_f32_16x16x32_bf16 v[152:155], a[16:19], a[180:183], v[152:155]
    v_mfma_f32_16x16x32_bf16 v[156:159], a[16:19], a[184:187], v[156:159]
    v_mfma_f32_16x16x32_bf16 v[160:163], a[16:19], a[188:191], v[160:163]
    buffer_load_dwordx4 a[128:131], v1, s[44:47], s12 offen sc1
    v_mfma_f32_16x16x32_bf16 v[164:167], a[20:23], a[172:175], v[164:167]
    ds_read_b128 a[16:19], v18 offset:19536
    v_mfma_f32_16x16x32_bf16 v[168:171], a[20:23], a[176:179], v[168:171]
    v_mfma_f32_16x16x32_bf16 v[172:175], a[20:23], a[180:183], v[172:175]
    s_add_u32 s12, s10, 107520
    buffer_load_dwordx4 a[132:135], v11, s[44:47], s12 offen offset:0 sc1
    v_mfma_f32_16x16x32_bf16 v[176:179], a[20:23], a[184:187], v[176:179]
    v_mfma_f32_16x16x32_bf16 v[180:183], a[20:23], a[188:191], v[180:183]
    s_waitcnt vmcnt(29) lgkmcnt(2)
    v_mfma_f32_16x16x32_bf16 v[64:67], a[0:3], a[32:35], v[64:67]
    ds_read_b128 a[20:23], v18 offset:19792
    v_mfma_f32_16x16x32_bf16 v[68:71], a[0:3], a[36:39], v[68:71]
    v_mfma_f32_16x16x32_bf16 v[72:75], a[0:3], a[40:43], v[72:75]
    ds_read_b128 a[208:211], v19 offset:19552
    v_mfma_f32_16x16x32_bf16 v[76:79], a[0:3], a[44:47], v[76:79]
    buffer_load_dwordx4 a[136:139], v11, s[44:47], s12 offen offset:1024 sc1
    v_mfma_f32_16x16x32_bf16 v[80:83], a[0:3], a[48:51], v[80:83]
    v_mfma_f32_16x16x32_bf16 v[84:87], a[4:7], a[32:35], v[84:87]
    ds_read_b128 a[0:3], v16 offset:19552
    v_mfma_f32_16x16x32_bf16 v[88:91], a[4:7], a[36:39], v[88:91]
    buffer_load_dwordx4 a[140:143], v11, s[44:47], s12 offen offset:2048 sc1
    v_mfma_f32_16x16x32_bf16 v[92:95], a[4:7], a[40:43], v[92:95]
    ds_read_b128 a[212:215], v19 offset:19808
    v_mfma_f32_16x16x32_bf16 v[96:99], a[4:7], a[44:47], v[96:99]
    v_mfma_f32_16x16x32_bf16 v[100:103], a[4:7], a[48:51], v[100:103]
    v_mfma_f32_16x16x32_bf16 v[104:107], a[8:11], a[32:35], v[104:107]
    ds_read_b128 a[4:7], v16 offset:19808
    v_mfma_f32_16x16x32_bf16 v[108:111], a[8:11], a[36:39], v[108:111]
    buffer_load_dwordx4 a[144:147], v11, s[44:47], s12 offen offset:3072 sc1
    v_mfma_f32_16x16x32_bf16 v[112:115], a[8:11], a[40:43], v[112:115]
    v_mfma_f32_16x16x32_bf16 v[116:119], a[8:11], a[44:47], v[116:119]
    buffer_load_dwordx4 a[148:151], v1, s[44:47], s12 offen sc1
    v_mfma_f32_16x16x32_bf16 v[120:123], a[8:11], a[48:51], v[120:123]
    s_waitcnt lgkmcnt(4)
    v_mfma_f32_16x16x32_bf16 v[124:127], a[12:15], a[32:35], v[124:127]
    ds_read_b128 a[8:11], v17 offset:19552
    v_mfma_f32_16x16x32_bf16 v[128:131], a[12:15], a[36:39], v[128:131]
    v_mfma_f32_16x16x32_bf16 v[132:135], a[12:15], a[40:43], v[132:135]
    v_mfma_f32_16x16x32_bf16 v[136:139], a[12:15], a[44:47], v[136:139]
    s_add_u32 s12, s10, 112640
    buffer_load_dwordx4 a[152:155], v11, s[44:47], s12 offen offset:0 sc1
    v_mfma_f32_16x16x32_bf16 v[140:143], a[12:15], a[48:51], v[140:143]
    v_mfma_f32_16x16x32_bf16 v[144:147], a[16:19], a[32:35], v[144:147]
    ds_read_b128 a[12:15], v17 offset:19808
    v_mfma_f32_16x16x32_bf16 v[148:151], a[16:19], a[36:39], v[148:151]
    buffer_load_dwordx4 a[156:159], v11, s[44:47], s12 offen offset:1024 sc1
    v_mfma_f32_16x16x32_bf16 v[152:155], a[16:19], a[40:43], v[152:155]
    v_mfma_f32_16x16x32_bf16 v[156:159], a[16:19], a[44:47], v[156:159]
    v_mfma_f32_16x16x32_bf16 v[160:163], a[16:19], a[48:51], v[160:163]
    buffer_load_dwordx4 a[160:163], v11, s[44:47], s12 offen offset:2048 sc1
    v_mfma_f32_16x16x32_bf16 v[164:167], a[20:23], a[32:35], v[164:167]
    ds_read_b128 a[16:19], v18 offset:19552
    v_mfma_f32_16x16x32_bf16 v[168:171], a[20:23], a[36:39], v[168:171]
    v_mfma_f32_16x16x32_bf16 v[172:175], a[20:23], a[40:43], v[172:175]
    buffer_load_dwordx4 a[164:167], v11, s[44:47], s12 offen offset:3072 sc1
    v_mfma_f32_16x16x32_bf16 v[176:179], a[20:23], a[44:47], v[176:179]
    v_mfma_f32_16x16x32_bf16 v[180:183], a[20:23], a[48:51], v[180:183]
    ds_read_b128 a[20:23], v18 offset:19808
    s_waitcnt vmcnt(26)
    v_add_u32 v16, v16, v13
    v_add_u32 v17, v17, v13
    v_add_u32 v18, v18, v13
    v_add_u32 v19, v19, v13
    s_waitcnt lgkmcnt(3)
    v_mfma_f32_16x16x32_bf16 v[64:67], a[0:3], a[52:55], v[64:67]
    v_mfma_f32_16x16x32_bf16 v[68:71], a[0:3], a[56:59], v[68:71]
    v_permlane16_swap_b32 v24, v26
    v_permlane16_swap_b32 v25, v27
    v_mfma_f32_16x16x32_bf16 v[72:75], a[0:3], a[60:63], v[72:75]
    ds_read_b128 a[216:219], v19 offset:32
    v_mfma_f32_16x16x32_bf16 v[76:79], a[0:3], a[64:67], v[76:79]
    v_lshlrev_b32 v224, 16, v24
    v_and_b32 v225, 0xffff0000, v24
    v_mfma_f32_16x16x32_bf16 v[80:83], a[0:3], a[68:71], v[80:83]
    v_lshlrev_b32 v226, 16, v25
    v_and_b32 v227, 0xffff0000, v25
    v_mfma_f32_16x16x32_bf16 v[84:87], a[4:7], a[52:55], v[84:87]
    ds_read_b128 a[0:3], v16 offset:32
    v_mfma_f32_16x16x32_bf16 v[88:91], a[4:7], a[56:59], v[88:91]
    v_lshlrev_b32 v228, 16, v26
    v_and_b32 v229, 0xffff0000, v26
    v_mfma_f32_16x16x32_bf16 v[92:95], a[4:7], a[60:63], v[92:95]
    ds_read_b128 a[220:223], v19 offset:288
    v_mfma_f32_16x16x32_bf16 v[96:99], a[4:7], a[64:67], v[96:99]
    v_lshlrev_b32 v230, 16, v27
    v_and_b32 v231, 0xffff0000, v27
    v_mfma_f32_16x16x32_bf16 v[100:103], a[4:7], a[68:71], v[100:103]
    v_add_f32 v184, v184, v224
    v_add_f32 v185, v185, v225
    v_mfma_f32_16x16x32_bf16 v[104:107], a[8:11], a[52:55], v[104:107]
    ds_read_b128 a[4:7], v16 offset:288
    v_mfma_f32_16x16x32_bf16 v[108:111], a[8:11], a[56:59], v[108:111]
    v_add_f32 v186, v186, v226
    v_add_f32 v187, v187, v227
    v_mfma_f32_16x16x32_bf16 v[112:115], a[8:11], a[60:63], v[112:115]
    v_add_f32 v204, v204, v228
    v_add_f32 v205, v205, v229
    v_mfma_f32_16x16x32_bf16 v[116:119], a[8:11], a[64:67], v[116:119]
    v_add_f32 v206, v206, v230
    v_add_f32 v207, v207, v231
    v_mfma_f32_16x16x32_bf16 v[120:123], a[8:11], a[68:71], v[120:123]
    s_waitcnt lgkmcnt(4)
    v_mfma_f32_16x16x32_bf16 v[124:127], a[12:15], a[52:55], v[124:127]
    ds_read_b128 a[8:11], v17 offset:32
    v_mfma_f32_16x16x32_bf16 v[128:131], a[12:15], a[56:59], v[128:131]
    v_permlane16_swap_b32 v28, v30
    v_permlane16_swap_b32 v29, v31
    v_mfma_f32_16x16x32_bf16 v[132:135], a[12:15], a[60:63], v[132:135]
    buffer_load_dwordx4 a[168:171], v1, s[44:47], s12 offen sc1
    v_mfma_f32_16x16x32_bf16 v[136:139], a[12:15], a[64:67], v[136:139]
    v_lshlrev_b32 v232, 16, v28
    v_and_b32 v233, 0xffff0000, v28
    v_mfma_f32_16x16x32_bf16 v[140:143], a[12:15], a[68:71], v[140:143]
    v_lshlrev_b32 v234, 16, v29
    v_and_b32 v235, 0xffff0000, v29
    v_mfma_f32_16x16x32_bf16 v[144:147], a[16:19], a[52:55], v[144:147]
    ds_read_b128 a[12:15], v17 offset:288
    v_mfma_f32_16x16x32_bf16 v[148:151], a[16:19], a[56:59], v[148:151]
    v_lshlrev_b32 v236, 16, v30
    v_and_b32 v237, 0xffff0000, v30
    v_mfma_f32_16x16x32_bf16 v[152:155], a[16:19], a[60:63], v[152:155]
    v_lshlrev_b32 v238, 16, v31
    v_and_b32 v239, 0xffff0000, v31
    v_mfma_f32_16x16x32_bf16 v[156:159], a[16:19], a[64:67], v[156:159]
    v_add_f32 v188, v188, v232
    v_add_f32 v189, v189, v233
    v_mfma_f32_16x16x32_bf16 v[160:163], a[16:19], a[68:71], v[160:163]
    v_add_f32 v190, v190, v234
    v_add_f32 v191, v191, v235
    v_mfma_f32_16x16x32_bf16 v[164:167], a[20:23], a[52:55], v[164:167]
    ds_read_b128 a[16:19], v18 offset:32
    v_mfma_f32_16x16x32_bf16 v[168:171], a[20:23], a[56:59], v[168:171]
    v_add_f32 v208, v208, v236
    v_add_f32 v209, v209, v237
    v_mfma_f32_16x16x32_bf16 v[172:175], a[20:23], a[60:63], v[172:175]
    v_add_f32 v210, v210, v238
    v_add_f32 v211, v211, v239
    v_mfma_f32_16x16x32_bf16 v[176:179], a[20:23], a[64:67], v[176:179]
    v_permlane16_swap_b32 v32, v34
    v_permlane16_swap_b32 v33, v35
    v_mfma_f32_16x16x32_bf16 v[180:183], a[20:23], a[68:71], v[180:183]
    ds_read_b128 a[20:23], v18 offset:288
    s_waitcnt vmcnt(20)
    v_add_u32 v16, v16, v14
    v_add_u32 v17, v17, v14
    v_add_u32 v18, v18, v14
    v_add_u32 v19, v19, v14
    v_add_u32 v4, v16, v15
    v_add_u32 v5, v17, v15
    v_add_u32 v6, v18, v15
    v_add_u32 v8, v19, v15
    s_waitcnt lgkmcnt(3)
    v_mfma_f32_16x16x32_bf16 v[64:67], a[0:3], a[72:75], v[64:67]
    v_mfma_f32_16x16x32_bf16 v[68:71], a[0:3], a[76:79], v[68:71]
    v_lshlrev_b32 v224, 16, v32
    v_and_b32 v225, 0xffff0000, v32
    v_mfma_f32_16x16x32_bf16 v[72:75], a[0:3], a[80:83], v[72:75]
    ds_read_b128 a[224:227], v19 offset:2144
    v_mfma_f32_16x16x32_bf16 v[76:79], a[0:3], a[84:87], v[76:79]
    ds_read_b128 a[248:251], v8 offset:2112
    v_mfma_f32_16x16x32_bf16 v[80:83], a[0:3], a[88:91], v[80:83]
    v_lshlrev_b32 v226, 16, v33
    v_and_b32 v227, 0xffff0000, v33
    v_mfma_f32_16x16x32_bf16 v[84:87], a[4:7], a[72:75], v[84:87]
    ds_read_b128 a[0:3], v16 offset:2144
    v_mfma_f32_16x16x32_bf16 v[88:91], a[4:7], a[76:79], v[88:91]
    v_lshlrev_b32 v228, 16, v34
    v_and_b32 v229, 0xffff0000, v34
    v_mfma_f32_16x16x32_bf16 v[92:95], a[4:7], a[80:83], v[92:95]
    ds_read_b128 a[228:231], v19 offset:2400
    v_mfma_f32_16x16x32_bf16 v[96:99], a[4:7], a[84:87], v[96:99]
    ds_read_b128 a[252:255], v8 offset:2368
    v_mfma_f32_16x16x32_bf16 v[100:103], a[4:7], a[88:91], v[100:103]
    v_lshlrev_b32 v230, 16, v35
    v_and_b32 v231, 0xffff0000, v35
    v_mfma_f32_16x16x32_bf16 v[104:107], a[8:11], a[72:75], v[104:107]
    ds_read_b128 a[4:7], v4 offset:0
    v_mfma_f32_16x16x32_bf16 v[108:111], a[8:11], a[76:79], v[108:111]
    v_add_f32 v192, v192, v224
    v_add_f32 v193, v193, v225
    v_mfma_f32_16x16x32_bf16 v[112:115], a[8:11], a[80:83], v[112:115]
    ds_read_b128 a[232:235], v8 offset:0
    v_mfma_f32_16x16x32_bf16 v[116:119], a[8:11], a[84:87], v[116:119]
    v_add_f32 v194, v194, v226
    v_add_f32 v195, v195, v227
    v_mfma_f32_16x16x32_bf16 v[120:123], a[8:11], a[88:91], v[120:123]
    s_waitcnt lgkmcnt(7)
    v_mfma_f32_16x16x32_bf16 v[124:127], a[12:15], a[72:75], v[124:127]
    ds_read_b128 a[8:11], v4 offset:1056
    v_mfma_f32_16x16x32_bf16 v[128:131], a[12:15], a[76:79], v[128:131]
    v_add_f32 v212, v212, v228
    v_add_f32 v213, v213, v229
    v_mfma_f32_16x16x32_bf16 v[132:135], a[12:15], a[80:83], v[132:135]
    ds_read_b128 a[236:239], v8 offset:256
    v_mfma_f32_16x16x32_bf16 v[136:139], a[12:15], a[84:87], v[136:139]
    v_add_f32 v214, v214, v230
    v_add_f32 v215, v215, v231
    v_mfma_f32_16x16x32_bf16 v[140:143], a[12:15], a[88:91], v[140:143]
    v_permlane16_swap_b32 v36, v38
    v_permlane16_swap_b32 v37, v39
    v_mfma_f32_16x16x32_bf16 v[144:147], a[16:19], a[72:75], v[144:147]
    ds_read_b128 a[12:15], v4 offset:2112
    v_mfma_f32_16x16x32_bf16 v[148:151], a[16:19], a[76:79], v[148:151]
    v_lshlrev_b32 v232, 16, v36
    v_and_b32 v233, 0xffff0000, v36
    v_mfma_f32_16x16x32_bf16 v[152:155], a[16:19], a[80:83], v[152:155]
    ds_read_b128 a[240:243], v8 offset:1056
    v_mfma_f32_16x16x32_bf16 v[156:159], a[16:19], a[84:87], v[156:159]
    v_lshlrev_b32 v234, 16, v37
    v_and_b32 v235, 0xffff0000, v37
    v_mfma_f32_16x16x32_bf16 v[160:163], a[16:19], a[88:91], v[160:163]
    v_lshlrev_b32 v236, 16, v38
    v_and_b32 v237, 0xffff0000, v38
    v_mfma_f32_16x16x32_bf16 v[164:167], a[20:23], a[72:75], v[164:167]
    v_mfma_f32_16x16x32_bf16 v[168:171], a[20:23], a[76:79], v[168:171]
    v_lshlrev_b32 v238, 16, v39
    v_and_b32 v239, 0xffff0000, v39
    v_mfma_f32_16x16x32_bf16 v[172:175], a[20:23], a[80:83], v[172:175]
    ds_read_b128 a[244:247], v8 offset:1312
    v_mfma_f32_16x16x32_bf16 v[176:179], a[20:23], a[84:87], v[176:179]
    v_add_f32 v196, v196, v232
    v_add_f32 v197, v197, v233
    v_mfma_f32_16x16x32_bf16 v[180:183], a[20:23], a[88:91], v[180:183]
    s_waitcnt vmcnt(0) lgkmcnt(2)
    v_mfma_f32_16x16x32_bf16 v[64:67], a[0:3], a[92:95], v[64:67]
    ds_read_b128 a[16:19], v16 offset:2400
    v_mfma_f32_16x16x32_bf16 v[68:71], a[0:3], a[96:99], v[68:71]
    v_add_f32 v198, v198, v234
    v_add_f32 v199, v199, v235
    v_mfma_f32_16x16x32_bf16 v[72:75], a[0:3], a[100:103], v[72:75]
    v_add_f32 v216, v216, v236
    v_add_f32 v217, v217, v237
    v_mfma_f32_16x16x32_bf16 v[76:79], a[0:3], a[104:107], v[76:79]
    v_add_f32 v218, v218, v238
    v_add_f32 v219, v219, v239
    v_mfma_f32_16x16x32_bf16 v[80:83], a[0:3], a[108:111], v[80:83]
    v_permlane16_swap_b32 v40, v42
    v_permlane16_swap_b32 v41, v43
    v_mfma_f32_16x16x32_bf16 v[64:67], a[4:7], a[112:115], v[64:67]
    ds_read_b128 a[20:23], v4 offset:256
    v_mfma_f32_16x16x32_bf16 v[68:71], a[4:7], a[116:119], v[68:71]
    v_lshlrev_b32 v224, 16, v40
    v_and_b32 v225, 0xffff0000, v40
    v_mfma_f32_16x16x32_bf16 v[72:75], a[4:7], a[120:123], v[72:75]
    v_lshlrev_b32 v226, 16, v41
    v_and_b32 v227, 0xffff0000, v41
    v_mfma_f32_16x16x32_bf16 v[76:79], a[4:7], a[124:127], v[76:79]
    v_lshlrev_b32 v228, 16, v42
    v_and_b32 v229, 0xffff0000, v42
    v_mfma_f32_16x16x32_bf16 v[80:83], a[4:7], a[128:131], v[80:83]
    v_lshlrev_b32 v230, 16, v43
    v_and_b32 v231, 0xffff0000, v43
    v_mfma_f32_16x16x32_bf16 v[64:67], a[8:11], a[132:135], v[64:67]
    ds_read_b128 a[24:27], v4 offset:1312
    v_mfma_f32_16x16x32_bf16 v[68:71], a[8:11], a[136:139], v[68:71]
    v_add_f32 v200, v200, v224
    v_add_f32 v201, v201, v225
    v_mfma_f32_16x16x32_bf16 v[72:75], a[8:11], a[140:143], v[72:75]
    v_add_f32 v202, v202, v226
    v_add_f32 v203, v203, v227
    v_mfma_f32_16x16x32_bf16 v[76:79], a[8:11], a[144:147], v[76:79]
    v_add_f32 v220, v220, v228
    v_add_f32 v221, v221, v229
    v_mfma_f32_16x16x32_bf16 v[80:83], a[8:11], a[148:151], v[80:83]
    v_add_f32 v222, v222, v230
    v_add_f32 v223, v223, v231
    v_mfma_f32_16x16x32_bf16 v[64:67], a[12:15], a[152:155], v[64:67]
    ds_read_b128 a[28:31], v4 offset:2368
    v_mfma_f32_16x16x32_bf16 v[68:71], a[12:15], a[156:159], v[68:71]
    v_mfma_f32_16x16x32_bf16 v[72:75], a[12:15], a[160:163], v[72:75]
    v_mfma_f32_16x16x32_bf16 v[76:79], a[12:15], a[164:167], v[76:79]
    v_mfma_f32_16x16x32_bf16 v[80:83], a[12:15], a[168:171], v[80:83]
    s_waitcnt lgkmcnt(0)
    v_mfma_f32_16x16x32_bf16 v[84:87], a[16:19], a[92:95], v[84:87]
    ds_read_b128 a[0:3], v17 offset:2144
    v_mfma_f32_16x16x32_bf16 v[88:91], a[16:19], a[96:99], v[88:91]
    v_mfma_f32_16x16x32_bf16 v[92:95], a[16:19], a[100:103], v[92:95]
    v_mfma_f32_16x16x32_bf16 v[96:99], a[16:19], a[104:107], v[96:99]
    ds_write_b128 v20, v[64:67] offset:0
    v_mfma_f32_16x16x32_bf16 v[100:103], a[16:19], a[108:111], v[100:103]
    v_mfma_f32_16x16x32_bf16 v[84:87], a[20:23], a[112:115], v[84:87]
    ds_read_b128 a[4:7], v5 offset:0
    v_mfma_f32_16x16x32_bf16 v[88:91], a[20:23], a[116:119], v[88:91]
    v_mfma_f32_16x16x32_bf16 v[92:95], a[20:23], a[120:123], v[92:95]
    ds_write_b128 v20, v[68:71] offset:1024
    v_mfma_f32_16x16x32_bf16 v[96:99], a[20:23], a[124:127], v[96:99]
    v_mfma_f32_16x16x32_bf16 v[100:103], a[20:23], a[128:131], v[100:103]
    v_mfma_f32_16x16x32_bf16 v[84:87], a[24:27], a[132:135], v[84:87]
    ds_read_b128 a[8:11], v5 offset:1056
    v_mfma_f32_16x16x32_bf16 v[88:91], a[24:27], a[136:139], v[88:91]
    ds_write_b128 v20, v[72:75] offset:2048
    v_mfma_f32_16x16x32_bf16 v[92:95], a[24:27], a[140:143], v[92:95]
    v_mfma_f32_16x16x32_bf16 v[96:99], a[24:27], a[144:147], v[96:99]
    v_mfma_f32_16x16x32_bf16 v[100:103], a[24:27], a[148:151], v[100:103]
    ds_write_b128 v20, v[76:79] offset:3072
    v_mfma_f32_16x16x32_bf16 v[84:87], a[28:31], a[152:155], v[84:87]
    ds_read_b128 a[12:15], v5 offset:2112
    v_mfma_f32_16x16x32_bf16 v[88:91], a[28:31], a[156:159], v[88:91]
    v_mfma_f32_16x16x32_bf16 v[92:95], a[28:31], a[160:163], v[92:95]
    v_mfma_f32_16x16x32_bf16 v[96:99], a[28:31], a[164:167], v[96:99]
    ds_write_b128 v20, v[80:83] offset:4096
    v_mfma_f32_16x16x32_bf16 v[100:103], a[28:31], a[168:171], v[100:103]
    s_waitcnt lgkmcnt(1)
    v_mfma_f32_16x16x32_bf16 v[104:107], a[0:3], a[92:95], v[104:107]
    ds_read_b128 a[16:19], v17 offset:2400
    v_mfma_f32_16x16x32_bf16 v[108:111], a[0:3], a[96:99], v[108:111]
    v_mfma_f32_16x16x32_bf16 v[112:115], a[0:3], a[100:103], v[112:115]
    v_mfma_f32_16x16x32_bf16 v[116:119], a[0:3], a[104:107], v[116:119]
    ds_write_b128 v20, v[84:87] offset:5120
    v_mfma_f32_16x16x32_bf16 v[120:123], a[0:3], a[108:111], v[120:123]
    v_mfma_f32_16x16x32_bf16 v[104:107], a[4:7], a[112:115], v[104:107]
    ds_read_b128 a[20:23], v5 offset:256
    v_mfma_f32_16x16x32_bf16 v[108:111], a[4:7], a[116:119], v[108:111]
    v_mfma_f32_16x16x32_bf16 v[112:115], a[4:7], a[120:123], v[112:115]
    ds_write_b128 v20, v[88:91] offset:6144
    v_mfma_f32_16x16x32_bf16 v[116:119], a[4:7], a[124:127], v[116:119]
    v_mfma_f32_16x16x32_bf16 v[120:123], a[4:7], a[128:131], v[120:123]
    v_mfma_f32_16x16x32_bf16 v[104:107], a[8:11], a[132:135], v[104:107]
    ds_read_b128 a[24:27], v5 offset:1312
    v_mfma_f32_16x16x32_bf16 v[108:111], a[8:11], a[136:139], v[108:111]
    ds_write_b128 v20, v[92:95] offset:7168
    v_mfma_f32_16x16x32_bf16 v[112:115], a[8:11], a[140:143], v[112:115]
    v_mfma_f32_16x16x32_bf16 v[116:119], a[8:11], a[144:147], v[116:119]
    v_mfma_f32_16x16x32_bf16 v[120:123], a[8:11], a[148:151], v[120:123]
    ds_write_b128 v20, v[96:99] offset:8192
    v_mfma_f32_16x16x32_bf16 v[104:107], a[12:15], a[152:155], v[104:107]
    ds_read_b128 a[28:31], v5 offset:2368
    v_mfma_f32_16x16x32_bf16 v[108:111], a[12:15], a[156:159], v[108:111]
    v_mfma_f32_16x16x32_bf16 v[112:115], a[12:15], a[160:163], v[112:115]
    v_mfma_f32_16x16x32_bf16 v[116:119], a[12:15], a[164:167], v[116:119]
    ds_write_b128 v20, v[100:103] offset:9216
    v_mfma_f32_16x16x32_bf16 v[120:123], a[12:15], a[168:171], v[120:123]
    s_waitcnt lgkmcnt(1)
    v_mfma_f32_16x16x32_bf16 v[124:127], a[16:19], a[92:95], v[124:127]
    ds_read_b128 a[0:3], v18 offset:2144
    v_mfma_f32_16x16x32_bf16 v[128:131], a[16:19], a[96:99], v[128:131]
    v_mfma_f32_16x16x32_bf16 v[132:135], a[16:19], a[100:103], v[132:135]
    v_mfma_f32_16x16x32_bf16 v[136:139], a[16:19], a[104:107], v[136:139]
    ds_write_b128 v20, v[104:107] offset:10240
    v_mfma_f32_16x16x32_bf16 v[140:143], a[16:19], a[108:111], v[140:143]
    v_mfma_f32_16x16x32_bf16 v[124:127], a[20:23], a[112:115], v[124:127]
    ds_read_b128 a[4:7], v6 offset:0
    v_mfma_f32_16x16x32_bf16 v[128:131], a[20:23], a[116:119], v[128:131]
    v_mfma_f32_16x16x32_bf16 v[132:135], a[20:23], a[120:123], v[132:135]
    ds_write_b128 v20, v[108:111] offset:11264
    v_mfma_f32_16x16x32_bf16 v[136:139], a[20:23], a[124:127], v[136:139]
    v_mfma_f32_16x16x32_bf16 v[140:143], a[20:23], a[128:131], v[140:143]
    v_mfma_f32_16x16x32_bf16 v[124:127], a[24:27], a[132:135], v[124:127]
    ds_read_b128 a[8:11], v6 offset:1056
    v_mfma_f32_16x16x32_bf16 v[128:131], a[24:27], a[136:139], v[128:131]
    ds_write_b128 v20, v[112:115] offset:12288
    v_mfma_f32_16x16x32_bf16 v[132:135], a[24:27], a[140:143], v[132:135]
    v_mfma_f32_16x16x32_bf16 v[136:139], a[24:27], a[144:147], v[136:139]
    v_mfma_f32_16x16x32_bf16 v[140:143], a[24:27], a[148:151], v[140:143]
    ds_write_b128 v20, v[116:119] offset:13312
    v_mfma_f32_16x16x32_bf16 v[124:127], a[28:31], a[152:155], v[124:127]
    ds_read_b128 a[12:15], v6 offset:2112
    v_mfma_f32_16x16x32_bf16 v[128:131], a[28:31], a[156:159], v[128:131]
    v_mfma_f32_16x16x32_bf16 v[132:135], a[28:31], a[160:163], v[132:135]
    v_mfma_f32_16x16x32_bf16 v[136:139], a[28:31], a[164:167], v[136:139]
    ds_write_b128 v20, v[120:123] offset:14336
    v_mfma_f32_16x16x32_bf16 v[140:143], a[28:31], a[168:171], v[140:143]
    s_waitcnt lgkmcnt(1)
    v_mfma_f32_16x16x32_bf16 v[144:147], a[0:3], a[92:95], v[144:147]
    ds_read_b128 a[16:19], v18 offset:2400
    v_mfma_f32_16x16x32_bf16 v[148:151], a[0:3], a[96:99], v[148:151]
    v_mfma_f32_16x16x32_bf16 v[152:155], a[0:3], a[100:103], v[152:155]
    v_mfma_f32_16x16x32_bf16 v[156:159], a[0:3], a[104:107], v[156:159]
    ds_write_b128 v20, v[124:127] offset:15360
    v_mfma_f32_16x16x32_bf16 v[160:163], a[0:3], a[108:111], v[160:163]
    v_mfma_f32_16x16x32_bf16 v[144:147], a[4:7], a[112:115], v[144:147]
    ds_read_b128 a[20:23], v6 offset:256
    v_mfma_f32_16x16x32_bf16 v[148:151], a[4:7], a[116:119], v[148:151]
    v_mfma_f32_16x16x32_bf16 v[152:155], a[4:7], a[120:123], v[152:155]
    ds_write_b128 v20, v[128:131] offset:16384
    v_mfma_f32_16x16x32_bf16 v[156:159], a[4:7], a[124:127], v[156:159]
    v_mfma_f32_16x16x32_bf16 v[160:163], a[4:7], a[128:131], v[160:163]
    v_mfma_f32_16x16x32_bf16 v[144:147], a[8:11], a[132:135], v[144:147]
    ds_read_b128 a[24:27], v6 offset:1312
    v_mfma_f32_16x16x32_bf16 v[148:151], a[8:11], a[136:139], v[148:151]
    ds_write_b128 v20, v[132:135] offset:17408
    v_mfma_f32_16x16x32_bf16 v[152:155], a[8:11], a[140:143], v[152:155]
    v_mfma_f32_16x16x32_bf16 v[156:159], a[8:11], a[144:147], v[156:159]
    v_mfma_f32_16x16x32_bf16 v[160:163], a[8:11], a[148:151], v[160:163]
    ds_write_b128 v20, v[136:139] offset:18432
    v_mfma_f32_16x16x32_bf16 v[144:147], a[12:15], a[152:155], v[144:147]
    ds_read_b128 a[28:31], v6 offset:2368
    v_mfma_f32_16x16x32_bf16 v[148:151], a[12:15], a[156:159], v[148:151]
    v_mfma_f32_16x16x32_bf16 v[152:155], a[12:15], a[160:163], v[152:155]
    v_mfma_f32_16x16x32_bf16 v[156:159], a[12:15], a[164:167], v[156:159]
    ds_write_b128 v20, v[140:143] offset:19456
    v_mfma_f32_16x16x32_bf16 v[160:163], a[12:15], a[168:171], v[160:163]
    s_waitcnt lgkmcnt(1)
    v_mfma_f32_16x16x32_bf16 v[164:167], a[16:19], a[92:95], v[164:167]
    v_mfma_f32_16x16x32_bf16 v[168:171], a[16:19], a[96:99], v[168:171]
    v_mfma_f32_16x16x32_bf16 v[172:175], a[16:19], a[100:103], v[172:175]
    v_mfma_f32_16x16x32_bf16 v[176:179], a[16:19], a[104:107], v[176:179]
    ds_write_b128 v20, v[144:147] offset:20480
    v_mfma_f32_16x16x32_bf16 v[180:183], a[16:19], a[108:111], v[180:183]
    v_mfma_f32_16x16x32_bf16 v[164:167], a[20:23], a[112:115], v[164:167]
    v_mfma_f32_16x16x32_bf16 v[168:171], a[20:23], a[116:119], v[168:171]
    v_mfma_f32_16x16x32_bf16 v[172:175], a[20:23], a[120:123], v[172:175]
    ds_write_b128 v20, v[148:151] offset:21504
    v_mfma_f32_16x16x32_bf16 v[176:179], a[20:23], a[124:127], v[176:179]
    v_mfma_f32_16x16x32_bf16 v[180:183], a[20:23], a[128:131], v[180:183]
    v_mfma_f32_16x16x32_bf16 v[164:167], a[24:27], a[132:135], v[164:167]
    v_mfma_f32_16x16x32_bf16 v[168:171], a[24:27], a[136:139], v[168:171]
    ds_write_b128 v20, v[152:155] offset:22528
    v_mfma_f32_16x16x32_bf16 v[172:175], a[24:27], a[140:143], v[172:175]
    v_mfma_f32_16x16x32_bf16 v[176:179], a[24:27], a[144:147], v[176:179]
    v_mfma_f32_16x16x32_bf16 v[180:183], a[24:27], a[148:151], v[180:183]
    ds_write_b128 v20, v[156:159] offset:23552
    v_mfma_f32_16x16x32_bf16 v[164:167], a[28:31], a[152:155], v[164:167]
    v_mfma_f32_16x16x32_bf16 v[168:171], a[28:31], a[156:159], v[168:171]
    v_mfma_f32_16x16x32_bf16 v[172:175], a[28:31], a[160:163], v[172:175]
    v_mfma_f32_16x16x32_bf16 v[176:179], a[28:31], a[164:167], v[176:179]
    ds_write_b128 v20, v[160:163] offset:24576
    v_mfma_f32_16x16x32_bf16 v[180:183], a[28:31], a[168:171], v[180:183]
    v_mfma_f32_16x16x32_bf16 v[184:187], a[192:195], a[172:175], v[184:187]
    v_mfma_f32_16x16x32_bf16 v[204:207], a[196:199], a[172:175], v[204:207]
    v_mfma_f32_16x16x32_bf16 v[184:187], a[200:203], a[32:35], v[184:187]
    v_mfma_f32_16x16x32_bf16 v[204:207], a[204:207], a[32:35], v[204:207]
    ds_write_b128 v20, v[164:167] offset:25600
    v_mfma_f32_16x16x32_bf16 v[184:187], a[208:211], a[52:55], v[184:187]
    v_mfma_f32_16x16x32_bf16 v[204:207], a[212:215], a[52:55], v[204:207]
    ds_write_b128 v20, v[168:171] offset:26624
    v_mfma_f32_16x16x32_bf16 v[184:187], a[216:219], a[72:75], v[184:187]
    v_mfma_f32_16x16x32_bf16 v[204:207], a[220:223], a[72:75], v[204:207]
    ds_write_b128 v20, v[172:175] offset:27648
    v_mfma_f32_16x16x32_bf16 v[184:187], a[224:227], a[92:95], v[184:187]
    v_mfma_f32_16x16x32_bf16 v[204:207], a[228:231], a[92:95], v[204:207]
    ds_write_b128 v20, v[176:179] offset:28672
    v_mfma_f32_16x16x32_bf16 v[184:187], a[232:235], a[112:115], v[184:187]
    v_mfma_f32_16x16x32_bf16 v[204:207], a[236:239], a[112:115], v[204:207]
    ds_write_b128 v20, v[180:183] offset:29696
    v_mfma_f32_16x16x32_bf16 v[184:187], a[240:243], a[132:135], v[184:187]
    v_mfma_f32_16x16x32_bf16 v[204:207], a[244:247], a[132:135], v[204:207]
    s_waitcnt lgkmcnt(0)
    s_barrier
    s_add_u32 s14, s13, s3
    s_cmp_lg_u32 s14, 0x10000
    s_cbranch_scc1 c2_noep
    s_mov_b32 s14, 0x24000
    s_mov_b64 exec, 1
    buffer_store_dword v10, v0, s[92:95], s14 offen sc1
    s_mov_b64 exec, -1
c2_noep:
    v_mfma_f32_16x16x32_bf16 v[184:187], a[248:251], a[152:155], v[184:187]
    ds_read_b128 v[64:67], v21 offset:0
    ds_read_b128 v[84:87], v21 offset:5120
    v_mfma_f32_16x16x32_bf16 v[204:207], a[252:255], a[152:155], v[204:207]
    ds_read_b128 v[104:107], v22 offset:0
    ds_read_b128 v[124:127], v22 offset:5120
    v_mfma_f32_16x16x32_bf16 v[188:191], a[192:195], a[176:179], v[188:191]
    ds_read_b128 v[144:147], v23 offset:0
    ds_read_b128 v[164:167], v23 offset:5120
    v_mfma_f32_16x16x32_bf16 v[208:211], a[196:199], a[176:179], v[208:211]
    ds_read_b128 v[68:71], v21 offset:1024
    ds_read_b128 v[88:91], v21 offset:6144
    v_mfma_f32_16x16x32_bf16 v[188:191], a[200:203], a[36:39], v[188:191]
    ds_read_b128 v[108:111], v22 offset:1024
    ds_read_b128 v[128:131], v22 offset:6144
    v_mfma_f32_16x16x32_bf16 v[208:211], a[204:207], a[36:39], v[208:211]
    ds_read_b128 v[148:151], v23 offset:1024
    ds_read_b128 v[168:171], v23 offset:6144
    v_mfma_f32_16x16x32_bf16 v[188:191], a[208:211], a[56:59], v[188:191]
    ds_read_b128 v[72:75], v21 offset:2048
    ds_read_b128 v[92:95], v21 offset:7168
    v_mfma_f32_16x16x32_bf16 v[208:211], a[212:215], a[56:59], v[208:211]
    ds_read_b128 v[112:115], v22 offset:2048
    ds_read_b128 v[132:135], v22 offset:7168
    v_mfma_f32_16x16x32_bf16 v[188:191], a[216:219], a[76:79], v[188:191]
    ds_read_b128 v[152:155], v23 offset:2048
    ds_read_b128 v[172:175], v23 offset:7168
    v_mfma_f32_16x16x32_bf16 v[208:211], a[220:223], a[76:79], v[208:211]
    ds_read_b128 v[76:79], v21 offset:3072
    ds_read_b128 v[96:99], v21 offset:8192
    v_mfma_f32_16x16x32_bf16 v[188:191], a[224:227], a[96:99], v[188:191]
    ds_read_b128 v[116:119], v22 offset:3072
    ds_read_b128 v[136:139], v22 offset:8192
    v_mfma_f32_16x16x32_bf16 v[208:211], a[228:231], a[96:99], v[208:211]
    ds_read_b128 v[156:159], v23 offset:3072
    ds_read_b128 v[176:179], v23 offset:8192
    v_mfma_f32_16x16x32_bf16 v[188:191], a[232:235], a[116:119], v[188:191]
    ds_read_b128 v[80:83], v21 offset:4096
    ds_read_b128 v[100:103], v21 offset:9216
    v_mfma_f32_16x16x32_bf16 v[208:211], a[236:239], a[116:119], v[208:211]
    ds_read_b128 v[120:123], v22 offset:4096
    ds_read_b128 v[140:143], v22 offset:9216
    v_mfma_f32_16x16x32_bf16 v[188:191], a[240:243], a[136:139], v[188:191]
    ds_read_b128 v[160:163], v23 offset:4096
    ds_read_b128 v[180:183], v23 offset:9216
    v_mfma_f32_16x16x32_bf16 v[208:211], a[244:247], a[136:139], v[208:211]
    v_mfma_f32_16x16x32_bf16 v[188:191], a[248:251], a[156:159], v[188:191]
    s_waitcnt lgkmcnt(15)
    v_mfma_f32_16x16x32_bf16 v[208:211], a[252:255], a[156:159], v[208:211]
    v_add_f32 v64, v64, v104
    v_add_f32 v65, v65, v105
    v_mfma_f32_16x16x32_bf16 v[192:195], a[192:195], a[180:183], v[192:195]
    v_add_f32 v66, v66, v106
    v_add_f32 v67, v67, v107
    v_mfma_f32_16x16x32_bf16 v[212:215], a[196:199], a[180:183], v[212:215]
    v_add_f32 v84, v84, v124
    v_add_f32 v85, v85, v125
    v_mfma_f32_16x16x32_bf16 v[192:195], a[200:203], a[40:43], v[192:195]
    v_add_f32 v86, v86, v126
    v_add_f32 v87, v87, v127
    v_mfma_f32_16x16x32_bf16 v[212:215], a[204:207], a[40:43], v[212:215]
    v_add_f32 v64, v64, v144
    v_add_f32 v65, v65, v145
    v_mfma_f32_16x16x32_bf16 v[192:195], a[208:211], a[60:63], v[192:195]
    v_add_f32 v66, v66, v146
    v_add_f32 v67, v67, v147
    v_mfma_f32_16x16x32_bf16 v[212:215], a[212:215], a[60:63], v[212:215]
    v_add_f32 v84, v84, v164
    v_add_f32 v85, v85, v165
    v_mfma_f32_16x16x32_bf16 v[192:195], a[216:219], a[80:83], v[192:195]
    v_add_f32 v86, v86, v166
    v_add_f32 v87, v87, v167
    v_mfma_f32_16x16x32_bf16 v[212:215], a[220:223], a[80:83], v[212:215]
    v_add_f32 v184, v184, v64
    v_add_f32 v185, v185, v65
    v_mfma_f32_16x16x32_bf16 v[192:195], a[224:227], a[100:103], v[192:195]
    v_add_f32 v186, v186, v66
    v_add_f32 v187, v187, v67
    v_mfma_f32_16x16x32_bf16 v[212:215], a[228:231], a[100:103], v[212:215]
    v_add_f32 v204, v204, v84
    v_add_f32 v205, v205, v85
    v_mfma_f32_16x16x32_bf16 v[192:195], a[232:235], a[120:123], v[192:195]
    v_add_f32 v206, v206, v86
    v_add_f32 v207, v207, v87
    v_mfma_f32_16x16x32_bf16 v[212:215], a[236:239], a[120:123], v[212:215]
    v_cvt_pk_bf16_f32 v24, v184, v185
    v_cvt_pk_bf16_f32 v25, v186, v187
    v_mfma_f32_16x16x32_bf16 v[192:195], a[240:243], a[140:143], v[192:195]
    v_cvt_pk_bf16_f32 v26, v204, v205
    v_cvt_pk_bf16_f32 v27, v206, v207
    v_mfma_f32_16x16x32_bf16 v[212:215], a[244:247], a[140:143], v[212:215]
    v_permlane16_swap_b32 v24, v26
    v_permlane16_swap_b32 v25, v27
    v_mfma_f32_16x16x32_bf16 v[192:195], a[248:251], a[160:163], v[192:195]
    buffer_store_dwordx4 v[24:27], v3, s[60:63], 0 offen
    v_mfma_f32_16x16x32_bf16 v[212:215], a[252:255], a[160:163], v[212:215]
    v_add_f32 v68, v68, v108
    v_add_f32 v69, v69, v109
    v_mfma_f32_16x16x32_bf16 v[196:199], a[192:195], a[184:187], v[196:199]
    v_add_f32 v70, v70, v110
    v_add_f32 v71, v71, v111
    v_mfma_f32_16x16x32_bf16 v[216:219], a[196:199], a[184:187], v[216:219]
    v_add_f32 v88, v88, v128
    v_add_f32 v89, v89, v129
    v_mfma_f32_16x16x32_bf16 v[196:199], a[200:203], a[44:47], v[196:199]
    v_add_f32 v90, v90, v130
    v_add_f32 v91, v91, v131
    v_mfma_f32_16x16x32_bf16 v[216:219], a[204:207], a[44:47], v[216:219]
    v_add_f32 v68, v68, v148
    v_add_f32 v69, v69, v149
    v_mfma_f32_16x16x32_bf16 v[196:199], a[208:211], a[64:67], v[196:199]
    v_add_f32 v70, v70, v150
    v_add_f32 v71, v71, v151
    v_mfma_f32_16x16x32_bf16 v[216:219], a[212:215], a[64:67], v[216:219]
    v_add_f32 v88, v88, v168
    v_add_f32 v89, v89, v169
    v_mfma_f32_16x16x32_bf16 v[196:199], a[216:219], a[84:87], v[196:199]
    v_add_f32 v90, v90, v170
    v_add_f32 v91, v91, v171
    v_mfma_f32_16x16x32_bf16 v[216:219], a[220:223], a[84:87], v[216:219]
    v_add_f32 v188, v188, v68
    v_add_f32 v189, v189, v69
    v_mfma_f32_16x16x32_bf16 v[196:199], a[224:227], a[104:107], v[196:199]
    v_add_f32 v190, v190, v70
    v_add_f32 v191, v191, v71
    v_mfma_f32_16x16x32_bf16 v[216:219], a[228:231], a[104:107], v[216:219]
    v_add_f32 v208, v208, v88
    v_add_f32 v209, v209, v89
    v_mfma_f32_16x16x32_bf16 v[196:199], a[232:235], a[124:127], v[196:199]
    v_add_f32 v210, v210, v90
    v_add_f32 v211, v211, v91
    v_mfma_f32_16x16x32_bf16 v[216:219], a[236:239], a[124:127], v[216:219]
    v_cvt_pk_bf16_f32 v28, v188, v189
    v_cvt_pk_bf16_f32 v29, v190, v191
    v_mfma_f32_16x16x32_bf16 v[196:199], a[240:243], a[144:147], v[196:199]
    v_cvt_pk_bf16_f32 v30, v208, v209
    v_cvt_pk_bf16_f32 v31, v210, v211
    v_mfma_f32_16x16x32_bf16 v[216:219], a[244:247], a[144:147], v[216:219]
    v_permlane16_swap_b32 v28, v30
    v_permlane16_swap_b32 v29, v31
    v_mfma_f32_16x16x32_bf16 v[196:199], a[248:251], a[164:167], v[196:199]
    buffer_store_dwordx4 v[28:31], v3, s[60:63], s56 offen
    s_waitcnt lgkmcnt(12)
    v_mfma_f32_16x16x32_bf16 v[216:219], a[252:255], a[164:167], v[216:219]
    v_add_f32 v72, v72, v112
    v_add_f32 v73, v73, v113
    v_mfma_f32_16x16x32_bf16 v[200:203], a[192:195], a[188:191], v[200:203]
    v_add_f32 v74, v74, v114
    v_add_f32 v75, v75, v115
    v_mfma_f32_16x16x32_bf16 v[220:223], a[196:199], a[188:191], v[220:223]
    v_add_f32 v92, v92, v132
    v_add_f32 v93, v93, v133
    v_mfma_f32_16x16x32_bf16 v[200:203], a[200:203], a[48:51], v[200:203]
    v_add_f32 v94, v94, v134
    v_add_f32 v95, v95, v135
    v_mfma_f32_16x16x32_bf16 v[220:223], a[204:207], a[48:51], v[220:223]
    v_add_f32 v72, v72, v152
    v_add_f32 v73, v73, v153
    v_mfma_f32_16x16x32_bf16 v[200:203], a[208:211], a[68:71], v[200:203]
    v_add_f32 v74, v74, v154
    v_add_f32 v75, v75, v155
    v_mfma_f32_16x16x32_bf16 v[220:223], a[212:215], a[68:71], v[220:223]
    v_add_f32 v92, v92, v172
    v_add_f32 v93, v93, v173
    v_mfma_f32_16x16x32_bf16 v[200:203], a[216:219], a[88:91], v[200:203]
    v_add_f32 v94, v94, v174
    v_add_f32 v95, v95, v175
    v_mfma_f32_16x16x32_bf16 v[220:223], a[220:223], a[88:91], v[220:223]
    v_add_f32 v192, v192, v72
    v_add_f32 v193, v193, v73
    v_mfma_f32_16x16x32_bf16 v[200:203], a[224:227], a[108:111], v[200:203]
    v_add_f32 v194, v194, v74
    v_add_f32 v195, v195, v75
    v_mfma_f32_16x16x32_bf16 v[220:223], a[228:231], a[108:111], v[220:223]
    v_add_f32 v212, v212, v92
    v_add_f32 v213, v213, v93
    v_mfma_f32_16x16x32_bf16 v[200:203], a[232:235], a[128:131], v[200:203]
    v_add_f32 v214, v214, v94
    v_add_f32 v215, v215, v95
    v_mfma_f32_16x16x32_bf16 v[220:223], a[236:239], a[128:131], v[220:223]
    v_cvt_pk_bf16_f32 v32, v192, v193
    v_cvt_pk_bf16_f32 v33, v194, v195
    v_mfma_f32_16x16x32_bf16 v[200:203], a[240:243], a[148:151], v[200:203]
    v_cvt_pk_bf16_f32 v34, v212, v213
    v_cvt_pk_bf16_f32 v35, v214, v215
    v_mfma_f32_16x16x32_bf16 v[220:223], a[244:247], a[148:151], v[220:223]
    v_permlane16_swap_b32 v32, v34
    v_permlane16_swap_b32 v33, v35
    v_mfma_f32_16x16x32_bf16 v[200:203], a[248:251], a[168:171], v[200:203]
    buffer_store_dwordx4 v[32:35], v3, s[60:63], s57 offen
    s_waitcnt lgkmcnt(6)
    v_mfma_f32_16x16x32_bf16 v[220:223], a[252:255], a[168:171], v[220:223]
    v_add_f32 v76, v76, v116
    v_add_f32 v77, v77, v117
    v_pk_add_f32 v[78:79], v[78:79], v[118:119]
    v_pk_add_f32 v[96:97], v[96:97], v[136:137]
    v_pk_add_f32 v[98:99], v[98:99], v[138:139]
    v_pk_add_f32 v[76:77], v[76:77], v[156:157]
    v_pk_add_f32 v[78:79], v[78:79], v[158:159]
    v_pk_add_f32 v[96:97], v[96:97], v[176:177]
    v_pk_add_f32 v[98:99], v[98:99], v[178:179]
    v_pk_add_f32 v[196:197], v[196:197], v[76:77]
    v_pk_add_f32 v[198:199], v[198:199], v[78:79]
    v_pk_add_f32 v[216:217], v[216:217], v[96:97]
    v_pk_add_f32 v[218:219], v[218:219], v[98:99]
    v_cvt_pk_bf16_f32 v36, v196, v197
    v_cvt_pk_bf16_f32 v37, v198, v199
    v_cvt_pk_bf16_f32 v38, v216, v217
    v_cvt_pk_bf16_f32 v39, v218, v219
    s_nop 0
    v_permlane16_swap_b32 v36, v38
    v_permlane16_swap_b32 v37, v39
    buffer_store_dwordx4 v[36:39], v3, s[60:63], s58 offen
    s_waitcnt lgkmcnt(0)
    v_pk_add_f32 v[80:81], v[80:81], v[120:121]
    v_pk_add_f32 v[82:83], v[82:83], v[122:123]
    v_pk_add_f32 v[100:101], v[100:101], v[140:141]
    v_pk_add_f32 v[102:103], v[102:103], v[142:143]
    v_pk_add_f32 v[80:81], v[80:81], v[160:161]
    v_pk_add_f32 v[82:83], v[82:83], v[162:163]
    v_pk_add_f32 v[100:101], v[100:101], v[180:181]
    v_pk_add_f32 v[102:103], v[102:103], v[182:183]
    v_pk_add_f32 v[200:201], v[200:201], v[80:81]
    v_pk_add_f32 v[202:203], v[202:203], v[82:83]
    v_pk_add_f32 v[220:221], v[220:221], v[100:101]
    v_pk_add_f32 v[222:223], v[222:223], v[102:103]
    v_cvt_pk_bf16_f32 v40, v200, v201
    v_cvt_pk_bf16_f32 v41, v202, v203
    v_cvt_pk_bf16_f32 v42, v220, v221
    v_cvt_pk_bf16_f32 v43, v222, v223
    s_nop 0
    v_permlane16_swap_b32 v40, v42
    v_permlane16_swap_b32 v41, v43
    buffer_store_dwordx4 v[40:43], v3, s[60:63], s59 offen
c2_end:
    s_endpgm
.p2align 6
.type w2_table,@object
w2_table:
.long 30720, 5120, 56320, 0
.long 35840, 10240, 56320, 0
.long 40960, 46080, 1073741824, 0
.long 0, 51200, 1073741824, 0
.long 61440, 20480, 87040, 0
.long 66560, 25600, 87040, 0
.long 71680, 76800, 1073741824, 0
.long 15360, 81920, 1073741824, 0
.long 102400, 108032, 97280, 0
.long 102912, 92672, 97280, 0
.long 92160, 112640, 97792, 0
.long 107520, 113152, 97792, 0
.size w2_table, 192
.section .rodata,"a"
.p2align 6
.amdhsa_kernel standalone__adm_resblock__diffusion_kernel
  .amdhsa_next_free_vgpr 512
  .amdhsa_next_free_sgpr 100
  .amdhsa_accum_offset 256
  .amdhsa_group_segment_fixed_size 0
  .amdhsa_kernarg_size 96
  .amdhsa_user_sgpr_count 2
  .amdhsa_user_sgpr_kernarg_segment_ptr 1
  .amdhsa_system_sgpr_workgroup_id_x 1
.end_amdhsa_kernel
```
